```python
import torch

def _softmax(x, axis=-1):
    return torch.softmax(x, dim=axis)
def _gelu(x):
    return torch.nn.functional.gelu(x, approximate="tanh")
def _silu(x):
    return torch.nn.functional.silu(x)
def _sigmoid(x):
    return torch.sigmoid(x)
def _layernorm(x, axis=-1, eps=1e-5):
    m = x.mean(dim=axis, keepdim=True)
    v = x.var(dim=axis, keepdim=True, unbiased=False)
    return (x - m) / torch.sqrt(v + eps)
def _scatter_add(tgt, idx, src, axis=0):
    return tgt.clone().index_add_(axis, idx, src)
def _segment_sum(src, seg, n):
    out = torch.zeros((n,) + src.shape[1:], dtype=src.dtype)
    return out.index_add_(0, seg, src)
def _pad(x, pw):
    flat = tuple(v for pair in reversed(pw) for v in pair)
    return torch.nn.functional.pad(x, flat)

kernel_name = 'sequential_preLN__sliding_block__mixer_s_mlp__prompt'

def setup_inputs():

    _w = (lambda a: (lambda t: t.to(torch.bfloat16) if t.is_floating_point() else t)(torch.as_tensor(a)))
    def _A_setup():
        B, S, D = 1, 2048, 448
        return {
            "x": _w((lambda *s: torch.randn(*s, dtype=torch.bfloat16) * 0.05)(B, S, D)),
            "wqkv": _w((lambda *s: torch.randn(*s, dtype=torch.bfloat16) * 0.05)(D, 3 * D)),
            "wo": _w((lambda *s: torch.randn(*s, dtype=torch.bfloat16) * 0.05)(D, D)),
        }
    _A_in = _A_setup()

    def _B_setup():
        B, S, D, F = 1, 2048, 448, 1792
        return {
            "x":  _w((lambda *s: torch.randn(*s, dtype=torch.bfloat16) * 0.05)(B, S, D)),
            "w1": _w((lambda *s: torch.randn(*s, dtype=torch.bfloat16) * 3.2)(D, D) * (D ** -0.5)),
            "w2": _w((lambda *s: torch.randn(*s, dtype=torch.bfloat16) * 3.2)(D, D) * (D ** -0.5)),
            "w3": _w((lambda *s: torch.randn(*s, dtype=torch.bfloat16) * 3.2)(D, F) * (D ** -0.5)),
            "w4": _w((lambda *s: torch.randn(*s, dtype=torch.bfloat16) * 3.2)(F, D) * (F ** -0.5)),
        }
    _B_in = _B_setup()

    return {
        "A_x": _A_in["x"],
        "A_wqkv": _A_in["wqkv"],
        "A_wo": _A_in["wo"],
        "B_x": _B_in["x"],
        "B_w1": _B_in["w1"],
        "B_w2": _B_in["w2"],
        "B_w3": _B_in["w3"],
        "B_w4": _B_in["w4"],
    }

def reference(A_x, A_wqkv, A_wo, B_x, B_w1, B_w2, B_w3, B_w4):
    def _A_ref(x, wqkv, wo):
        B, S, D = x.shape
        H = 16; Dh = D // H; W = 256
        qkv = (lambda x, *d: x.permute(*d))((x @ wqkv).reshape(B, S, 3, H, Dh), 2, 0, 3, 1, 4)
        q, k, v = qkv[0], qkv[1], qkv[2]
        scores = torch.einsum("bhqd,bhkd->bhqk", q, k) * (Dh ** -0.5)
        idx = torch.arange(S)
        mask = (idx[:, None] - idx[None, :] >= 0) & (idx[:, None] - idx[None, :] < W)
        scores = torch.where(mask[None, None], scores, -1e9)
        p = _softmax(scores, axis=-1)
        o = torch.einsum("bhqk,bhkd->bhqd", p, v)
        return (lambda x, *d: x.permute(*d))(o, 0, 2, 1, 3).reshape(B, S, D) @ wo

    def _B_ref(x, w1, w2, w3, w4):
        B, S, D = x.shape
        h = _gelu(_layernorm(x, axis=-1) @ w1)
        c = D // 4
        g0 = _pad(h[:, :, 0*c:1*c], ((0, 0), (1, 0), (0, 0)))[:, :S, :]
        g1 = _pad(h[:, :, 1*c:2*c], ((0, 0), (0, 1), (0, 0)))[:, 1:, :]
        g2 = _pad(h[:, :, 2*c:3*c], ((0, 0), (2, 0), (0, 0)))[:, :S, :]
        g3 = _pad(h[:, :, 3*c:   ], ((0, 0), (0, 2), (0, 0)))[:, 2:, :]
        hs = torch.concatenate([g0, g1, g2, g3], axis=-1) @ w2
        x1 = x + hs
        h2 = _gelu(_layernorm(x1, axis=-1) @ w3) @ w4
        return x1 + h2

    x = A_x
    h = x + _A_ref(_layernorm(x, axis=-1), A_wqkv, A_wo)
    h2 = h + _B_ref(_layernorm(h, axis=-1), B_w1, B_w2, B_w3, B_w4)
    return h2
```

```asm
; @launch grid=(256,1,1) block=(256,1,1) lds=163840
.amdgcn_target "amdgcn-amd-amdhsa--gfx950"
.text
.globl sequential_preLN__sliding_block__mixer_s_mlp__prompt_kernel
.p2align 8
.type sequential_preLN__sliding_block__mixer_s_mlp__prompt_kernel,@function
sequential_preLN__sliding_block__mixer_s_mlp__prompt_kernel:
    s_load_dwordx2 s[8:9], s[0:1], 0
    s_load_dwordx2 s[12:13], s[0:1], 8
    s_load_dwordx2 s[4:5], s[0:1], 80
    s_cmp_ge_u32 s2, 256
    s_cbranch_scc1 L_end
    s_getpc_b64 s[60:61]
L_pc:
    s_sub_u32 s60, s60, L_pc-sequential_preLN__sliding_block__mixer_s_mlp__prompt_kernel
    s_subb_u32 s61, s61, 0
    s_mov_b32 s62, L_end-sequential_preLN__sliding_block__mixer_s_mlp__prompt_kernel
    s_mov_b32 s63, 0x20000
    s_lshr_b32 s59, s2, 3
    s_lshl_b32 s59, s59, 7
    v_lshlrev_b32 v41, 8, v0
    v_and_b32 v41, 0xf000, v41
    buffer_load_dword v41, v41, s[60:63], s59 offen
    v_and_b32 v1, 63, v0
    v_lshlrev_b32 v40, 7, v0
    v_lshrrev_b32_e64 v0, 6, v0
    s_and_b32 s40, s2, 7
    s_lshl_b32 s40, s40, 1
    s_lshr_b32 s41, s2, 7
    s_add_u32 s40, s40, s41
    s_bfe_u32 s41, s2, 0x40003
    v_readfirstlane_b32 s44, v0
    s_cmp_ge_u32 s41, 7
    s_cselect_b32 s46, 1, 0
    s_mul_i32 s43, s46, 7
    s_sub_u32 s43, s41, s43
    s_lshl_b32 s42, s40, 1
    s_add_u32 s42, s42, s46
    v_lshrrev_b32 v250, 3, v1
    v_and_b32_e64 v251, 7, v1
    v_mul_u32_u24 v239, 896, v250
    v_lshl_add_u32 v239, v251, 4, v239
    s_lshl_b32 s64, s42, 2
    s_add_u32 s64, s64, s44
    s_mul_i32 s64, s64, 14336
    s_add_u32 s65, s64, 7168
    s_lshl_b32 s66, s43, 7
    s_add_u32 s67, s66, s65
    s_add_u32 s66, s66, s64
    s_mov_b32 s68, s64
    s_bitcmp1_b32 s43, 0
    s_cselect_b32 s64, s65, s64
    s_cselect_b32 s65, s68, s65
    s_mov_b32 s10, 1835008
    s_mov_b32 s11, s63
    s_mov_b32 s14, 1204224
    s_mov_b32 s15, s63
    s_cmp_ge_u32 s41, 14
    s_waitcnt lgkmcnt(0)
    s_cbranch_scc0 L_p1
    s_lshl_b32 s68, s40, 1
    s_add_u32 s68, s68, s41
    s_sub_u32 s68, s68, 14
    s_mul_i32 s68, s68, 37632
    buffer_load_dword v43, v40, s[12:15], s68 offen
    s_add_u32 s68, s68, 32768
    v_cmp_gt_u32 vcc, 4864, v40
    s_nop 0
    s_and_saveexec_b64 s[58:59], vcc
    s_cbranch_execz L_hx
    buffer_load_dword v43, v40, s[12:15], s68 offen
L_hx:
    s_mov_b64 exec, -1
    s_branch L_hh
L_p1:
    buffer_load_dwordx4 v[184:187], v239, s[8:11], s66 offen nt
    buffer_load_dwordx4 v[188:191], v239, s[8:11], s67 offen nt
    buffer_load_dwordx4 v[128:131], v239, s[8:11], s64 offen offset:0 nt
    buffer_load_dwordx4 v[132:135], v239, s[8:11], s64 offen offset:128 nt
    buffer_load_dwordx4 v[136:139], v239, s[8:11], s64 offen offset:256 nt
    s_load_dwordx2 s[16:17], s[0:1], 16
    s_load_dwordx2 s[20:21], s[0:1], 32
    s_load_dwordx2 s[24:25], s[0:1], 40
    s_load_dwordx2 s[28:29], s[0:1], 48
    s_load_dwordx2 s[32:33], s[0:1], 56
    s_load_dwordx2 s[36:37], s[0:1], 64
    s_mov_b32 s6, 0x10000000
    s_mov_b32 s7, 0x20000
    v_mov_b32_e64 v255, 0
    buffer_load_dwordx4 v[140:143], v239, s[8:11], s64 offen offset:384 nt
    buffer_load_dword v4, v255, s[4:7], 0 offen sc1
    s_mov_b32 s48, 0x3f803f80
    s_mov_b32 s49, 0x00003f80
    s_mov_b32 s51, 0x3f800000
    s_mul_i32 s52, s44, 14592
    buffer_load_dwordx4 v[144:147], v239, s[8:11], s64 offen offset:512 nt
    v_mul_u32_u24 v246, 912, v250
    v_lshl_add_u32 v246, v251, 4, v246
    v_add_u32 v246, s52, v246
    s_and_b32 s53, s43, 1
    s_mul_i32 s54, s53, 7296
    v_add_u32 v244, s54, v246
    s_sub_u32 s54, 7296, s54
    v_add_u32 v245, s54, v246
    v_lshlrev_b32 v251, 4, v251
    buffer_load_dwordx4 v[148:151], v239, s[8:11], s64 offen offset:640 nt
    v_sub_u32 v90, v244, v251
    v_sub_u32 v91, v245, v251
    v_and_b32 v250, 15, v1
    v_lshrrev_b32 v251, 4, v1
    v_mul_u32_u24 v93, 912, v250
    v_lshl_add_u32 v93, v251, 3, v93
    v_add_u32_e64 v93, s52, v93
    v_mul_u32_u24 v94, 1824, v250
    v_lshl_add_u32 v247, v251, 4, v94
    buffer_load_dwordx4 v[152:155], v239, s[8:11], s64 offen offset:768 nt
    v_lshlrev_b32_e64 v95, 4, v250
    v_lshl_add_u32 v95, v251, 10, v95
    v_lshrrev_b32_e64 v252, 3, v1
    v_mul_u32_u24 v248, 2688, v252
    v_bfe_u32 v252, v1, 4, 1
    v_lshlrev_b32 v252, 2, v252
    v_and_b32 v253, 7, v1
    v_xor_b32_e64 v252, v252, v253
    v_lshl_add_u32 v248, v252, 4, v248
    buffer_load_dwordx4 v[156:159], v239, s[8:11], s65 offen offset:0 nt
    v_xor_b32_e64 v249, 32, v248
    v_add_u32 v249, 20480, v249
    v_mov_b32 v96, 0
    v_mov_b32 v97, 0
    v_mov_b32 v98, 0
    v_mov_b32 v99, 0
    v_mov_b32 v100, 0
    v_mov_b32 v101, 0
    v_mov_b32 v102, 0
    v_mov_b32 v103, 0
    s_branch L_skip1
.p2align 12
L_stub1:
    s_setpc_b64 s[56:57]
    s_nop 0
L_skip1:
    s_cmp_lg_u32 s44, 1
    s_cbranch_scc1 L_tour_1
    s_call_b64 s[56:57], L_stub4
L_tour_1:
    s_cmp_lg_u32 s44, 2
    s_cbranch_scc1 L_tour_2
    s_call_b64 s[56:57], L_stub3
L_tour_2:
    s_cmp_lg_u32 s44, 3
    s_cbranch_scc1 L_tour_3
    s_call_b64 s[56:57], L_stub2
L_tour_3:
    v_lshrrev_b32 v252, 5, v1
    v_mul_u32_u24 v250, 512, v252
    v_bfe_u32 v252, v1, 2, 2
    v_lshl_add_u32 v250, v252, 7, v250
    v_bfe_u32 v252, v1, 4, 1
    v_lshl_add_u32 v250, v252, 5, v250
    v_and_b32_e64 v252, 3, v1
    v_lshl_add_u32 v250, v252, 3, v250
    v_bfe_u32 v252, v1, 3, 1
    v_lshl_add_u32 v250, v252, 6, v250
    v_accvgpr_write_b32 a249, v250
    v_and_b32 v250, 0x1ff, v250
    v_lshl_add_u32 v250, v251, 10, v250
    s_lshl_b32 s54, s44, 5
    v_xor_b32 v250, s54, v250
    v_add_u32 v240, 58368, v250
    v_add_u32 v241, 107520, v250
    s_lshl_b32 s55, s44, 12
    s_lshl_b32 s54, s43, 14
    s_add_u32 s55, s55, s54
    s_mul_i32 s54, s40, 344064
    s_add_u32 s55, s55, s54
    s_lshl_b32 s54, s46, 9
    s_add_u32 s55, s55, s54
    s_add_u32 s55, s55, 1048576
    s_mul_i32 s56, s44, 43008
    s_lshl_b32 s57, s43, 7
    s_add_u32 s56, s56, s57
    s_lshl_b32 s57, s44, 11
    s_waitcnt lgkmcnt(0)
    s_lshl_b32 s47, s42, 3
    s_add_u32 s47, s47, s43
    s_mul_i32 s67, s44, 12288
    s_add_u32 s67, s67, 114688
    s_mul_i32 s70, s44, 401408
    s_lshl_b32 s52, s41, 7
    s_add_u32 s70, s70, s52
    s_mul_i32 s73, s46, 57344
    s_mul_i32 s52, s40, 344064
    s_add_u32 s73, s73, s52
    s_lshl_b32 s71, s43, 13
    s_add_u32 s71, s71, s73
    s_lshl_b32 s72, s47, 9
    s_lshl_b32 s52, s44, 7
    s_add_u32 s72, s72, s52
    s_mov_b32 s48, 0x3f803f80
    s_and_b32 s52, s44, 1
    s_mul_i32 s50, s52, 401408
    s_lshr_b32 s52, s44, 1
    s_mul_i32 s52, s52, 28672
    s_add_u32 s50, s50, s52
    s_lshl_b32 s52, s43, 7
    s_add_u32 s50, s50, s52
    s_add_u32 s50, s50, 802816
    v_lshrrev_b32 v110, 4, v1
    v_and_b32 v111, 15, v1
    v_lshlrev_b32 v111, 4, v111
    v_lshl_add_u32 v2, v110, 10, v111
    v_lshl_add_u32 v2, v0, 8, v2
    v_lshrrev_b32 v110, 5, v1
    v_and_b32 v111, 31, v1
    v_lshlrev_b32_e64 v111, 4, v111
    v_lshl_add_u32 v3, v110, 10, v111
    v_lshrrev_b32 v110, 2, v1
    v_lshlrev_b32 v111, 7, v110
    v_and_b32_e64 v110, 6, v110
    v_lshl_add_u32 v111, v110, 4, v111
    v_and_b32_e64 v110, 3, v1
    v_lshl_add_u32 v111, v110, 3, v111
    v_accvgpr_write_b32 a248, v111
    v_lshrrev_b32_e64 v252, 3, v1
    v_mul_u32_u24 v111, 3584, v252
    v_bfe_u32 v252, v1, 4, 1
    v_lshlrev_b32 v252, 2, v252
    v_and_b32 v253, 7, v1
    v_xor_b32_e64 v252, v252, v253
    v_lshl_add_u32 v111, v252, 4, v111
    v_accvgpr_write_b32 a252, v111
    s_mov_b32 s18, 401408
    s_mov_b32 s19, 0x20000
    s_mov_b32 s22, 401408
    s_mov_b32 s23, 0x20000
    s_mov_b32 s26, 401408
    s_mov_b32 s27, 0x20000
    s_mov_b32 s30, 1605632
    s_mov_b32 s31, 0x20000
    s_mov_b32 s34, 1605632
    s_mov_b32 s35, 0x20000
    s_mov_b32 s38, 1835008
    s_mov_b32 s39, 0x20000
    s_waitcnt vmcnt(9)
    buffer_load_dwordx4 v[160:163], v239, s[8:11], s65 offen offset:128 nt
    ds_write_b128 v246, v[184:187]
    ds_write_b128 v246, v[188:191] offset:7296
    s_waitcnt lgkmcnt(0)
    ds_read_b64 v[8:9], v93 offset:0
    ds_read_b64 v[10:11], v93 offset:32
    buffer_load_dwordx4 v[164:167], v239, s[8:11], s65 offen offset:256 nt
    ds_read_b64 v[12:13], v93 offset:64
    ds_read_b64 v[14:15], v93 offset:96
    s_waitcnt vmcnt(10)
    v_dot2c_f32_bf16 v96, s48, v128
    v_dot2c_f32_bf16 v98, v128, v128
    v_dot2c_f32_bf16 v97, s48, v129
    v_dot2c_f32_bf16 v99, v129, v129
    v_dot2c_f32_bf16 v96, s48, v130
    v_dot2c_f32_bf16 v98, v130, v130
    v_dot2c_f32_bf16 v97, s48, v131
    v_dot2c_f32_bf16 v99, v131, v131
    s_waitcnt vmcnt(9)
    v_dot2c_f32_bf16 v96, s48, v132
    v_dot2c_f32_bf16 v98, v132, v132
    v_dot2c_f32_bf16 v97, s48, v133
    v_dot2c_f32_bf16 v99, v133, v133
    buffer_load_dwordx4 v[168:171], v239, s[8:11], s65 offen offset:384 nt
    v_dot2c_f32_bf16 v96, s48, v134
    v_dot2c_f32_bf16 v98, v134, v134
    v_dot2c_f32_bf16 v97, s48, v135
    v_dot2c_f32_bf16 v99, v135, v135
    s_waitcnt vmcnt(9)
    v_dot2c_f32_bf16 v96, s48, v136
    v_dot2c_f32_bf16 v98, v136, v136
    v_dot2c_f32_bf16 v97, s48, v137
    v_dot2c_f32_bf16 v99, v137, v137
    v_dot2c_f32_bf16 v96, s48, v138
    v_dot2c_f32_bf16 v98, v138, v138
    v_dot2c_f32_bf16 v97, s48, v139
    v_dot2c_f32_bf16 v99, v139, v139
    s_waitcnt vmcnt(8)
    v_dot2c_f32_bf16 v96, s48, v140
    v_dot2c_f32_bf16 v98, v140, v140
    v_dot2c_f32_bf16 v97, s48, v141
    buffer_load_dwordx4 v[172:175], v239, s[8:11], s65 offen offset:512 nt
    v_dot2c_f32_bf16 v99, v141, v141
    v_dot2c_f32_bf16 v96, s48, v142
    v_dot2c_f32_bf16 v98, v142, v142
    v_dot2c_f32_bf16 v97, s48, v143
    v_dot2c_f32_bf16 v99, v143, v143
    s_waitcnt vmcnt(7)
    v_dot2c_f32_bf16 v96, s48, v144
    v_dot2c_f32_bf16 v98, v144, v144
    v_dot2c_f32_bf16 v97, s48, v145
    v_dot2c_f32_bf16 v99, v145, v145
    v_dot2c_f32_bf16 v96, s48, v146
    v_dot2c_f32_bf16 v98, v146, v146
    v_dot2c_f32_bf16 v97, s48, v147
    v_dot2c_f32_bf16 v99, v147, v147
    s_waitcnt vmcnt(6)
    v_dot2c_f32_bf16 v96, s48, v148
    v_dot2c_f32_bf16 v98, v148, v148
    buffer_load_dwordx4 v[176:179], v239, s[8:11], s65 offen offset:640 nt
    v_dot2c_f32_bf16 v97, s48, v149
    v_dot2c_f32_bf16 v99, v149, v149
    v_dot2c_f32_bf16 v96, s48, v150
    v_dot2c_f32_bf16 v98, v150, v150
    v_dot2c_f32_bf16 v97, s48, v151
    v_dot2c_f32_bf16 v99, v151, v151
    s_waitcnt vmcnt(6)
    v_dot2c_f32_bf16 v96, s48, v152
    v_dot2c_f32_bf16 v98, v152, v152
    v_dot2c_f32_bf16 v97, s48, v153
    v_dot2c_f32_bf16 v99, v153, v153
    v_dot2c_f32_bf16 v96, s48, v154
    v_dot2c_f32_bf16 v98, v154, v154
    v_dot2c_f32_bf16 v97, s48, v155
    v_dot2c_f32_bf16 v99, v155, v155
    s_nop 1
    v_add_f32_e64 v96, v96, v97
    buffer_load_dwordx4 v[180:183], v239, s[8:11], s65 offen offset:768 nt
    v_add_f32_e64 v98, v98, v99
    v_add_f32_dpp v96, v96, v96 quad_perm:[1,0,3,2] row_mask:0xf bank_mask:0xf
    s_nop 0
    v_add_f32_dpp v98, v98, v98 quad_perm:[1,0,3,2] row_mask:0xf bank_mask:0xf
    v_add_f32_dpp v96, v96, v96 quad_perm:[2,3,0,1] row_mask:0xf bank_mask:0xf
    s_nop 0
    v_add_f32_dpp v98, v98, v98 quad_perm:[2,3,0,1] row_mask:0xf bank_mask:0xf
    v_add_f32_dpp v96, v96, v96 row_half_mirror row_mask:0xf bank_mask:0xf
    s_nop 0
    v_add_f32_dpp v98, v98, v98 row_half_mirror row_mask:0xf bank_mask:0xf
    v_mul_f32 v96, 0xbb124925, v96
    v_mul_f32 v98, 0x3b124925, v98
    v_fma_f32 v98, -v96, v96, v98
    v_max_f32 v98, 0, v98
    v_add_f32 v98, 0x3727c5ac, v98
    v_rsq_f32 v98, v98
    s_waitcnt lgkmcnt(0)
    ds_write_b32 v90, v98 offset:896
    s_add_u32 m0, s57, 58368
    s_add_u32 s59, s56, 896
    buffer_load_dwordx4 v248, s[12:15], s59 offen lds
    v_dot2_f32_bf16 v112, v128, s49, v96
    v_dot2_f32_bf16 v113, v128, s51, v96
    v_dot2_f32_bf16 v114, v129, s49, v96
    v_dot2_f32_bf16 v115, v129, s51, v96
    v_dot2_f32_bf16 v116, v130, s49, v96
    v_dot2_f32_bf16 v117, v130, s51, v96
    v_dot2_f32_bf16 v118, v131, s49, v96
    v_dot2_f32_bf16 v119, v131, s51, v96
    v_cvt_pk_bf16_f32 v128, v112, v113
    v_cvt_pk_bf16_f32 v129, v114, v115
    v_cvt_pk_bf16_f32 v130, v116, v117
    v_cvt_pk_bf16_f32 v131, v118, v119
    ds_write_b128 v244, v[128:131] offset:0
    buffer_load_dwordx4 v249, s[12:15], s59 offen offset:1024 lds
    v_dot2_f32_bf16 v112, v132, s49, v96
    v_dot2_f32_bf16 v113, v132, s51, v96
    v_dot2_f32_bf16 v114, v133, s49, v96
    v_dot2_f32_bf16 v115, v133, s51, v96
    v_dot2_f32_bf16 v116, v134, s49, v96
    v_dot2_f32_bf16 v117, v134, s51, v96
    v_dot2_f32_bf16 v118, v135, s49, v96
    v_dot2_f32_bf16 v119, v135, s51, v96
    v_cvt_pk_bf16_f32 v132, v112, v113
    v_cvt_pk_bf16_f32 v133, v114, v115
    v_cvt_pk_bf16_f32 v134, v116, v117
    v_cvt_pk_bf16_f32 v135, v118, v119
    ds_write_b128 v244, v[132:135] offset:128
    s_add_u32 m0, s57, 66560
    s_add_u32 s59, s56, 172928
    buffer_load_dwordx4 v248, s[12:15], s59 offen lds
    v_dot2_f32_bf16 v112, v136, s49, v96
    v_dot2_f32_bf16 v113, v136, s51, v96
    v_dot2_f32_bf16 v114, v137, s49, v96
    v_dot2_f32_bf16 v115, v137, s51, v96
    v_dot2_f32_bf16 v116, v138, s49, v96
    v_dot2_f32_bf16 v117, v138, s51, v96
    v_dot2_f32_bf16 v118, v139, s49, v96
    v_dot2_f32_bf16 v119, v139, s51, v96
    v_cvt_pk_bf16_f32 v136, v112, v113
    v_cvt_pk_bf16_f32 v137, v114, v115
    v_cvt_pk_bf16_f32 v138, v116, v117
    v_cvt_pk_bf16_f32 v139, v118, v119
    ds_write_b128 v244, v[136:139] offset:256
    buffer_load_dwordx4 v249, s[12:15], s59 offen offset:1024 lds
    v_dot2_f32_bf16 v112, v140, s49, v96
    v_dot2_f32_bf16 v113, v140, s51, v96
    v_dot2_f32_bf16 v114, v141, s49, v96
    v_dot2_f32_bf16 v115, v141, s51, v96
    v_dot2_f32_bf16 v116, v142, s49, v96
    v_dot2_f32_bf16 v117, v142, s51, v96
    v_dot2_f32_bf16 v118, v143, s49, v96
    v_dot2_f32_bf16 v119, v143, s51, v96
    v_cvt_pk_bf16_f32 v140, v112, v113
    v_cvt_pk_bf16_f32 v141, v114, v115
    v_cvt_pk_bf16_f32 v142, v116, v117
    v_cvt_pk_bf16_f32 v143, v118, v119
    ds_write_b128 v244, v[140:143] offset:384
    s_add_u32 m0, s57, 74752
    s_add_u32 s59, s56, 344960
    buffer_load_dwordx4 v248, s[12:15], s59 offen lds
    v_dot2_f32_bf16 v112, v144, s49, v96
    v_dot2_f32_bf16 v113, v144, s51, v96
    v_dot2_f32_bf16 v114, v145, s49, v96
    v_dot2_f32_bf16 v115, v145, s51, v96
    v_dot2_f32_bf16 v116, v146, s49, v96
    v_dot2_f32_bf16 v117, v146, s51, v96
    v_dot2_f32_bf16 v118, v147, s49, v96
    v_dot2_f32_bf16 v119, v147, s51, v96
    v_cvt_pk_bf16_f32 v144, v112, v113
    v_cvt_pk_bf16_f32 v145, v114, v115
    v_cvt_pk_bf16_f32 v146, v116, v117
    v_cvt_pk_bf16_f32 v147, v118, v119
    ds_write_b128 v244, v[144:147] offset:512
    buffer_load_dwordx4 v249, s[12:15], s59 offen offset:1024 lds
    v_dot2_f32_bf16 v112, v148, s49, v96
    v_dot2_f32_bf16 v113, v148, s51, v96
    v_dot2_f32_bf16 v114, v149, s49, v96
    v_dot2_f32_bf16 v115, v149, s51, v96
    v_dot2_f32_bf16 v116, v150, s49, v96
    v_dot2_f32_bf16 v117, v150, s51, v96
    v_dot2_f32_bf16 v118, v151, s49, v96
    v_dot2_f32_bf16 v119, v151, s51, v96
    v_cvt_pk_bf16_f32 v148, v112, v113
    v_cvt_pk_bf16_f32 v149, v114, v115
    v_cvt_pk_bf16_f32 v150, v116, v117
    v_cvt_pk_bf16_f32 v151, v118, v119
    ds_write_b128 v244, v[148:151] offset:640
    s_add_u32 m0, s57, 82944
    s_add_u32 s59, s56, 516992
    buffer_load_dwordx4 v248, s[12:15], s59 offen lds
    v_dot2_f32_bf16 v112, v152, s49, v96
    v_dot2_f32_bf16 v113, v152, s51, v96
    v_dot2_f32_bf16 v114, v153, s49, v96
    v_dot2_f32_bf16 v115, v153, s51, v96
    v_dot2_f32_bf16 v116, v154, s49, v96
    v_dot2_f32_bf16 v117, v154, s51, v96
    v_dot2_f32_bf16 v118, v155, s49, v96
    v_dot2_f32_bf16 v119, v155, s51, v96
    v_cvt_pk_bf16_f32 v152, v112, v113
    v_cvt_pk_bf16_f32 v153, v114, v115
    v_cvt_pk_bf16_f32 v154, v116, v117
    v_cvt_pk_bf16_f32 v155, v118, v119
    ds_write_b128 v244, v[152:155] offset:768
    buffer_load_dwordx4 v249, s[12:15], s59 offen offset:1024 lds
    s_waitcnt vmcnt(14)
    v_dot2c_f32_bf16 v100, s48, v156
    v_dot2c_f32_bf16 v102, v156, v156
    v_dot2c_f32_bf16 v101, s48, v157
    v_dot2c_f32_bf16 v103, v157, v157
    v_dot2c_f32_bf16 v100, s48, v158
    v_dot2c_f32_bf16 v102, v158, v158
    v_dot2c_f32_bf16 v101, s48, v159
    v_dot2c_f32_bf16 v103, v159, v159
    s_waitcnt vmcnt(13)
    v_dot2c_f32_bf16 v100, s48, v160
    v_dot2c_f32_bf16 v102, v160, v160
    v_dot2c_f32_bf16 v101, s48, v161
    v_dot2c_f32_bf16 v103, v161, v161
    v_dot2c_f32_bf16 v100, s48, v162
    v_dot2c_f32_bf16 v102, v162, v162
    v_dot2c_f32_bf16 v101, s48, v163
    s_add_u32 m0, s57, 91136
    s_add_u32 s59, s56, 689024
    buffer_load_dwordx4 v248, s[12:15], s59 offen lds
    v_dot2c_f32_bf16 v103, v163, v163
    s_waitcnt vmcnt(13)
    v_dot2c_f32_bf16 v100, s48, v164
    v_dot2c_f32_bf16 v102, v164, v164
    v_dot2c_f32_bf16 v101, s48, v165
    v_dot2c_f32_bf16 v103, v165, v165
    v_dot2c_f32_bf16 v100, s48, v166
    v_dot2c_f32_bf16 v102, v166, v166
    v_dot2c_f32_bf16 v101, s48, v167
    v_dot2c_f32_bf16 v103, v167, v167
    s_waitcnt vmcnt(12)
    v_dot2c_f32_bf16 v100, s48, v168
    v_dot2c_f32_bf16 v102, v168, v168
    v_dot2c_f32_bf16 v101, s48, v169
    v_dot2c_f32_bf16 v103, v169, v169
    buffer_load_dwordx4 v249, s[12:15], s59 offen offset:1024 lds
    v_dot2c_f32_bf16 v100, s48, v170
    v_dot2c_f32_bf16 v102, v170, v170
    v_dot2c_f32_bf16 v101, s48, v171
    v_dot2c_f32_bf16 v103, v171, v171
    s_waitcnt vmcnt(12)
    v_dot2c_f32_bf16 v100, s48, v172
    v_dot2c_f32_bf16 v102, v172, v172
    v_dot2c_f32_bf16 v101, s48, v173
    v_dot2c_f32_bf16 v103, v173, v173
    v_dot2c_f32_bf16 v100, s48, v174
    v_dot2c_f32_bf16 v102, v174, v174
    v_dot2c_f32_bf16 v101, s48, v175
    v_dot2c_f32_bf16 v103, v175, v175
    s_waitcnt vmcnt(11)
    v_dot2c_f32_bf16 v100, s48, v176
    v_dot2c_f32_bf16 v102, v176, v176
    v_dot2c_f32_bf16 v101, s48, v177
    s_add_u32 m0, s57, 99328
    s_add_u32 s59, s56, 861056
    buffer_load_dwordx4 v248, s[12:15], s59 offen lds
    v_dot2c_f32_bf16 v103, v177, v177
    v_dot2c_f32_bf16 v100, s48, v178
    v_dot2c_f32_bf16 v102, v178, v178
    v_dot2c_f32_bf16 v101, s48, v179
    v_dot2c_f32_bf16 v103, v179, v179
    s_waitcnt vmcnt(11)
    v_dot2c_f32_bf16 v100, s48, v180
    v_dot2c_f32_bf16 v102, v180, v180
    v_dot2c_f32_bf16 v101, s48, v181
    v_dot2c_f32_bf16 v103, v181, v181
    v_dot2c_f32_bf16 v100, s48, v182
    v_dot2c_f32_bf16 v102, v182, v182
    v_dot2c_f32_bf16 v101, s48, v183
    v_dot2c_f32_bf16 v103, v183, v183
    buffer_load_dwordx4 v249, s[12:15], s59 offen offset:1024 lds
    s_nop 0
    v_add_f32_e64 v100, v100, v101
    v_add_f32 v102, v102, v103
    s_nop 0
    v_add_f32_dpp v100, v100, v100 quad_perm:[1,0,3,2] row_mask:0xf bank_mask:0xf
    v_add_f32_dpp v102, v102, v102 quad_perm:[1,0,3,2] row_mask:0xf bank_mask:0xf
    s_nop 0
    v_add_f32_dpp v100, v100, v100 quad_perm:[2,3,0,1] row_mask:0xf bank_mask:0xf
    v_add_f32_dpp v102, v102, v102 quad_perm:[2,3,0,1] row_mask:0xf bank_mask:0xf
    s_nop 0
    v_add_f32_dpp v100, v100, v100 row_half_mirror row_mask:0xf bank_mask:0xf
    v_add_f32_dpp v102, v102, v102 row_half_mirror row_mask:0xf bank_mask:0xf
    v_mul_f32 v100, 0xbb124925, v100
    v_mul_f32 v102, 0x3b124925, v102
    v_fma_f32 v102, -v100, v100, v102
    v_max_f32_e64 v102, 0, v102
    v_add_f32 v102, 0x3727c5ac, v102
    v_rsq_f32_e64 v102, v102
    ds_write_b32 v91, v102 offset:896
    s_add_u32 m0, s57, 107520
    s_add_u32 s59, s56, 1033088
    buffer_load_dwordx4 v248, s[12:15], s59 offen lds
    v_dot2_f32_bf16 v112, v156, s49, v100
    v_dot2_f32_bf16 v113, v156, s51, v100
    v_dot2_f32_bf16 v114, v157, s49, v100
    v_dot2_f32_bf16 v115, v157, s51, v100
    v_dot2_f32_bf16 v116, v158, s49, v100
    v_dot2_f32_bf16 v117, v158, s51, v100
    v_dot2_f32_bf16 v118, v159, s49, v100
    v_dot2_f32_bf16 v119, v159, s51, v100
    v_cvt_pk_bf16_f32 v156, v112, v113
    v_cvt_pk_bf16_f32 v157, v114, v115
    v_cvt_pk_bf16_f32 v158, v116, v117
    v_cvt_pk_bf16_f32 v159, v118, v119
    ds_write_b128 v245, v[156:159] offset:0
    buffer_load_dwordx4 v249, s[12:15], s59 offen offset:1024 lds
    v_dot2_f32_bf16 v112, v160, s49, v100
    v_dot2_f32_bf16 v113, v160, s51, v100
    v_dot2_f32_bf16 v114, v161, s49, v100
    v_dot2_f32_bf16 v115, v161, s51, v100
    v_dot2_f32_bf16 v116, v162, s49, v100
    v_dot2_f32_bf16 v117, v162, s51, v100
    v_dot2_f32_bf16 v118, v163, s49, v100
    v_dot2_f32_bf16 v119, v163, s51, v100
    v_cvt_pk_bf16_f32 v160, v112, v113
    v_cvt_pk_bf16_f32 v161, v114, v115
    v_cvt_pk_bf16_f32 v162, v116, v117
    v_cvt_pk_bf16_f32 v163, v118, v119
    ds_write_b128 v245, v[160:163] offset:128
    s_add_u32 m0, s57, 115712
    s_add_u32 s59, s56, 0
    s_nop 0
    buffer_load_dwordx4 v248, s[12:15], s59 offen lds
    v_dot2_f32_bf16 v112, v164, s49, v100
    v_dot2_f32_bf16 v113, v164, s51, v100
    v_dot2_f32_bf16 v114, v165, s49, v100
    v_dot2_f32_bf16 v115, v165, s51, v100
    v_dot2_f32_bf16 v116, v166, s49, v100
    v_dot2_f32_bf16 v117, v166, s51, v100
    v_dot2_f32_bf16 v118, v167, s49, v100
    v_dot2_f32_bf16 v119, v167, s51, v100
    v_cvt_pk_bf16_f32 v164, v112, v113
    v_cvt_pk_bf16_f32 v165, v114, v115
    v_cvt_pk_bf16_f32 v166, v116, v117
    v_cvt_pk_bf16_f32 v167, v118, v119
    ds_write_b128 v245, v[164:167] offset:256
    buffer_load_dwordx4 v249, s[12:15], s59 offen offset:1024 lds
    v_dot2_f32_bf16 v112, v168, s49, v100
    v_dot2_f32_bf16 v113, v168, s51, v100
    v_dot2_f32_bf16 v114, v169, s49, v100
    v_dot2_f32_bf16 v115, v169, s51, v100
    v_dot2_f32_bf16 v116, v170, s49, v100
    v_dot2_f32_bf16 v117, v170, s51, v100
    v_dot2_f32_bf16 v118, v171, s49, v100
    v_dot2_f32_bf16 v119, v171, s51, v100
    v_cvt_pk_bf16_f32 v168, v112, v113
    v_cvt_pk_bf16_f32 v169, v114, v115
    v_cvt_pk_bf16_f32 v170, v116, v117
    v_cvt_pk_bf16_f32 v171, v118, v119
    ds_write_b128 v245, v[168:171] offset:384
    v_dot2_f32_bf16 v112, v172, s49, v100
    v_dot2_f32_bf16 v113, v172, s51, v100
    v_dot2_f32_bf16 v114, v173, s49, v100
    v_dot2_f32_bf16 v115, v173, s51, v100
    v_dot2_f32_bf16 v116, v174, s49, v100
    v_dot2_f32_bf16 v117, v174, s51, v100
    v_dot2_f32_bf16 v118, v175, s49, v100
    v_dot2_f32_bf16 v119, v175, s51, v100
    v_cvt_pk_bf16_f32 v172, v112, v113
    s_waitcnt vmcnt(12)
    s_barrier
    ds_read_b64_tr_b16 a[0:1], v240 offset:0
    ds_read_b64_tr_b16 a[2:3], v240 offset:512
    ds_read_b64_tr_b16 a[4:5], v240 offset:4096
    ds_read_b64_tr_b16 a[6:7], v240 offset:4608
    v_cvt_pk_bf16_f32 v173, v114, v115
    v_cvt_pk_bf16_f32 v174, v116, v117
    v_cvt_pk_bf16_f32 v175, v118, v119
    ds_write_b128 v245, v[172:175] offset:512
    v_dot2_f32_bf16 v112, v176, s49, v100
    v_dot2_f32_bf16 v113, v176, s51, v100
    v_dot2_f32_bf16 v114, v177, s49, v100
    v_dot2_f32_bf16 v115, v177, s51, v100
    v_dot2_f32_bf16 v116, v178, s49, v100
    v_dot2_f32_bf16 v117, v178, s51, v100
    v_dot2_f32_bf16 v118, v179, s49, v100
    v_dot2_f32_bf16 v119, v179, s51, v100
    v_cvt_pk_bf16_f32 v176, v112, v113
    v_cvt_pk_bf16_f32 v177, v114, v115
    v_cvt_pk_bf16_f32 v178, v116, v117
    v_cvt_pk_bf16_f32 v179, v118, v119
    ds_write_b128 v245, v[176:179] offset:640
    v_dot2_f32_bf16 v112, v180, s49, v100
    v_dot2_f32_bf16 v113, v180, s51, v100
    v_dot2_f32_bf16 v114, v181, s49, v100
    v_dot2_f32_bf16 v115, v181, s51, v100
    v_dot2_f32_bf16 v116, v182, s49, v100
    v_dot2_f32_bf16 v117, v182, s51, v100
    v_dot2_f32_bf16 v118, v183, s49, v100
    v_dot2_f32_bf16 v119, v183, s51, v100
    v_cvt_pk_bf16_f32 v180, v112, v113
    v_cvt_pk_bf16_f32 v181, v114, v115
    v_cvt_pk_bf16_f32 v182, v116, v117
    v_cvt_pk_bf16_f32 v183, v118, v119
    ds_write_b128 v245, v[180:183] offset:768
    s_waitcnt lgkmcnt(0)
    s_barrier
    ds_read_b128 v[128:131], v247 offset:0
    ds_read_b128 v[132:135], v247 offset:912
    ds_read_b128 a[32:35], v247 offset:29184
    ds_read_b128 a[36:39], v247 offset:30096
    ds_read_b128 v[136:139], v247 offset:64
    ds_read_b128 v[140:143], v247 offset:976
    ds_read_b128 a[40:43], v247 offset:29248
    ds_read_b128 a[44:47], v247 offset:30160
    s_waitcnt lgkmcnt(6)
    v_mfma_f32_16x16x32_bf16 v[32:35], a[0:3], v[128:131], 0
    ds_read_b64_tr_b16 a[8:9], v240 offset:8192
    ds_read_b64_tr_b16 a[10:11], v240 offset:8704
    v_mfma_f32_16x16x32_bf16 v[36:39], a[0:3], v[132:135], 0
    ds_read_b128 v[144:147], v247 offset:128
    ds_read_b128 v[148:151], v247 offset:1040
    s_waitcnt lgkmcnt(8)
    v_mfma_f32_16x16x32_bf16 v[40:43], a[0:3], a[32:35], 0
    ds_read_b128 a[48:51], v247 offset:29312
    v_mfma_f32_16x16x32_bf16 v[44:47], a[0:3], a[36:39], 0
    ds_read_b128 a[52:55], v247 offset:30224
    s_add_u32 m0, s57, 123904
    s_add_u32 s59, s56, 172032
    buffer_load_dwordx4 v248, s[12:15], s59 offen lds
    s_waitcnt lgkmcnt(8)
    v_mfma_f32_16x16x32_bf16 v[32:35], a[4:7], v[136:139], v[32:35]
    ds_read_b64_tr_b16 a[12:13], v240 offset:12288
    ds_read_b64_tr_b16 a[14:15], v240 offset:12800
    v_mfma_f32_16x16x32_bf16 v[36:39], a[4:7], v[140:143], v[36:39]
    ds_read_b128 v[152:155], v247 offset:192
    ds_read_b128 v[156:159], v247 offset:1104
    s_waitcnt lgkmcnt(10)
    v_mfma_f32_16x16x32_bf16 v[40:43], a[4:7], a[40:43], v[40:43]
    ds_read_b128 a[56:59], v247 offset:29376
    v_mfma_f32_16x16x32_bf16 v[44:47], a[4:7], a[44:47], v[44:47]
    ds_read_b128 a[60:63], v247 offset:30288
    buffer_load_dwordx4 v249, s[12:15], s59 offen offset:1024 lds
    s_waitcnt vmcnt(10)
    s_barrier
    s_waitcnt lgkmcnt(8)
    v_mfma_f32_16x16x32_bf16 v[32:35], a[8:11], v[144:147], v[32:35]
    ds_read_b64_tr_b16 a[16:17], v240 offset:16384
    ds_read_b64_tr_b16 a[18:19], v240 offset:16896
    v_mfma_f32_16x16x32_bf16 v[36:39], a[8:11], v[148:151], v[36:39]
    ds_read_b128 v[160:163], v247 offset:256
    ds_read_b128 v[164:167], v247 offset:1168
    s_waitcnt lgkmcnt(10)
    v_mfma_f32_16x16x32_bf16 v[40:43], a[8:11], a[48:51], v[40:43]
    ds_read_b128 a[64:67], v247 offset:29440
    v_mfma_f32_16x16x32_bf16 v[44:47], a[8:11], a[52:55], v[44:47]
    ds_read_b128 a[68:71], v247 offset:30352
    s_add_u32 m0, s57, 132096
    s_add_u32 s59, s56, 344064
    buffer_load_dwordx4 v248, s[12:15], s59 offen lds
    s_waitcnt lgkmcnt(8)
    v_mfma_f32_16x16x32_bf16 v[32:35], a[12:15], v[152:155], v[32:35]
    ds_read_b64_tr_b16 a[20:21], v240 offset:20480
    ds_read_b64_tr_b16 a[22:23], v240 offset:20992
    v_mfma_f32_16x16x32_bf16 v[36:39], a[12:15], v[156:159], v[36:39]
    ds_read_b128 v[168:171], v247 offset:320
    ds_read_b128 v[172:175], v247 offset:1232
    s_waitcnt lgkmcnt(10)
    v_mfma_f32_16x16x32_bf16 v[40:43], a[12:15], a[56:59], v[40:43]
    ds_read_b128 a[72:75], v247 offset:29504
    v_mfma_f32_16x16x32_bf16 v[44:47], a[12:15], a[60:63], v[44:47]
    ds_read_b128 a[76:79], v247 offset:30416
    buffer_load_dwordx4 v249, s[12:15], s59 offen offset:1024 lds
    s_waitcnt lgkmcnt(8)
    v_mfma_f32_16x16x32_bf16 v[32:35], a[16:19], v[160:163], v[32:35]
    ds_read_b64_tr_b16 a[24:25], v240 offset:24576
    ds_read_b64_tr_b16 a[26:27], v240 offset:25088
    v_mfma_f32_16x16x32_bf16 v[36:39], a[16:19], v[164:167], v[36:39]
    ds_read_b128 v[176:179], v247 offset:384
    ds_read_b128 v[180:183], v247 offset:1296
    s_waitcnt lgkmcnt(10)
    v_mfma_f32_16x16x32_bf16 v[40:43], a[16:19], a[64:67], v[40:43]
    ds_read_b128 a[80:83], v247 offset:29568
    v_mfma_f32_16x16x32_bf16 v[44:47], a[16:19], a[68:71], v[44:47]
    ds_read_b128 a[84:87], v247 offset:30480
    s_add_u32 m0, s57, 140288
    s_add_u32 s59, s56, 516096
    buffer_load_dwordx4 v248, s[12:15], s59 offen lds
    s_waitcnt lgkmcnt(8)
    v_mfma_f32_16x16x32_bf16 v[32:35], a[20:23], v[168:171], v[32:35]
    ds_read_b64_tr_b16 a[28:29], v240 offset:28672
    ds_read_b64_tr_b16 a[30:31], v240 offset:29184
    v_mfma_f32_16x16x32_bf16 v[36:39], a[20:23], v[172:175], v[36:39]
    ds_read_b128 v[184:187], v247 offset:448
    ds_read_b128 v[188:191], v247 offset:1360
    s_waitcnt lgkmcnt(10)
    v_mfma_f32_16x16x32_bf16 v[40:43], a[20:23], a[72:75], v[40:43]
    ds_read_b128 a[88:91], v247 offset:29632
    v_mfma_f32_16x16x32_bf16 v[44:47], a[20:23], a[76:79], v[44:47]
    ds_read_b128 a[92:95], v247 offset:30544
    buffer_load_dwordx4 v249, s[12:15], s59 offen offset:1024 lds
    s_waitcnt vmcnt(10)
    s_barrier
    s_waitcnt lgkmcnt(8)
    v_mfma_f32_16x16x32_bf16 v[32:35], a[24:27], v[176:179], v[32:35]
    ds_read_b64_tr_b16 a[0:1], v240 offset:32768
    ds_read_b64_tr_b16 a[2:3], v240 offset:33280
    v_mfma_f32_16x16x32_bf16 v[36:39], a[24:27], v[180:183], v[36:39]
    ds_read_b128 v[192:195], v247 offset:512
    ds_read_b128 v[196:199], v247 offset:1424
    s_waitcnt lgkmcnt(10)
    v_mfma_f32_16x16x32_bf16 v[40:43], a[24:27], a[80:83], v[40:43]
    ds_read_b128 a[96:99], v247 offset:29696
    v_mfma_f32_16x16x32_bf16 v[44:47], a[24:27], a[84:87], v[44:47]
    ds_read_b128 a[100:103], v247 offset:30608
    s_add_u32 m0, s57, 148480
    s_add_u32 s59, s56, 688128
    buffer_load_dwordx4 v248, s[12:15], s59 offen lds
    s_waitcnt lgkmcnt(8)
    v_mfma_f32_16x16x32_bf16 v[32:35], a[28:31], v[184:187], v[32:35]
    ds_read_b64_tr_b16 a[4:5], v240 offset:36864
    s_branch L_skip2
.p2align 12
L_stub2:
    s_setpc_b64 s[56:57]
    s_nop 0
L_skip2:
    ds_read_b64_tr_b16 a[6:7], v240 offset:37376
    v_mfma_f32_16x16x32_bf16 v[36:39], a[28:31], v[188:191], v[36:39]
    ds_read_b128 v[200:203], v247 offset:576
    ds_read_b128 v[204:207], v247 offset:1488
    s_waitcnt lgkmcnt(10)
    v_mfma_f32_16x16x32_bf16 v[40:43], a[28:31], a[88:91], v[40:43]
    ds_read_b128 a[104:107], v247 offset:29760
    v_mfma_f32_16x16x32_bf16 v[44:47], a[28:31], a[92:95], v[44:47]
    ds_read_b128 a[108:111], v247 offset:30672
    buffer_load_dwordx4 v249, s[12:15], s59 offen offset:1024 lds
    s_waitcnt lgkmcnt(8)
    v_mfma_f32_16x16x32_bf16 v[32:35], a[0:3], v[192:195], v[32:35]
    ds_read_b64_tr_b16 a[8:9], v240 offset:40960
    ds_read_b64_tr_b16 a[10:11], v240 offset:41472
    v_mfma_f32_16x16x32_bf16 v[36:39], a[0:3], v[196:199], v[36:39]
    ds_read_b128 v[208:211], v247 offset:640
    ds_read_b128 v[212:215], v247 offset:1552
    s_waitcnt lgkmcnt(10)
    v_mfma_f32_16x16x32_bf16 v[40:43], a[0:3], a[96:99], v[40:43]
    ds_read_b128 a[112:115], v247 offset:29824
    v_mfma_f32_16x16x32_bf16 v[44:47], a[0:3], a[100:103], v[44:47]
    ds_read_b128 a[116:119], v247 offset:30736
    s_add_u32 m0, s57, 58368
    s_add_u32 s59, s56, 860160
    buffer_load_dwordx4 v248, s[12:15], s59 offen lds
    s_waitcnt lgkmcnt(8)
    v_mfma_f32_16x16x32_bf16 v[32:35], a[4:7], v[200:203], v[32:35]
    ds_read_b64_tr_b16 a[12:13], v240 offset:45056
    ds_read_b64_tr_b16 a[14:15], v240 offset:45568
    v_mfma_f32_16x16x32_bf16 v[36:39], a[4:7], v[204:207], v[36:39]
    ds_read_b128 v[216:219], v247 offset:704
    ds_read_b128 v[220:223], v247 offset:1616
    s_waitcnt lgkmcnt(10)
    v_mfma_f32_16x16x32_bf16 v[40:43], a[4:7], a[104:107], v[40:43]
    ds_read_b128 a[120:123], v247 offset:29888
    v_mfma_f32_16x16x32_bf16 v[44:47], a[4:7], a[108:111], v[44:47]
    ds_read_b128 a[124:127], v247 offset:30800
    buffer_load_dwordx4 v249, s[12:15], s59 offen offset:1024 lds
    s_waitcnt vmcnt(10)
    s_barrier
    s_waitcnt lgkmcnt(8)
    v_mfma_f32_16x16x32_bf16 v[32:35], a[8:11], v[208:211], v[32:35]
    ds_read_b64_tr_b16 a[16:17], v241 offset:0
    ds_read_b64_tr_b16 a[18:19], v241 offset:512
    v_mfma_f32_16x16x32_bf16 v[36:39], a[8:11], v[212:215], v[36:39]
    ds_read_b128 v[224:227], v247 offset:768
    ds_read_b128 v[228:231], v247 offset:1680
    s_waitcnt lgkmcnt(10)
    v_mfma_f32_16x16x32_bf16 v[40:43], a[8:11], a[112:115], v[40:43]
    ds_read_b128 a[128:131], v247 offset:29952
    v_mfma_f32_16x16x32_bf16 v[44:47], a[8:11], a[116:119], v[44:47]
    ds_read_b128 a[132:135], v247 offset:30864
    s_add_u32 m0, s57, 66560
    s_add_u32 s59, s56, 1032192
    buffer_load_dwordx4 v248, s[12:15], s59 offen lds
    s_waitcnt lgkmcnt(8)
    v_mfma_f32_16x16x32_bf16 v[32:35], a[12:15], v[216:219], v[32:35]
    ds_read_b64_tr_b16 a[20:21], v241 offset:4096
    ds_read_b64_tr_b16 a[22:23], v241 offset:4608
    v_mfma_f32_16x16x32_bf16 v[36:39], a[12:15], v[220:223], v[36:39]
    ds_read_b128 v[232:235], v247 offset:832
    ds_read_b128 v[236:239], v247 offset:1744
    s_waitcnt lgkmcnt(10)
    v_mfma_f32_16x16x32_bf16 v[40:43], a[12:15], a[120:123], v[40:43]
    ds_read_b128 a[136:139], v247 offset:30016
    v_mfma_f32_16x16x32_bf16 v[44:47], a[12:15], a[124:127], v[44:47]
    ds_read_b128 a[140:143], v247 offset:30928
    buffer_load_dwordx4 v249, s[12:15], s59 offen offset:1024 lds
    s_waitcnt lgkmcnt(8)
    v_mfma_f32_16x16x32_bf16 v[32:35], a[16:19], v[224:227], v[32:35]
    ds_read_b64_tr_b16 a[24:25], v241 offset:8192
    ds_read_b64_tr_b16 a[26:27], v241 offset:8704
    v_mfma_f32_16x16x32_bf16 v[36:39], a[16:19], v[228:231], v[36:39]
    ds_read_b32 v120, v94 offset:896
    s_waitcnt lgkmcnt(9)
    v_mfma_f32_16x16x32_bf16 v[40:43], a[16:19], a[128:131], v[40:43]
    ds_read_b32 v121, v94 offset:1808
    v_mfma_f32_16x16x32_bf16 v[44:47], a[16:19], a[132:135], v[44:47]
    s_add_u32 m0, s57, 74752
    s_add_u32 s59, s56, 1792
    buffer_load_dwordx4 v248, s[12:15], s59 offen lds
    s_waitcnt lgkmcnt(6)
    v_mfma_f32_16x16x32_bf16 v[32:35], a[20:23], v[232:235], v[32:35]
    ds_read_b64_tr_b16 a[28:29], v241 offset:12288
    ds_read_b64_tr_b16 a[30:31], v241 offset:12800
    v_mfma_f32_16x16x32_bf16 v[36:39], a[20:23], v[236:239], v[36:39]
    ds_read_b32 v122, v94 offset:30080
    s_waitcnt lgkmcnt(7)
    v_mfma_f32_16x16x32_bf16 v[40:43], a[20:23], a[136:139], v[40:43]
    ds_read_b32 v123, v94 offset:30992
    v_mfma_f32_16x16x32_bf16 v[44:47], a[20:23], a[140:143], v[44:47]
    buffer_load_dwordx4 v249, s[12:15], s59 offen offset:1024 lds
    s_waitcnt vmcnt(10)
    s_barrier
    s_waitcnt lgkmcnt(6)
    v_mfma_f32_16x16x32_bf16 v[48:51], a[24:27], v[128:131], 0
    ds_read_b64_tr_b16 a[0:1], v241 offset:16384
    v_mfma_f32_16x16x32_bf16 v[52:55], a[24:27], v[132:135], 0
    ds_read_b64_tr_b16 a[2:3], v241 offset:16896
    v_mfma_f32_16x16x32_bf16 v[56:59], a[24:27], a[32:35], 0
    v_mfma_f32_16x16x32_bf16 v[60:63], a[24:27], a[36:39], 0
    s_add_u32 m0, s57, 82944
    s_add_u32 s59, s56, 173824
    buffer_load_dwordx4 v248, s[12:15], s59 offen lds
    s_waitcnt lgkmcnt(4)
    v_mfma_f32_16x16x32_bf16 v[48:51], a[28:31], v[136:139], v[48:51]
    ds_read_b64_tr_b16 a[4:5], v241 offset:20480
    v_mfma_f32_16x16x32_bf16 v[52:55], a[28:31], v[140:143], v[52:55]
    ds_read_b64_tr_b16 a[6:7], v241 offset:20992
    s_waitcnt lgkmcnt(4)
    s_add_u32 s54, s55, 114688
    v_mfma_f32_16x16x32_bf16 v[56:59], a[28:31], a[40:43], v[56:59]
    v_mul_f32 v32, v32, v120
    v_mul_f32 v33, v33, v120
    v_mfma_f32_16x16x32_bf16 v[60:63], a[28:31], a[44:47], v[60:63]
    buffer_load_dwordx4 v249, s[12:15], s59 offen offset:1024 lds
    v_mul_f32_e64 v34, v34, v120
    v_mul_f32 v35, v35, v120
    s_waitcnt lgkmcnt(2)
    v_mfma_f32_16x16x32_bf16 v[48:51], a[0:3], v[144:147], v[48:51]
    ds_read_b64_tr_b16 a[8:9], v241 offset:24576
    v_mfma_f32_16x16x32_bf16 v[52:55], a[0:3], v[148:151], v[52:55]
    ds_read_b64_tr_b16 a[10:11], v241 offset:25088
    v_cvt_pk_bf16_f32 v80, v32, v33
    v_cvt_pk_bf16_f32 v81, v34, v35
    v_mfma_f32_16x16x32_bf16 v[56:59], a[0:3], a[48:51], v[56:59]
    v_mul_f32 v36, v36, v121
    v_mul_f32 v37, v37, v121
    v_mfma_f32_16x16x32_bf16 v[60:63], a[0:3], a[52:55], v[60:63]
    s_add_u32 m0, s57, 91136
    s_add_u32 s59, s56, 345856
    buffer_load_dwordx4 v248, s[12:15], s59 offen lds
    v_mul_f32_e64 v38, v38, v121
    v_mul_f32 v39, v39, v121
    s_waitcnt lgkmcnt(2)
    v_mfma_f32_16x16x32_bf16 v[48:51], a[4:7], v[152:155], v[48:51]
    ds_read_b64_tr_b16 a[12:13], v241 offset:28672
    v_mfma_f32_16x16x32_bf16 v[52:55], a[4:7], v[156:159], v[52:55]
    ds_read_b64_tr_b16 a[14:15], v241 offset:29184
    v_cvt_pk_bf16_f32 v82, v36, v37
    v_cvt_pk_bf16_f32 v83, v38, v39
    v_mfma_f32_16x16x32_bf16 v[56:59], a[4:7], a[56:59], v[56:59]
    buffer_store_dwordx4 v[80:83], v95, s[4:7], s54 offen offset:0 sc1
    v_mul_f32_e64 v40, v40, v122
    v_mfma_f32_16x16x32_bf16 v[60:63], a[4:7], a[60:63], v[60:63]
    buffer_load_dwordx4 v249, s[12:15], s59 offen offset:1024 lds
    v_mul_f32_e64 v41, v41, v122
    v_mul_f32 v42, v42, v122
    s_waitcnt vmcnt(11)
    s_barrier
    s_waitcnt lgkmcnt(2)
    v_mfma_f32_16x16x32_bf16 v[48:51], a[8:11], v[160:163], v[48:51]
    ds_read_b64_tr_b16 a[16:17], v241 offset:32768
    v_mfma_f32_16x16x32_bf16 v[52:55], a[8:11], v[164:167], v[52:55]
    ds_read_b64_tr_b16 a[18:19], v241 offset:33280
    v_mul_f32_e64 v43, v43, v122
    v_cvt_pk_bf16_f32 v84, v40, v41
    v_mfma_f32_16x16x32_bf16 v[56:59], a[8:11], a[64:67], v[56:59]
    v_cvt_pk_bf16_f32 v85, v42, v43
    v_mul_f32_e64 v44, v44, v123
    v_mfma_f32_16x16x32_bf16 v[60:63], a[8:11], a[68:71], v[60:63]
    s_add_u32 m0, s57, 99328
    s_add_u32 s59, s56, 517888
    buffer_load_dwordx4 v248, s[12:15], s59 offen lds
    v_mul_f32_e64 v45, v45, v123
    v_mul_f32 v46, v46, v123
    s_waitcnt lgkmcnt(2)
    v_mfma_f32_16x16x32_bf16 v[48:51], a[12:15], v[168:171], v[48:51]
    ds_read_b64_tr_b16 a[20:21], v241 offset:36864
    v_mfma_f32_16x16x32_bf16 v[52:55], a[12:15], v[172:175], v[52:55]
    ds_read_b64_tr_b16 a[22:23], v241 offset:37376
    v_readfirstlane_b32 s45, v4
    s_getreg_b32 s61, hwreg(HW_REG_XCC_ID, 0, 4)
    s_lshr_b32 s45, s45, 4
    s_mul_i32 s45, s45, 0x9E3779B1
    v_mul_f32 v47, v47, v123
    v_cvt_pk_bf16_f32 v86, v44, v45
    v_mfma_f32_16x16x32_bf16 v[56:59], a[12:15], a[72:75], v[56:59]
    v_cvt_pk_bf16_f32 v87, v46, v47
    buffer_store_dwordx4 v[84:87], v95, s[4:7], s54 offen offset:256 sc1
    v_mfma_f32_16x16x32_bf16 v[60:63], a[12:15], a[76:79], v[60:63]
    s_add_u32 s45, s45, 0x7F4A7C15
    s_lshl_b32 s45, s45, 4
    s_lshl_b32 s3, s40, 4
    s_add_u32 s3, s3, s41
    buffer_load_dwordx4 v249, s[12:15], s59 offen offset:1024 lds
    s_waitcnt lgkmcnt(2)
    v_mfma_f32_16x16x32_bf16 v[48:51], a[16:19], v[176:179], v[48:51]
    ds_read_b64_tr_b16 a[24:25], v241 offset:40960
    v_mfma_f32_16x16x32_bf16 v[52:55], a[16:19], v[180:183], v[52:55]
    ds_read_b64_tr_b16 a[26:27], v241 offset:41472
    s_mul_i32 s66, s44, 14336
    s_lshl_b32 s52, s43, 7
    s_cmp_ge_u32 s41, 14
    s_cselect_b32 s52, 1073741824, s52
    v_mfma_f32_16x16x32_bf16 v[56:59], a[16:19], a[80:83], v[56:59]
    v_mfma_f32_16x16x32_bf16 v[60:63], a[16:19], a[84:87], v[60:63]
    s_mul_i32 s68, s44, 100352
    s_add_u32 s68, s68, s52
    s_mul_i32 s69, s44, 200704
    s_add_u32 s69, s69, s52
    s_add_u32 m0, s57, 107520
    s_add_u32 s59, s56, 689920
    buffer_load_dwordx4 v248, s[12:15], s59 offen lds
    s_waitcnt lgkmcnt(2)
    v_mfma_f32_16x16x32_bf16 v[48:51], a[20:23], v[184:187], v[48:51]
    ds_read_b64_tr_b16 a[28:29], v241 offset:45056
    v_mfma_f32_16x16x32_bf16 v[52:55], a[20:23], v[188:191], v[52:55]
    ds_read_b64_tr_b16 a[30:31], v241 offset:45568
    v_lshrrev_b32_e64 v252, 3, v1
    v_mul_u32_u24 v251, 896, v252
    v_lshrrev_b32 v252, 4, v1
    v_lshlrev_b32 v252, 1, v252
    v_mfma_f32_16x16x32_bf16 v[56:59], a[20:23], a[88:91], v[56:59]
    v_mfma_f32_16x16x32_bf16 v[60:63], a[20:23], a[92:95], v[60:63]
    v_and_b32 v253, 7, v1
    v_xor_b32 v252, v252, v253
    v_lshl_add_u32 v251, v252, 4, v251
    v_accvgpr_write_b32 a250, v251
    buffer_load_dwordx4 v249, s[12:15], s59 offen offset:1024 lds
    s_waitcnt vmcnt(12)
    s_barrier
    s_waitcnt lgkmcnt(2)
    v_mfma_f32_16x16x32_bf16 v[48:51], a[24:27], v[192:195], v[48:51]
    ds_read_b64_tr_b16 a[0:1], v240 offset:0
    v_mfma_f32_16x16x32_bf16 v[52:55], a[24:27], v[196:199], v[52:55]
    ds_read_b64_tr_b16 a[2:3], v240 offset:512
    v_lshrrev_b32 v252, 3, v1
    v_mul_u32_u24 v251, 896, v252
    v_bfe_u32 v252, v1, 4, 1
    v_lshlrev_b32_e64 v252, 2, v252
    v_mfma_f32_16x16x32_bf16 v[56:59], a[24:27], a[96:99], v[56:59]
    v_mfma_f32_16x16x32_bf16 v[60:63], a[24:27], a[100:103], v[60:63]
    v_and_b32 v253, 7, v1
    v_xor_b32 v252, v252, v253
    v_lshl_add_u32 v251, v252, 4, v251
    v_accvgpr_write_b32 a251, v251
    s_add_u32 m0, s57, 115712
    s_add_u32 s59, s56, 861952
    buffer_load_dwordx4 v248, s[12:15], s59 offen lds
    s_waitcnt lgkmcnt(2)
    v_mfma_f32_16x16x32_bf16 v[48:51], a[28:31], v[200:203], v[48:51]
    ds_read_b64_tr_b16 a[4:5], v240 offset:4096
    v_mfma_f32_16x16x32_bf16 v[52:55], a[28:31], v[204:207], v[52:55]
    ds_read_b64_tr_b16 a[6:7], v240 offset:4608
    s_lshl_b32 s52, s40, 4
    v_lshrrev_b32 v252, 5, v1
    v_and_b32 v253, 15, v1
    v_add_lshl_u32 v254, v253, s52, 8
    v_mfma_f32_16x16x32_bf16 v[56:59], a[28:31], a[104:107], v[56:59]
    v_mfma_f32_16x16x32_bf16 v[60:63], a[28:31], a[108:111], v[60:63]
    v_lshl_add_u32 v254, v252, 19, v254
    s_min_u32 s52, s44, 2
    s_sub_u32 s52, 2, s52
    s_min_u32 s52, s52, s40
    buffer_load_dwordx4 v249, s[12:15], s59 offen offset:1024 lds
    s_waitcnt lgkmcnt(2)
    v_mfma_f32_16x16x32_bf16 v[48:51], a[0:3], v[208:211], v[48:51]
    ds_read_b64_tr_b16 a[8:9], v240 offset:8192
    v_mfma_f32_16x16x32_bf16 v[52:55], a[0:3], v[212:215], v[52:55]
    ds_read_b64_tr_b16 a[10:11], v240 offset:8704
    s_lshl_b32 s52, s52, 12
    s_mov_b64 exec, 0xffff
    v_subrev_u32 v254, s52, v254
    s_mov_b64 exec, -1
    v_mfma_f32_16x16x32_bf16 v[56:59], a[0:3], a[112:115], v[56:59]
    v_mfma_f32_16x16x32_bf16 v[60:63], a[0:3], a[116:119], v[60:63]
    s_mul_i32 s0, s41, 28
    s_add_u32 s1, s0, 27
    s_lshr_b32 s0, s0, 6
    s_lshr_b32 s1, s1, 6
    s_add_u32 m0, s57, 123904
    s_add_u32 s59, s56, 1033984
    buffer_load_dwordx4 v248, s[12:15], s59 offen lds
    s_waitcnt lgkmcnt(2)
    v_mfma_f32_16x16x32_bf16 v[48:51], a[4:7], v[216:219], v[48:51]
    ds_read_b64_tr_b16 a[12:13], v240 offset:12288
    v_mfma_f32_16x16x32_bf16 v[52:55], a[4:7], v[220:223], v[52:55]
    ds_read_b64_tr_b16 a[14:15], v240 offset:12800
    s_lshl_b32 s0, 1, s0
    s_bitset1_b32 s0, s1
    s_lshr_b32 s52, s44, 1
    s_lshl_b32 s52, s52, 3
    v_mfma_f32_16x16x32_bf16 v[56:59], a[4:7], a[120:123], v[56:59]
    v_mfma_f32_16x16x32_bf16 v[60:63], a[4:7], a[124:127], v[60:63]
    s_lshl_b32 s1, s0, s52
    s_mul_i32 s0, s0, 0x101
    s_add_u32 s52, s72, 786432
    v_mov_b32 v104, s52
    buffer_load_dwordx4 v249, s[12:15], s59 offen offset:1024 lds
    s_waitcnt vmcnt(12)
    s_barrier
    s_waitcnt lgkmcnt(2)
    v_mfma_f32_16x16x32_bf16 v[48:51], a[8:11], v[224:227], v[48:51]
    ds_read_b64_tr_b16 a[16:17], v240 offset:16384
    v_mfma_f32_16x16x32_bf16 v[52:55], a[8:11], v[228:231], v[52:55]
    ds_read_b64_tr_b16 a[18:19], v240 offset:16896
    s_cmp_eq_u32 s44, 0
    s_cselect_b32 s53, s3, s47
    s_lshl_b32 s53, s53, 8
    s_lshl_b32 s52, s44, 16
    v_mfma_f32_16x16x32_bf16 v[56:59], a[8:11], a[128:131], v[56:59]
    v_mfma_f32_16x16x32_bf16 v[60:63], a[8:11], a[132:135], v[60:63]
    s_add_u32 s53, s53, s52
    s_add_u32 s53, s53, 131072
    v_writelane_b32 v104, s53, 1
    s_lshl_b32 s53, s3, 8
    s_waitcnt lgkmcnt(2)
    v_mfma_f32_16x16x32_bf16 v[48:51], a[12:15], v[232:235], v[48:51]
    ds_read_b64_tr_b16 a[20:21], v240 offset:20480
    v_mfma_f32_16x16x32_bf16 v[52:55], a[12:15], v[236:239], v[52:55]
    ds_read_b64_tr_b16 a[22:23], v240 offset:20992
    s_add_u32 s53, s53, 458752
    v_writelane_b32 v104, s53, 2
    v_accvgpr_write_b32 a253, v104
    v_lshrrev_b32_e64 v104, 2, v1
    v_mfma_f32_16x16x32_bf16 v[56:59], a[12:15], a[136:139], v[56:59]
    v_mfma_f32_16x16x32_bf16 v[60:63], a[12:15], a[140:143], v[60:63]
    v_and_b32 v105, 3, v1
    v_lshlrev_b32 v105, 2, v105
    v_lshl_add_u32 v104, v104, 8, v105
    v_accvgpr_write_b32 a254, v104
    s_waitcnt lgkmcnt(2)
    v_mfma_f32_16x16x32_bf16 v[64:67], a[16:19], v[128:131], 0
    ds_read_b64_tr_b16 a[24:25], v240 offset:24576
    v_mfma_f32_16x16x32_bf16 v[68:71], a[16:19], v[132:135], 0
    ds_read_b64_tr_b16 a[26:27], v240 offset:25088
    v_bfe_u32 v104, v1, 2, 3
    v_lshlrev_b32 v104, 7, v104
    v_lshl_add_u32 v104, v105, 1, v104
    v_lshrrev_b32_e64 v105, 5, v1
    v_mfma_f32_16x16x32_bf16 v[72:75], a[16:19], a[32:35], 0
    v_mfma_f32_16x16x32_bf16 v[76:79], a[16:19], a[36:39], 0
    v_lshl_add_u32 v104, v105, 11, v104
    v_bfe_u32 v105, v1, 3, 1
    v_lshl_add_u32 v104, v105, 6, v104
    v_accvgpr_write_b32 a255, v104
    s_waitcnt lgkmcnt(2)
    v_mfma_f32_16x16x32_bf16 v[64:67], a[20:23], v[136:139], v[64:67]
    ds_read_b64_tr_b16 a[28:29], v240 offset:28672
    v_mfma_f32_16x16x32_bf16 v[68:71], a[20:23], v[140:143], v[68:71]
    ds_read_b64_tr_b16 a[30:31], v240 offset:29184
    s_add_u32 s54, s55, 0
    v_mul_f32_e64 v48, v48, v120
    v_mfma_f32_16x16x32_bf16 v[72:75], a[20:23], a[40:43], v[72:75]
    v_mul_f32 v49, v49, v120
    v_mul_f32 v50, v50, v120
    v_mfma_f32_16x16x32_bf16 v[76:79], a[20:23], a[44:47], v[76:79]
    v_mul_f32_e64 v51, v51, v120
    v_cvt_pk_bf16_f32 v80, v48, v49
    s_waitcnt vmcnt(7)
    s_waitcnt vmcnt(6)
    s_barrier
    s_cmp_lg_u32 s44, 0
    s_cbranch_scc1 L_sig_4
    s_lshl_b32 s51, s47, 8
    s_add_u32 s51, s51, 65536
    v_mov_b32 v242, s45
    v_lshlrev_b32 v243, 2, v1
    s_mov_b32 exec_hi, 0
    v_or_b32 v242, s61, v242
    buffer_store_dword v242, v243, s[4:7], s51 offen sc1
    s_mov_b32 exec_hi, -1
L_sig_4:
    s_waitcnt lgkmcnt(2)
    v_mfma_f32_16x16x32_bf16 v[64:67], a[24:27], v[144:147], v[64:67]
    ds_read_b64_tr_b16 a[0:1], v240 offset:32768
    v_mfma_f32_16x16x32_bf16 v[68:71], a[24:27], v[148:151], v[68:71]
    ds_read_b64_tr_b16 a[2:3], v240 offset:33280
    v_cvt_pk_bf16_f32 v81, v50, v51
    v_mul_f32_e64 v52, v52, v121
    v_mfma_f32_16x16x32_bf16 v[72:75], a[24:27], a[48:51], v[72:75]
    v_mul_f32 v53, v53, v121
    v_mul_f32 v54, v54, v121
    v_mfma_f32_16x16x32_bf16 v[76:79], a[24:27], a[52:55], v[76:79]
    v_mul_f32_e64 v55, v55, v121
    v_cvt_pk_bf16_f32 v82, v52, v53
    s_waitcnt lgkmcnt(2)
    v_mfma_f32_16x16x32_bf16 v[64:67], a[28:31], v[152:155], v[64:67]
    ds_read_b64_tr_b16 a[4:5], v240 offset:36864
    v_mfma_f32_16x16x32_bf16 v[68:71], a[28:31], v[156:159], v[68:71]
    ds_read_b64_tr_b16 a[6:7], v240 offset:37376
    v_cvt_pk_bf16_f32 v83, v54, v55
    buffer_store_dwordx4 v[80:83], v95, s[4:7], s54 offen offset:0 sc1
    v_mfma_f32_16x16x32_bf16 v[72:75], a[28:31], a[56:59], v[72:75]
    v_mul_f32 v56, v56, v122
    v_mul_f32_e64 v57, v57, v122
    v_mfma_f32_16x16x32_bf16 v[76:79], a[28:31], a[60:63], v[76:79]
    v_mul_f32_e64 v58, v58, v122
    v_mul_f32 v59, v59, v122
    s_waitcnt lgkmcnt(2)
    v_mfma_f32_16x16x32_bf16 v[64:67], a[0:3], v[160:163], v[64:67]
    ds_read_b64_tr_b16 a[8:9], v240 offset:40960
    v_mfma_f32_16x16x32_bf16 v[68:71], a[0:3], v[164:167], v[68:71]
    ds_read_b64_tr_b16 a[10:11], v240 offset:41472
    v_cvt_pk_bf16_f32 v84, v56, v57
    v_cvt_pk_bf16_f32 v85, v58, v59
    v_mfma_f32_16x16x32_bf16 v[72:75], a[0:3], a[64:67], v[72:75]
    v_mul_f32 v60, v60, v123
    v_mul_f32 v61, v61, v123
    v_mfma_f32_16x16x32_bf16 v[76:79], a[0:3], a[68:71], v[76:79]
    v_mul_f32_e64 v62, v62, v123
    v_mul_f32 v63, v63, v123
    s_waitcnt lgkmcnt(2)
    v_mfma_f32_16x16x32_bf16 v[64:67], a[4:7], v[168:171], v[64:67]
    ds_read_b64_tr_b16 a[12:13], v240 offset:45056
    v_mfma_f32_16x16x32_bf16 v[68:71], a[4:7], v[172:175], v[68:71]
    ds_read_b64_tr_b16 a[14:15], v240 offset:45568
    v_cvt_pk_bf16_f32 v86, v60, v61
    v_cvt_pk_bf16_f32 v87, v62, v63
    v_mfma_f32_16x16x32_bf16 v[72:75], a[4:7], a[72:75], v[72:75]
    buffer_store_dwordx4 v[84:87], v95, s[4:7], s54 offen offset:256 sc1
    v_mfma_f32_16x16x32_bf16 v[76:79], a[4:7], a[76:79], v[76:79]
    s_waitcnt vmcnt(4)
    s_barrier
    s_waitcnt lgkmcnt(2)
    v_mfma_f32_16x16x32_bf16 v[64:67], a[8:11], v[176:179], v[64:67]
    ds_read_b64_tr_b16 a[16:17], v241 offset:0
    v_mfma_f32_16x16x32_bf16 v[68:71], a[8:11], v[180:183], v[68:71]
    ds_read_b64_tr_b16 a[18:19], v241 offset:512
    v_mfma_f32_16x16x32_bf16 v[72:75], a[8:11], a[80:83], v[72:75]
    v_mfma_f32_16x16x32_bf16 v[76:79], a[8:11], a[84:87], v[76:79]
    s_waitcnt lgkmcnt(2)
    v_mfma_f32_16x16x32_bf16 v[64:67], a[12:15], v[184:187], v[64:67]
    ds_read_b64_tr_b16 a[20:21], v241 offset:4096
    v_mfma_f32_16x16x32_bf16 v[68:71], a[12:15], v[188:191], v[68:71]
    ds_read_b64_tr_b16 a[22:23], v241 offset:4608
    v_mfma_f32_16x16x32_bf16 v[72:75], a[12:15], a[88:91], v[72:75]
    v_mfma_f32_16x16x32_bf16 v[76:79], a[12:15], a[92:95], v[76:79]
    s_waitcnt lgkmcnt(2)
    v_mfma_f32_16x16x32_bf16 v[64:67], a[16:19], v[192:195], v[64:67]
    ds_read_b64_tr_b16 a[24:25], v241 offset:8192
    v_mfma_f32_16x16x32_bf16 v[68:71], a[16:19], v[196:199], v[68:71]
    ds_read_b64_tr_b16 a[26:27], v241 offset:8704
    v_mfma_f32_16x16x32_bf16 v[72:75], a[16:19], a[96:99], v[72:75]
    v_mfma_f32_16x16x32_bf16 v[76:79], a[16:19], a[100:103], v[76:79]
    s_waitcnt lgkmcnt(2)
    v_mfma_f32_16x16x32_bf16 v[64:67], a[20:23], v[200:203], v[64:67]
    ds_read_b64_tr_b16 a[28:29], v241 offset:12288
    v_mfma_f32_16x16x32_bf16 v[68:71], a[20:23], v[204:207], v[68:71]
    ds_read_b64_tr_b16 a[30:31], v241 offset:12800
    v_mfma_f32_16x16x32_bf16 v[72:75], a[20:23], a[104:107], v[72:75]
    v_mfma_f32_16x16x32_bf16 v[76:79], a[20:23], a[108:111], v[76:79]
    s_waitcnt vmcnt(2)
    s_barrier
    s_waitcnt lgkmcnt(2)
    v_mfma_f32_16x16x32_bf16 v[64:67], a[24:27], v[208:211], v[64:67]
    ds_read_b64_tr_b16 a[0:1], v241 offset:16384
    v_mfma_f32_16x16x32_bf16 v[68:71], a[24:27], v[212:215], v[68:71]
    ds_read_b64_tr_b16 a[2:3], v241 offset:16896
    v_mfma_f32_16x16x32_bf16 v[72:75], a[24:27], a[112:115], v[72:75]
    v_mfma_f32_16x16x32_bf16 v[76:79], a[24:27], a[116:119], v[76:79]
    s_waitcnt lgkmcnt(2)
    v_mfma_f32_16x16x32_bf16 v[64:67], a[28:31], v[216:219], v[64:67]
    ds_read_b64_tr_b16 a[4:5], v241 offset:20480
    v_mfma_f32_16x16x32_bf16 v[68:71], a[28:31], v[220:223], v[68:71]
    ds_read_b64_tr_b16 a[6:7], v241 offset:20992
    v_mfma_f32_16x16x32_bf16 v[72:75], a[28:31], a[120:123], v[72:75]
    v_mfma_f32_16x16x32_bf16 v[76:79], a[28:31], a[124:127], v[76:79]
    s_waitcnt lgkmcnt(2)
    v_mfma_f32_16x16x32_bf16 v[64:67], a[0:3], v[224:227], v[64:67]
    v_mfma_f32_16x16x32_bf16 v[68:71], a[0:3], v[228:231], v[68:71]
    v_mfma_f32_16x16x32_bf16 v[72:75], a[0:3], a[128:131], v[72:75]
    v_mfma_f32_16x16x32_bf16 v[76:79], a[0:3], a[132:135], v[76:79]
    s_waitcnt lgkmcnt(0)
    v_mfma_f32_16x16x32_bf16 v[64:67], a[4:7], v[232:235], v[64:67]
    v_mfma_f32_16x16x32_bf16 v[68:71], a[4:7], v[236:239], v[68:71]
    v_mfma_f32_16x16x32_bf16 v[72:75], a[4:7], a[136:139], v[72:75]
    v_mfma_f32_16x16x32_bf16 v[76:79], a[4:7], a[140:143], v[76:79]
    s_nop 4
    s_nop 0
    v_pk_mul_f32 v[64:65], v[64:65], v[120:121] op_sel:[0,0] op_sel_hi:[1,0]
    v_pk_mul_f32 v[66:67], v[66:67], v[120:121] op_sel:[0,0] op_sel_hi:[1,0]
    v_cvt_pk_bf16_f32 v80, v64, v65
    v_cvt_pk_bf16_f32 v81, v66, v67
    v_pk_mul_f32 v[68:69], v[68:69], v[120:121] op_sel:[0,1] op_sel_hi:[1,1]
    v_pk_mul_f32 v[70:71], v[70:71], v[120:121] op_sel:[0,1] op_sel_hi:[1,1]
    v_cvt_pk_bf16_f32 v82, v68, v69
    v_cvt_pk_bf16_f32 v83, v70, v71
    v_pk_mul_f32 v[72:73], v[72:73], v[122:123] op_sel:[0,0] op_sel_hi:[1,0]
    v_pk_mul_f32 v[74:75], v[74:75], v[122:123] op_sel:[0,0] op_sel_hi:[1,0]
    v_cvt_pk_bf16_f32 v84, v72, v73
    v_cvt_pk_bf16_f32 v85, v74, v75
    v_pk_mul_f32 v[76:77], v[76:77], v[122:123] op_sel:[0,1] op_sel_hi:[1,1]
    v_pk_mul_f32 v[78:79], v[78:79], v[122:123] op_sel:[0,1] op_sel_hi:[1,1]
    v_cvt_pk_bf16_f32 v86, v76, v77
    v_cvt_pk_bf16_f32 v87, v78, v79
    s_waitcnt vmcnt(0) lgkmcnt(0)
    s_barrier
    s_cmp_lg_u32 s44, 0
    s_cbranch_scc1 L_sig_5
    s_lshl_b32 s51, s47, 8
    s_add_u32 s51, s51, 589824
    v_mov_b32 v242, s45
    v_lshlrev_b32 v243, 2, v1
    s_mov_b32 exec_hi, 0
    buffer_store_dword v242, v243, s[4:7], s51 offen sc1
    s_mov_b32 exec_hi, -1
L_sig_5:
    s_mov_b32 s63, 65536
    s_mov_b32 exec_lo, s0
    s_mov_b32 exec_hi, 0
    buffer_load_dword v255, v254, s[4:7], s63 offen sc1
    s_mov_b64 exec, -1
    s_add_u32 s54, s55, 229376
    buffer_store_dwordx4 v[80:83], v95, s[4:7], s54 offen offset:0 sc1
    buffer_store_dwordx4 v[84:87], v95, s[4:7], s54 offen offset:256 sc1
    s_sub_u32 s57, 2, s40
    s_max_i32 s57, s57, 0
    v_lshrrev_b32 v125, 5, v1
    v_and_b32 v124, 31, v1
    v_lshlrev_b32_e64 v124, 3, v124
    v_lshl_add_u32 v234, v125, 10, v124
    v_lshlrev_b32_e64 v235, 4, v1
    s_mul_i32 s55, s40, 344064
    s_mul_i32 s54, s41, 7168
    s_add_u32 s55, s55, s54
    s_add_u32 s55, s55, 1048576
    s_sub_u32 s58, 2, s44
    s_mul_i32 s58, s58, 344064
    s_sub_u32 s58, s55, s58
    s_cmp_lt_u32 s44, s57
    s_cselect_b32 s58, 1073741824, s58
    s_lshl_b32 s53, s44, 8
    s_add_u32 s55, s55, s53
    s_lshl_b32 s59, s44, 10
    s_cmp_eq_u32 s44, 3
    s_cselect_b32 s59, 110592, s59
    s_cselect_b32 s58, 1073741824, s58
    v_and_b32 v112, 31, v1
    v_lshrrev_b32 v113, 5, v1
    v_lshlrev_b32 v114, 2, v113
    v_sub_u32 v112, v112, v114
    v_mov_b32 v114, 0xf149f2ca
    v_subrev_u32 v115, 0, v112
    v_ashrrev_i32 v115, 31, v115
    v_and_b32 v176, v114, v115
    v_xor_b32 v192, v114, v176
    v_subrev_u32 v115, 1, v112
    v_ashrrev_i32 v115, 31, v115
    v_and_b32 v177, v114, v115
    v_xor_b32 v193, v114, v177
    v_subrev_u32 v115, 2, v112
    v_ashrrev_i32 v115, 31, v115
    v_and_b32 v178, v114, v115
    v_xor_b32 v194, v114, v178
    v_subrev_u32 v115, 3, v112
    v_ashrrev_i32 v115, 31, v115
    v_and_b32 v179, v114, v115
    v_xor_b32 v195, v114, v179
    v_subrev_u32 v115, 8, v112
    v_ashrrev_i32 v115, 31, v115
    v_and_b32 v180, v114, v115
    v_xor_b32 v196, v114, v180
    v_subrev_u32 v115, 9, v112
    v_ashrrev_i32 v115, 31, v115
    v_and_b32 v181, v114, v115
    v_xor_b32 v197, v114, v181
    v_subrev_u32 v115, 10, v112
    v_ashrrev_i32 v115, 31, v115
    v_and_b32 v182, v114, v115
    v_xor_b32 v198, v114, v182
    v_subrev_u32 v115, 11, v112
    v_ashrrev_i32 v115, 31, v115
    v_and_b32 v183, v114, v115
    v_xor_b32 v199, v114, v183
    v_subrev_u32 v115, 16, v112
    v_ashrrev_i32 v115, 31, v115
    v_and_b32 v184, v114, v115
    v_xor_b32 v200, v114, v184
    v_subrev_u32 v115, 17, v112
    v_ashrrev_i32 v115, 31, v115
    v_and_b32 v185, v114, v115
    v_xor_b32 v201, v114, v185
    v_subrev_u32 v115, 18, v112
    v_ashrrev_i32 v115, 31, v115
    v_and_b32 v186, v114, v115
    v_xor_b32 v202, v114, v186
    v_subrev_u32 v115, 19, v112
    v_ashrrev_i32 v115, 31, v115
    v_and_b32 v187, v114, v115
    v_xor_b32 v203, v114, v187
    v_subrev_u32 v115, 24, v112
    v_ashrrev_i32 v115, 31, v115
    v_and_b32 v188, v114, v115
    v_xor_b32 v204, v114, v188
    v_subrev_u32 v115, 25, v112
    v_ashrrev_i32 v115, 31, v115
    v_and_b32 v189, v114, v115
    v_xor_b32 v205, v114, v189
    v_subrev_u32 v115, 26, v112
    v_ashrrev_i32 v115, 31, v115
    v_and_b32 v190, v114, v115
    v_xor_b32 v206, v114, v190
    v_subrev_u32 v115, 27, v112
    v_ashrrev_i32 v115, 31, v115
    v_and_b32_e64 v191, v114, v115
    v_xor_b32 v207, v114, v191
    s_cmp_lt_u32 s44, s57
    s_cselect_b32 s53, 0x0000f149, 0
    v_mov_b32 v116, s53
    v_mov_b32 v117, 0
    v_mov_b32 v118, s53
    v_mov_b32 v119, 0
    v_mov_b32 v120, 0x3f80
    v_mov_b32_e64 v121, 0
    v_mov_b32 v122, 0x3f80
    v_mov_b32_e64 v123, 0
    s_add_u32 s53, s59, 79072
    v_add_u32_e64 v112, s53, v235
    ds_write_b128 v112, v[116:119]
    ds_write_b128 v112, v[120:123] offset:24832
    v_and_b32 v112, 0xff, v234
    v_mul_u32_u24 v232, 3104, v113
    s_lshl_b32 s53, s44, 8
    s_add_u32 s52, s53, 57344
    v_add3_u32 v232, v232, v112, s52
    v_bfe_u32 v112, v1, 4, 1
    v_and_b32 v114, 3, v1
    v_lshl_add_u32 v112, v112, 2, v114
    v_mul_u32_u24 v233, 3104, v112
    v_lshl_add_u32 v233, v113, 5, v233
    v_bfe_u32 v112, v1, 2, 2
    v_lshl_add_u32 v233, v112, 3, v233
    s_add_u32 s52, s53, 82176
    v_add_u32_e64 v233, s52, v233
L_att:
    s_mov_b32 s62, 100000
    s_mov_b32 s63, 65536
    s_mov_b32 exec_lo, s0
    s_branch L_skip3
.p2align 12
L_stub3:
    s_setpc_b64 s[56:57]
    s_nop 0
L_skip3:
    s_mov_b32 exec_hi, 0
    s_waitcnt vmcnt(2)
L_sp_6:
    v_xor_b32 v239, s45, v255
    v_cmp_lt_u32 vcc, 15, v239
    s_sub_u32 s62, s62, 1
    s_cbranch_vccz L_spok_7
L_spr_8:
    buffer_load_dword v255, v254, s[4:7], s63 offen sc1
    s_waitcnt vmcnt(0)
    s_cmp_gt_i32 s62, 0
    s_cbranch_scc1 L_sp_6
L_spok_7:
    s_mov_b64 exec, -1
    s_cmp_ge_u32 s41, 14
    s_cbranch_scc1 L_fv_9
    s_waitcnt vmcnt(0)
    s_barrier
    s_cmp_lg_u32 s44, 0
    s_cbranch_scc1 L_sig_10
    s_lshl_b32 s51, s47, 8
    s_add_u32 s51, s51, 655360
    v_mov_b32 v242, s45
    v_lshlrev_b32 v243, 2, v1
    s_mov_b32 exec_hi, 0
    buffer_store_dword v242, v243, s[4:7], s51 offen sc1
    s_mov_b32 exec_hi, -1
L_sig_10:
L_fv_9:
    s_mov_b32 s63, 65536
    s_mov_b32 exec_lo, 0
    s_mov_b32 exec_hi, s1
    buffer_load_dword v255, v254, s[4:7], s63 offen sc1
    s_mov_b64 exec, -1
    s_add_u32 s54, s58, 114688
    s_add_u32 m0, s59, 57344
    s_nop 0
    buffer_load_dwordx4 v235, s[4:7], s54 offen offset:0 sc1 lds
    s_add_u32 m0, s59, 59424
    s_nop 0
    buffer_load_dwordx4 v235, s[4:7], s54 offen offset:1024 sc1 lds
    s_add_u32 m0, s59, 61504
    s_nop 0
    buffer_load_dwordx4 v235, s[4:7], s54 offen offset:2048 sc1 lds
    s_add_u32 m0, s59, 63584
    s_nop 0
    buffer_load_dwordx4 v235, s[4:7], s54 offen offset:3072 sc1 lds
    s_add_u32 s54, s58, 118784
    s_add_u32 m0, s59, 69760
    s_nop 0
    buffer_load_dwordx4 v235, s[4:7], s54 offen offset:0 sc1 lds
    s_add_u32 m0, s59, 71840
    s_nop 0
    buffer_load_dwordx4 v235, s[4:7], s54 offen offset:1024 sc1 lds
    s_add_u32 m0, s59, 73920
    s_nop 0
    buffer_load_dwordx4 v235, s[4:7], s54 offen offset:2048 sc1 lds
    v_and_b32 v104, 15, v1
    s_lshl_b32 s52, s42, 6
    s_lshl_b32 s53, s44, 4
    s_add_u32 s52, s52, s53
    v_add_u32 v104, s52, v104
    v_and_b32 v105, 48, v1
    v_lshlrev_b32 v105, 2, v105
    s_mul_i32 s53, s46, 0x00444444
    s_add_u32 s53, s53, 0xA3987210
    v_lshrrev_b32 v106, 3, v1
    v_lshlrev_b32 v106, 2, v106
    v_lshrrev_b32 v106, v106, s53
    v_and_b32 v106, 15, v106
    v_and_b32 v107, 7, v1
    v_lshl_add_u32 v106, v106, 3, v107
    v_lshlrev_b32_e64 v106, 4, v106
    v_accvgpr_write_b32 a240, v106
    s_cmp_eq_u32 s46, 0
    s_cselect_b32 s53, 1, -15
    v_and_b32 v106, 15, v1
    v_add_u32 v106, s53, v106
    v_and_b32 v106, 1, v106
    v_lshlrev_b32 v106, 4, v106
    v_lshrrev_b32_e64 v107, 1, v105
    v_add3_u32 v106, v106, v107, s67
    v_accvgpr_write_b32 a241, v106
    s_cmp_eq_u32 s46, 0
    s_cselect_b32 s53, 0, -14
    v_and_b32 v106, 15, v1
    v_add_u32 v106, s53, v106
    v_and_b32 v106, 1, v106
    v_lshlrev_b32 v106, 4, v106
    v_lshrrev_b32_e64 v107, 1, v105
    v_add3_u32 v106, v106, v107, s67
    v_accvgpr_write_b32 a242, v106
    s_mov_b32 s52, 0x7fff7fff
    s_cmp_eq_u32 s46, 0
    s_cselect_b32 s52, 0xfffefffe, s52
    s_mul_i32 s53, s46, 3
    s_cmp_eq_u32 s44, s53
    s_cselect_b32 s8, s52, -1
    s_mov_b32 s9, s8
    s_mov_b32 s52, 0x3fff3fff
    s_cmp_eq_u32 s46, 0
    s_cselect_b32 s52, 0xfffcfffc, s52
    s_mul_i32 s53, s46, 3
    s_cmp_eq_u32 s44, s53
    s_cselect_b32 s10, s52, -1
    s_mov_b32 s11, s10
    v_and_b32_e64 v106, 1, v1
    v_lshl_add_u32 v106, v106, 5, v105
    v_lshrrev_b32_e64 v106, 1, v106
    v_accvgpr_write_b32 a243, v106
    v_and_b32 v104, 127, v104
    v_add_u32 v106, 16, v1
    v_lshrrev_b32 v106, 6, v106
    v_sub_u32 v106, 4, v106
    v_lshlrev_b32 v106, v106, v104
    v_lshl_add_u32 v0, v105, 5, v106
    s_lshl_b32 s52, s43, 2
    s_add_u32 s52, s52, 0
    s_cmp_ge_u32 s52, 7
    s_cselect_b32 s53, -1, 1
    s_cmp_ge_u32 s52, 14
    s_cselect_b32 s53, 2, s53
    s_cmp_ge_u32 s52, 21
    s_cselect_b32 s53, -2, s53
    s_cmp_eq_u32 s43, 5
    s_cselect_b32 s52, 3, 4
    s_mov_b32 s62, 100000
    s_mov_b32 s63, 65536
    s_mov_b32 exec_lo, 0
    s_mov_b32 exec_hi, s1
    s_waitcnt vmcnt(7)
L_sp_11:
    v_xor_b32 v239, s45, v255
    v_cmp_lt_u32 vcc, 15, v239
    s_sub_u32 s62, s62, 1
    s_cbranch_vccz L_spok_12
L_spr_13:
    buffer_load_dword v255, v254, s[4:7], s63 offen sc1
    s_waitcnt vmcnt(0)
    s_cmp_gt_i32 s62, 0
    s_cbranch_scc1 L_sp_11
L_spok_12:
    s_mov_b64 exec, -1
    s_nop 0
    s_add_u32 s54, s55, 4096
    buffer_load_dwordx2 v[208:209], v234, s[4:7], s55 offen offset:0 sc1
    buffer_load_dwordx2 v[210:211], v234, s[4:7], s55 offen offset:2048 sc1
    buffer_load_dwordx2 v[212:213], v234, s[4:7], s54 offen offset:0 sc1
    buffer_load_dwordx2 v[214:215], v234, s[4:7], s54 offen offset:2048 sc1
    v_accvgpr_read_b32 v248, a250
    v_add_u32 v249, 6144, v248
    v_add_u32 v250, 12288, v248
    v_add_u32 v251, 18432, v248
    s_add_u32 m0, s66, 0x00000000
    s_add_u32 s64, s68, 0
    buffer_load_dwordx4 v248, s[16:19], s64 offen offset:0 lds
    v_add_u32_e64 v106, s53, v104
    v_bfe_u32 v108, v106, 7, 1
    v_bfe_u32 v107, v106, 6, 1
    v_mul_u32_u24 v107, 57344, v107
    v_and_or_b32 v106, v106, 63, v105
    v_lshl_add_u32 v106, v106, s52, v107
    v_lshl_add_u32 v106, v108, 30, v106
    v_accvgpr_write_b32 a244, v106
    s_lshl_b32 s52, s43, 2
    s_add_u32 s52, s52, 1
    s_cmp_ge_u32 s52, 7
    s_cselect_b32 s53, -1, 1
    s_cmp_ge_u32 s52, 14
    s_cselect_b32 s53, 2, s53
    s_cmp_ge_u32 s52, 21
    s_cselect_b32 s53, -2, s53
    s_cmp_eq_u32 s43, 5
    s_cselect_b32 s52, 3, 4
    buffer_load_dwordx4 v249, s[16:19], s64 offen offset:1024 lds
    v_add_u32_e64 v106, s53, v104
    v_bfe_u32 v108, v106, 7, 1
    v_bfe_u32 v107, v106, 6, 1
    v_mul_u32_u24 v107, 57344, v107
    v_and_or_b32 v106, v106, 63, v105
    v_lshl_add_u32 v106, v106, s52, v107
    v_lshl_add_u32 v106, v108, 30, v106
    v_accvgpr_write_b32 a245, v106
    s_lshl_b32 s52, s43, 2
    s_add_u32 s52, s52, 2
    s_cmp_ge_u32 s52, 7
    s_cselect_b32 s53, -1, 1
    s_cmp_ge_u32 s52, 14
    s_cselect_b32 s53, 2, s53
    s_cmp_ge_u32 s52, 21
    s_cselect_b32 s53, -2, s53
    s_cmp_eq_u32 s43, 1
    s_cselect_b32 s52, 3, 4
    buffer_load_dwordx4 v250, s[16:19], s64 offen offset:2048 lds
    v_add_u32_e64 v106, s53, v104
    v_bfe_u32 v108, v106, 7, 1
    v_bfe_u32 v107, v106, 6, 1
    v_mul_u32_u24 v107, 57344, v107
    v_and_or_b32 v106, v106, 63, v105
    v_lshl_add_u32 v106, v106, s52, v107
    v_lshl_add_u32 v106, v108, 30, v106
    v_accvgpr_write_b32 a246, v106
    s_lshl_b32 s52, s43, 2
    s_add_u32 s52, s52, 3
    s_cmp_ge_u32 s52, 7
    s_cselect_b32 s53, -1, 1
    s_cmp_ge_u32 s52, 14
    s_cselect_b32 s53, 2, s53
    s_cmp_ge_u32 s52, 21
    s_cselect_b32 s53, -2, s53
    s_cmp_eq_u32 s43, 1
    s_cselect_b32 s52, 3, 4
    buffer_load_dwordx4 v251, s[16:19], s64 offen offset:3072 lds
    v_add_u32_e64 v106, s53, v104
    v_bfe_u32 v108, v106, 7, 1
    v_bfe_u32 v107, v106, 6, 1
    v_mul_u32_u24 v107, 57344, v107
    v_and_or_b32 v106, v106, 63, v105
    v_lshl_add_u32 v106, v106, s52, v107
    v_lshl_add_u32 v106, v108, 30, v106
    v_accvgpr_write_b32 a247, v106
    v_accvgpr_read_b32 v240, a253
    s_add_u32 m0, s66, 0x00001000
    s_add_u32 s64, s68, 28672
    buffer_load_dwordx4 v248, s[16:19], s64 offen offset:0 lds
    buffer_load_dwordx4 v249, s[16:19], s64 offen offset:1024 lds
    s_cmp_lg_u32 s44, 0
    s_cbranch_scc1 L_tour_14
    s_call_b64 s[56:57], L_stub8
L_tour_14:
    s_cmp_lg_u32 s44, 1
    s_cbranch_scc1 L_tour_15
    s_call_b64 s[56:57], L_stub7
L_tour_15:
    s_cmp_lg_u32 s44, 2
    s_cbranch_scc1 L_tour_16
    s_call_b64 s[56:57], L_stub6
L_tour_16:
    s_cmp_lg_u32 s44, 3
    s_cbranch_scc1 L_tour_17
    s_call_b64 s[56:57], L_stub5
    s_call_b64 s[56:57], L_stub9
L_tour_17:
    s_lshl_b32 s53, s44, 8
    s_add_u32 s56, s55, s53
    v_lshlrev_b32 v238, 1, v234
    s_and_b32 s57, s3, 31
    s_lshl_b32 s57, s57, 2
    s_add_u32 s57, s57, s44
    s_mul_i32 s57, s57, 3200
    v_lshlrev_b32 v241, 7, v1
    s_mov_b32 s63, 655360
    s_mov_b32 exec_lo, s0
    s_mov_b32 exec_hi, 0
    buffer_load_dword v255, v254, s[4:7], s63 offen sc1
    s_mov_b64 exec, -1
    s_waitcnt vmcnt(7) lgkmcnt(0)
    s_barrier
    s_nop 0
    ds_read_b64 a[184:185], v232 offset:0
    ds_read_b64 a[186:187], v232 offset:6208
    ds_read_b64 a[188:189], v232 offset:12416
    ds_read_b64 a[190:191], v232 offset:18624
    ds_read_b64 a[192:193], v232 offset:256
    ds_read_b64 a[194:195], v232 offset:6464
    ds_read_b64 a[196:197], v232 offset:12672
    ds_read_b64 a[198:199], v232 offset:18880
    s_cmp_lg_u32 s44, 0
    s_cbranch_scc1 L_sig_18
    s_lshl_b32 s51, s3, 8
    s_add_u32 s51, s51, 720896
    v_mov_b32 v242, s45
    v_lshlrev_b32 v243, 2, v1
    s_mov_b32 exec_hi, 0
    buffer_store_dword v242, v243, s[4:7], s51 offen sc1
    s_mov_b32 exec_hi, -1
L_sig_18:
    s_mov_b32 exec_lo, 0
    v_mov_b32 v214, 0x3f80
    v_mov_b32_e64 v215, 0
    s_mov_b32 exec_lo, -1
    s_waitcnt lgkmcnt(4)
    v_mfma_f32_32x32x16_bf16 v[32:47], a[184:187], v[208:211], v[192:207]
    ds_read_b64 a[200:201], v232 offset:512
    ds_read_b64 a[202:203], v232 offset:6720
    v_mfma_f32_32x32x16_bf16 v[32:47], a[188:191], v[212:215], v[32:47]
    ds_read_b64 a[204:205], v232 offset:12928
    ds_read_b64 a[206:207], v232 offset:19136
    buffer_load_dwordx4 v250, s[16:19], s64 offen offset:2048 lds
    buffer_load_dwordx4 v251, s[16:19], s64 offen offset:3072 lds
    s_waitcnt lgkmcnt(4)
    v_mfma_f32_32x32x16_bf16 v[48:63], a[192:195], v[208:211], 0
    ds_read_b64 a[184:185], v232 offset:768
    ds_read_b64 a[186:187], v232 offset:6976
    v_mfma_f32_32x32x16_bf16 v[48:63], a[196:199], v[212:215], v[48:63]
    s_nop 0
    ds_read_b64 a[188:189], v232 offset:13184
    ds_read_b64 a[190:191], v232 offset:19392
    s_add_u32 m0, s66, 0x00002000
    s_add_u32 s64, s68, 57344
    buffer_load_dwordx4 v248, s[16:19], s64 offen offset:0 lds
    buffer_load_dwordx4 v249, s[16:19], s64 offen offset:1024 lds
    s_waitcnt lgkmcnt(4)
    v_mfma_f32_32x32x16_bf16 v[64:79], a[200:203], v[208:211], 0
    ds_read_b64 a[192:193], v232 offset:1024
    ds_read_b64 a[194:195], v232 offset:7232
    v_max_f32 v236, v32, v33
    v_max_f32_e64 v237, v34, v35
    v_max3_f32 v236, v36, v37, v236
    v_max3_f32 v237, v38, v39, v237
    v_mfma_f32_32x32x16_bf16 v[64:79], a[204:207], v[212:215], v[64:79]
    ds_read_b64 a[196:197], v232 offset:13440
    ds_read_b64 a[198:199], v232 offset:19648
    buffer_load_dwordx4 v250, s[16:19], s64 offen offset:2048 lds
    buffer_load_dwordx4 v251, s[16:19], s64 offen offset:3072 lds
    v_max3_f32 v236, v40, v41, v236
    v_max3_f32 v237, v42, v43, v237
    v_max3_f32 v236, v44, v45, v236
    v_max3_f32 v237, v46, v47, v237
    s_waitcnt lgkmcnt(4)
    v_mfma_f32_32x32x16_bf16 v[80:95], a[184:187], v[208:211], 0
    ds_read_b64 a[200:201], v232 offset:1280
    ds_read_b64 a[202:203], v232 offset:7488
    v_max3_f32 v236, v48, v49, v236
    v_max3_f32 v237, v50, v51, v237
    v_max3_f32 v236, v52, v53, v236
    v_max3_f32 v237, v54, v55, v237
    v_mfma_f32_32x32x16_bf16 v[80:95], a[188:191], v[212:215], v[80:95]
    s_nop 0
    ds_read_b64 a[204:205], v232 offset:13696
    ds_read_b64 a[206:207], v232 offset:19904
    s_add_u32 m0, s66, 0x00003000
    s_add_u32 s64, s68, 86016
    buffer_load_dwordx4 v248, s[16:19], s64 offen offset:0 lds
    v_max3_f32 v236, v56, v57, v236
    v_max3_f32 v237, v58, v59, v237
    v_max3_f32 v236, v60, v61, v236
    v_max3_f32 v237, v62, v63, v237
    s_waitcnt lgkmcnt(4)
    v_mfma_f32_32x32x16_bf16 v[96:111], a[192:195], v[208:211], 0
    ds_read_b64 a[184:185], v232 offset:1536
    ds_read_b64 a[186:187], v232 offset:7744
    v_max3_f32 v236, v64, v65, v236
    v_max3_f32 v237, v66, v67, v237
    v_max3_f32 v236, v68, v69, v236
    v_max3_f32 v237, v70, v71, v237
    v_mfma_f32_32x32x16_bf16 v[96:111], a[196:199], v[212:215], v[96:111]
    s_nop 0
    ds_read_b64 a[188:189], v232 offset:13952
    ds_read_b64 a[190:191], v232 offset:20160
    buffer_load_dwordx4 v249, s[16:19], s64 offen offset:1024 lds
    v_max3_f32 v236, v72, v73, v236
    v_max3_f32 v237, v74, v75, v237
    v_max3_f32 v236, v76, v77, v236
    v_max3_f32 v237, v78, v79, v237
    s_mov_b32 s62, 100000
    s_mov_b32 s63, 655360
    s_mov_b32 exec_lo, s0
    s_mov_b32 exec_hi, 0
    s_waitcnt vmcnt(8)
L_sp_19:
    v_xor_b32 v239, s45, v255
    v_cmp_lt_u32 vcc, 15, v239
    s_sub_u32 s62, s62, 1
    s_cbranch_vccz L_spok_20
L_spr_21:
    buffer_load_dword v255, v254, s[4:7], s63 offen sc1
    s_waitcnt vmcnt(0)
    s_cmp_gt_i32 s62, 0
    s_cbranch_scc1 L_sp_19
L_spok_20:
    s_mov_b64 exec, -1
    s_waitcnt lgkmcnt(4)
    v_mfma_f32_32x32x16_bf16 v[112:127], a[200:203], v[208:211], 0
    ds_read_b64 a[192:193], v232 offset:1792
    ds_read_b64 a[194:195], v232 offset:8000
    s_add_u32 s54, s58, 229376
    s_add_u32 m0, s59, 82176
    s_nop 0
    buffer_load_dwordx4 v235, s[4:7], s54 offen offset:0 sc1 lds
    v_max3_f32 v236, v80, v81, v236
    v_max3_f32 v237, v82, v83, v237
    v_max3_f32 v236, v84, v85, v236
    v_max3_f32 v237, v86, v87, v237
    v_mfma_f32_32x32x16_bf16 v[112:127], a[204:207], v[212:215], v[112:127]
    ds_read_b64 a[196:197], v232 offset:14208
    ds_read_b64 a[198:199], v232 offset:20416
    s_add_u32 m0, s59, 84256
    s_nop 0
    buffer_load_dwordx4 v235, s[4:7], s54 offen offset:1024 sc1 lds
    v_max3_f32 v236, v88, v89, v236
    v_max3_f32 v237, v90, v91, v237
    v_max3_f32 v236, v92, v93, v236
    v_max3_f32 v237, v94, v95, v237
    s_waitcnt lgkmcnt(4)
    v_mfma_f32_32x32x16_bf16 v[128:143], a[184:187], v[208:211], 0
    ds_read_b64 a[200:201], v232 offset:2048
    ds_read_b64 a[202:203], v232 offset:8256
    s_add_u32 m0, s59, 86336
    s_nop 0
    buffer_load_dwordx4 v235, s[4:7], s54 offen offset:2048 sc1 lds
    v_max3_f32 v236, v96, v97, v236
    v_max3_f32 v237, v98, v99, v237
    v_max3_f32 v236, v100, v101, v236
    v_max3_f32 v237, v102, v103, v237
    v_mfma_f32_32x32x16_bf16 v[128:143], a[188:191], v[212:215], v[128:143]
    ds_read_b64 a[204:205], v232 offset:14464
    ds_read_b64 a[206:207], v232 offset:20672
    s_add_u32 m0, s59, 88416
    s_nop 0
    s_nop 0
    buffer_load_dwordx4 v235, s[4:7], s54 offen offset:3072 sc1 lds
    v_max3_f32 v236, v104, v105, v236
    v_max3_f32 v237, v106, v107, v237
    v_max3_f32 v236, v108, v109, v236
    v_max3_f32 v237, v110, v111, v237
    s_waitcnt lgkmcnt(4)
    v_mfma_f32_32x32x16_bf16 v[144:159], a[192:195], v[208:211], 0
    s_add_u32 s54, s58, 233472
    s_add_u32 m0, s59, 94592
    s_nop 0
    buffer_load_dwordx4 v235, s[4:7], s54 offen offset:0 sc1 lds
    v_max3_f32 v236, v112, v113, v236
    v_max3_f32 v237, v114, v115, v237
    v_max3_f32 v236, v116, v117, v236
    v_max3_f32 v237, v118, v119, v237
    v_mfma_f32_32x32x16_bf16 v[144:159], a[196:199], v[212:215], v[144:159]
    s_add_u32 m0, s59, 96672
    s_nop 0
    s_nop 0
    buffer_load_dwordx4 v235, s[4:7], s54 offen offset:1024 sc1 lds
    v_max3_f32 v236, v120, v121, v236
    v_max3_f32 v237, v122, v123, v237
    v_max3_f32 v236, v124, v125, v236
    v_max3_f32 v237, v126, v127, v237
    s_waitcnt lgkmcnt(0)
    v_mfma_f32_32x32x16_bf16 v[160:175], a[200:203], v[208:211], v[176:191]
    s_add_u32 m0, s59, 98752
    s_nop 0
    buffer_load_dwordx4 v235, s[4:7], s54 offen offset:2048 sc1 lds
    v_max3_f32 v236, v128, v129, v236
    v_max3_f32 v237, v130, v131, v237
    v_max3_f32 v236, v132, v133, v236
    v_max3_f32 v237, v134, v135, v237
    v_mfma_f32_32x32x16_bf16 v[160:175], a[204:207], v[212:215], v[160:175]
    s_mov_b32 s63, 65536
    s_mov_b32 exec_lo, 0x7f7f0000
    s_mov_b32 exec_hi, 0
    buffer_load_dword v255, v254, s[4:7], s63 offen sc1
    s_mov_b64 exec, -1
    v_max3_f32 v236, v136, v137, v236
    v_max3_f32 v237, v138, v139, v237
    v_max3_f32 v236, v140, v141, v236
    v_max3_f32 v237, v142, v143, v237
    v_max3_f32 v236, v144, v145, v236
    v_max3_f32 v237, v146, v147, v237
    v_max3_f32 v236, v148, v149, v236
    v_max3_f32 v237, v150, v151, v237
    v_max3_f32 v236, v152, v153, v236
    v_max3_f32 v237, v154, v155, v237
    v_max3_f32 v236, v156, v157, v236
    v_max3_f32 v237, v158, v159, v237
    v_max3_f32 v236, v160, v161, v236
    v_max3_f32 v237, v162, v163, v237
    v_max3_f32 v236, v164, v165, v236
    v_max3_f32 v237, v166, v167, v237
    v_max3_f32 v236, v168, v169, v236
    v_max3_f32 v237, v170, v171, v237
    v_max3_f32 v236, v172, v173, v236
    v_max3_f32 v237, v174, v175, v237
    v_max_f32 v236, v236, v237
    v_mov_b32 v237, v236
    s_nop 1
    v_permlane32_swap_b32 v236, v237
    v_max_f32_e64 v236, v236, v237
    v_mov_b32 v237, 0x3e8b97f6
    v_mul_f32 v236, 0xbe8b97f6, v236
    v_pk_fma_f32 v[32:33], v[32:33], v[236:237], v[236:237] op_sel:[0,1,0] op_sel_hi:[1,1,0]
    v_pk_fma_f32 v[34:35], v[34:35], v[236:237], v[236:237] op_sel:[0,1,0] op_sel_hi:[1,1,0]
    v_pk_fma_f32 v[36:37], v[36:37], v[236:237], v[236:237] op_sel:[0,1,0] op_sel_hi:[1,1,0]
    v_pk_fma_f32 v[38:39], v[38:39], v[236:237], v[236:237] op_sel:[0,1,0] op_sel_hi:[1,1,0]
    v_pk_fma_f32 v[40:41], v[40:41], v[236:237], v[236:237] op_sel:[0,1,0] op_sel_hi:[1,1,0]
    v_pk_fma_f32 v[42:43], v[42:43], v[236:237], v[236:237] op_sel:[0,1,0] op_sel_hi:[1,1,0]
    v_pk_fma_f32 v[44:45], v[44:45], v[236:237], v[236:237] op_sel:[0,1,0] op_sel_hi:[1,1,0]
    v_pk_fma_f32 v[46:47], v[46:47], v[236:237], v[236:237] op_sel:[0,1,0] op_sel_hi:[1,1,0]
    v_exp_f32 v32, v32
    v_exp_f32 v33, v33
    v_exp_f32 v34, v34
    v_exp_f32 v35, v35
    v_exp_f32 v36, v36
    v_exp_f32 v37, v37
    v_exp_f32 v38, v38
    v_exp_f32 v39, v39
    v_exp_f32 v40, v40
    v_exp_f32 v41, v41
    v_exp_f32 v42, v42
    v_exp_f32 v43, v43
    v_exp_f32 v44, v44
    v_exp_f32 v45, v45
    v_exp_f32 v46, v46
    v_exp_f32 v47, v47
    v_cvt_pk_bf16_f32 v32, v32, v33
    v_cvt_pk_bf16_f32 v33, v34, v35
    v_cvt_pk_bf16_f32 v34, v36, v37
    v_cvt_pk_bf16_f32 v35, v38, v39
    v_cvt_pk_bf16_f32 v36, v40, v41
    v_cvt_pk_bf16_f32 v37, v42, v43
    v_cvt_pk_bf16_f32 v38, v44, v45
    v_cvt_pk_bf16_f32 v39, v46, v47
    v_pk_fma_f32 v[48:49], v[48:49], v[236:237], v[236:237] op_sel:[0,1,0] op_sel_hi:[1,1,0]
    v_pk_fma_f32 v[50:51], v[50:51], v[236:237], v[236:237] op_sel:[0,1,0] op_sel_hi:[1,1,0]
    v_pk_fma_f32 v[52:53], v[52:53], v[236:237], v[236:237] op_sel:[0,1,0] op_sel_hi:[1,1,0]
    v_pk_fma_f32 v[54:55], v[54:55], v[236:237], v[236:237] op_sel:[0,1,0] op_sel_hi:[1,1,0]
    v_pk_fma_f32 v[56:57], v[56:57], v[236:237], v[236:237] op_sel:[0,1,0] op_sel_hi:[1,1,0]
    v_pk_fma_f32 v[58:59], v[58:59], v[236:237], v[236:237] op_sel:[0,1,0] op_sel_hi:[1,1,0]
    v_pk_fma_f32 v[60:61], v[60:61], v[236:237], v[236:237] op_sel:[0,1,0] op_sel_hi:[1,1,0]
    v_pk_fma_f32 v[62:63], v[62:63], v[236:237], v[236:237] op_sel:[0,1,0] op_sel_hi:[1,1,0]
    v_accvgpr_read_b32 v248, a251
    v_add_u32 v249, 6144, v248
    v_add_u32 v250, 12288, v248
    v_add_u32 v251, 18432, v248
    s_add_u32 m0, s67, 0x00000000
    s_add_u32 s64, s69, 0
    buffer_load_dwordx4 v248, s[32:35], s64 offen offset:0 lds
    v_exp_f32_e64 v48, v48
    buffer_load_dwordx4 v249, s[32:35], s64 offen offset:1024 lds
    v_exp_f32 v49, v49
    v_exp_f32 v50, v50
    v_exp_f32 v51, v51
    v_exp_f32 v52, v52
    buffer_load_dwordx4 v250, s[32:35], s64 offen offset:2048 lds
    v_exp_f32 v53, v53
    v_exp_f32 v54, v54
    v_exp_f32 v55, v55
    v_exp_f32 v56, v56
    buffer_load_dwordx4 v251, s[32:35], s64 offen offset:3072 lds
    v_exp_f32 v57, v57
    v_exp_f32 v58, v58
    v_exp_f32 v59, v59
    v_exp_f32 v60, v60
    v_exp_f32 v61, v61
    v_exp_f32 v62, v62
    v_exp_f32_e64 v63, v63
    v_cvt_pk_bf16_f32 v48, v48, v49
    v_cvt_pk_bf16_f32 v49, v50, v51
    v_cvt_pk_bf16_f32 v50, v52, v53
    v_cvt_pk_bf16_f32 v51, v54, v55
    v_cvt_pk_bf16_f32 v52, v56, v57
    v_cvt_pk_bf16_f32 v53, v58, v59
    v_cvt_pk_bf16_f32 v54, v60, v61
    v_cvt_pk_bf16_f32 v55, v62, v63
    v_pk_fma_f32 v[64:65], v[64:65], v[236:237], v[236:237] op_sel:[0,1,0] op_sel_hi:[1,1,0]
    v_pk_fma_f32 v[66:67], v[66:67], v[236:237], v[236:237] op_sel:[0,1,0] op_sel_hi:[1,1,0]
    v_pk_fma_f32 v[68:69], v[68:69], v[236:237], v[236:237] op_sel:[0,1,0] op_sel_hi:[1,1,0]
    v_pk_fma_f32 v[70:71], v[70:71], v[236:237], v[236:237] op_sel:[0,1,0] op_sel_hi:[1,1,0]
    v_pk_fma_f32 v[72:73], v[72:73], v[236:237], v[236:237] op_sel:[0,1,0] op_sel_hi:[1,1,0]
    v_pk_fma_f32 v[74:75], v[74:75], v[236:237], v[236:237] op_sel:[0,1,0] op_sel_hi:[1,1,0]
    v_pk_fma_f32 v[76:77], v[76:77], v[236:237], v[236:237] op_sel:[0,1,0] op_sel_hi:[1,1,0]
    v_pk_fma_f32 v[78:79], v[78:79], v[236:237], v[236:237] op_sel:[0,1,0] op_sel_hi:[1,1,0]
    s_add_u32 m0, s67, 0x00001000
    s_add_u32 s64, s69, 28672
    buffer_load_dwordx4 v248, s[32:35], s64 offen offset:0 lds
    v_exp_f32 v64, v64
    v_exp_f32 v65, v65
    v_exp_f32_e64 v66, v66
    buffer_load_dwordx4 v249, s[32:35], s64 offen offset:1024 lds
    v_exp_f32 v67, v67
    v_exp_f32 v68, v68
    v_exp_f32 v69, v69
    v_exp_f32 v70, v70
    buffer_load_dwordx4 v250, s[32:35], s64 offen offset:2048 lds
    v_exp_f32 v71, v71
    v_exp_f32 v72, v72
    v_exp_f32 v73, v73
    v_exp_f32 v74, v74
    buffer_load_dwordx4 v251, s[32:35], s64 offen offset:3072 lds
    v_exp_f32 v75, v75
    v_exp_f32 v76, v76
    v_exp_f32 v77, v77
    v_exp_f32 v78, v78
    v_exp_f32_e64 v79, v79
    v_cvt_pk_bf16_f32 v64, v64, v65
    v_cvt_pk_bf16_f32 v65, v66, v67
    v_cvt_pk_bf16_f32 v66, v68, v69
    v_cvt_pk_bf16_f32 v67, v70, v71
    v_cvt_pk_bf16_f32 v68, v72, v73
    v_cvt_pk_bf16_f32 v69, v74, v75
    v_cvt_pk_bf16_f32 v70, v76, v77
    v_cvt_pk_bf16_f32 v71, v78, v79
    v_pk_fma_f32 v[80:81], v[80:81], v[236:237], v[236:237] op_sel:[0,1,0] op_sel_hi:[1,1,0]
    v_pk_fma_f32 v[82:83], v[82:83], v[236:237], v[236:237] op_sel:[0,1,0] op_sel_hi:[1,1,0]
    v_pk_fma_f32 v[84:85], v[84:85], v[236:237], v[236:237] op_sel:[0,1,0] op_sel_hi:[1,1,0]
    v_pk_fma_f32 v[86:87], v[86:87], v[236:237], v[236:237] op_sel:[0,1,0] op_sel_hi:[1,1,0]
    v_pk_fma_f32 v[88:89], v[88:89], v[236:237], v[236:237] op_sel:[0,1,0] op_sel_hi:[1,1,0]
    v_pk_fma_f32 v[90:91], v[90:91], v[236:237], v[236:237] op_sel:[0,1,0] op_sel_hi:[1,1,0]
    v_pk_fma_f32 v[92:93], v[92:93], v[236:237], v[236:237] op_sel:[0,1,0] op_sel_hi:[1,1,0]
    v_pk_fma_f32 v[94:95], v[94:95], v[236:237], v[236:237] op_sel:[0,1,0] op_sel_hi:[1,1,0]
    v_exp_f32 v80, v80
    v_exp_f32 v81, v81
    v_exp_f32 v82, v82
    v_exp_f32 v83, v83
    v_exp_f32 v84, v84
    v_exp_f32 v85, v85
    v_exp_f32 v86, v86
    v_exp_f32 v87, v87
    v_exp_f32 v88, v88
    v_exp_f32 v89, v89
    v_exp_f32 v90, v90
    v_exp_f32 v91, v91
    s_waitcnt vmcnt(9)
    s_barrier
    ds_read_b64_tr_b16 a[184:185], v233 offset:0
    ds_read_b64_tr_b16 a[186:187], v233 offset:64
    ds_read_b64_tr_b16 a[188:189], v233 offset:128
    ds_read_b64_tr_b16 a[190:191], v233 offset:192
    ds_read_b64_tr_b16 a[192:193], v233 offset:256
    ds_read_b64_tr_b16 a[194:195], v233 offset:320
    ds_read_b64_tr_b16 a[196:197], v233 offset:384
    ds_read_b64_tr_b16 a[198:199], v233 offset:448
    ds_read_b64_tr_b16 a[200:201], v233 offset:512
    ds_read_b64_tr_b16 a[202:203], v233 offset:576
    ds_read_b64_tr_b16 a[204:205], v233 offset:640
    ds_read_b64_tr_b16 a[206:207], v233 offset:704
    v_exp_f32 v92, v92
    v_exp_f32 v93, v93
    v_exp_f32 v94, v94
    v_exp_f32 v95, v95
    v_cvt_pk_bf16_f32 v80, v80, v81
    v_cvt_pk_bf16_f32 v81, v82, v83
    v_cvt_pk_bf16_f32 v82, v84, v85
    v_cvt_pk_bf16_f32 v83, v86, v87
    v_cvt_pk_bf16_f32 v84, v88, v89
    v_cvt_pk_bf16_f32 v85, v90, v91
    v_cvt_pk_bf16_f32 v86, v92, v93
    v_cvt_pk_bf16_f32 v87, v94, v95
    v_pk_fma_f32 v[96:97], v[96:97], v[236:237], v[236:237] op_sel:[0,1,0] op_sel_hi:[1,1,0]
    v_pk_fma_f32 v[98:99], v[98:99], v[236:237], v[236:237] op_sel:[0,1,0] op_sel_hi:[1,1,0]
    v_pk_fma_f32 v[100:101], v[100:101], v[236:237], v[236:237] op_sel:[0,1,0] op_sel_hi:[1,1,0]
    v_pk_fma_f32 v[102:103], v[102:103], v[236:237], v[236:237] op_sel:[0,1,0] op_sel_hi:[1,1,0]
    v_pk_fma_f32 v[104:105], v[104:105], v[236:237], v[236:237] op_sel:[0,1,0] op_sel_hi:[1,1,0]
    v_pk_fma_f32 v[106:107], v[106:107], v[236:237], v[236:237] op_sel:[0,1,0] op_sel_hi:[1,1,0]
    v_pk_fma_f32 v[108:109], v[108:109], v[236:237], v[236:237] op_sel:[0,1,0] op_sel_hi:[1,1,0]
    v_pk_fma_f32 v[110:111], v[110:111], v[236:237], v[236:237] op_sel:[0,1,0] op_sel_hi:[1,1,0]
    s_waitcnt lgkmcnt(0)
    v_mfma_f32_32x32x16_bf16 v[216:231], a[184:187], v[32:35], 0
    ds_read_b64_tr_b16 a[208:209], v233 offset:768
    ds_read_b64_tr_b16 a[210:211], v233 offset:832
    ds_read_b64_tr_b16 a[212:213], v233 offset:896
    ds_read_b64_tr_b16 a[214:215], v233 offset:960
    v_exp_f32 v96, v96
    v_exp_f32 v97, v97
    v_exp_f32 v98, v98
    v_mfma_f32_32x32x16_bf16 v[216:231], a[188:191], v[36:39], v[216:231]
    s_add_u32 m0, s67, 0x00002000
    s_add_u32 s64, s69, 57344
    buffer_load_dwordx4 v248, s[32:35], s64 offen offset:0 lds
    v_exp_f32 v99, v99
    v_exp_f32 v100, v100
    v_exp_f32 v101, v101
    s_branch L_skip4
.p2align 12
L_stub4:
    s_setpc_b64 s[56:57]
    s_nop 0
L_skip4:
    v_mfma_f32_32x32x16_bf16 v[216:231], a[192:195], v[48:51], v[216:231]
    ds_read_b64_tr_b16 a[216:217], v233 offset:1024
    ds_read_b64_tr_b16 a[218:219], v233 offset:1088
    ds_read_b64_tr_b16 a[220:221], v233 offset:1152
    ds_read_b64_tr_b16 a[222:223], v233 offset:1216
    v_exp_f32 v102, v102
    v_exp_f32 v103, v103
    v_exp_f32_e64 v104, v104
    v_mfma_f32_32x32x16_bf16 v[216:231], a[196:199], v[52:55], v[216:231]
    buffer_load_dwordx4 v249, s[32:35], s64 offen offset:1024 lds
    v_exp_f32 v105, v105
    v_exp_f32 v106, v106
    v_exp_f32_e64 v107, v107
    v_mfma_f32_32x32x16_bf16 v[216:231], a[200:203], v[64:67], v[216:231]
    ds_read_b64_tr_b16 a[224:225], v233 offset:1280
    ds_read_b64_tr_b16 a[226:227], v233 offset:1344
    ds_read_b64_tr_b16 a[228:229], v233 offset:1408
    ds_read_b64_tr_b16 a[230:231], v233 offset:1472
    v_exp_f32 v108, v108
    v_exp_f32 v109, v109
    v_exp_f32_e64 v110, v110
    v_mfma_f32_32x32x16_bf16 v[216:231], a[204:207], v[68:71], v[216:231]
    buffer_load_dwordx4 v250, s[32:35], s64 offen offset:2048 lds
    v_exp_f32_e64 v111, v111
    v_cvt_pk_bf16_f32 v96, v96, v97
    v_cvt_pk_bf16_f32 v97, v98, v99
    v_cvt_pk_bf16_f32 v98, v100, v101
    v_cvt_pk_bf16_f32 v99, v102, v103
    v_cvt_pk_bf16_f32 v100, v104, v105
    v_cvt_pk_bf16_f32 v101, v106, v107
    v_cvt_pk_bf16_f32 v102, v108, v109
    v_cvt_pk_bf16_f32 v103, v110, v111
    s_mov_b64 exec, 7
    buffer_load_dword v245, v240, s[4:7], 0 offen sc1
    s_mov_b64 exec, 0x1ffffff
    buffer_load_dword v246, v241, s[20:23], s57 offen
    buffer_load_dword v247, v241, s[24:27], s57 offen
    s_mov_b64 exec, -1
    v_pk_fma_f32 v[112:113], v[112:113], v[236:237], v[236:237] op_sel:[0,1,0] op_sel_hi:[1,1,0]
    v_pk_fma_f32 v[114:115], v[114:115], v[236:237], v[236:237] op_sel:[0,1,0] op_sel_hi:[1,1,0]
    v_pk_fma_f32 v[116:117], v[116:117], v[236:237], v[236:237] op_sel:[0,1,0] op_sel_hi:[1,1,0]
    v_pk_fma_f32 v[118:119], v[118:119], v[236:237], v[236:237] op_sel:[0,1,0] op_sel_hi:[1,1,0]
    v_pk_fma_f32 v[120:121], v[120:121], v[236:237], v[236:237] op_sel:[0,1,0] op_sel_hi:[1,1,0]
    v_pk_fma_f32 v[122:123], v[122:123], v[236:237], v[236:237] op_sel:[0,1,0] op_sel_hi:[1,1,0]
    v_pk_fma_f32 v[124:125], v[124:125], v[236:237], v[236:237] op_sel:[0,1,0] op_sel_hi:[1,1,0]
    v_pk_fma_f32 v[126:127], v[126:127], v[236:237], v[236:237] op_sel:[0,1,0] op_sel_hi:[1,1,0]
    s_waitcnt lgkmcnt(4)
    v_mfma_f32_32x32x16_bf16 v[216:231], a[208:211], v[80:83], v[216:231]
    ds_read_b64_tr_b16 a[184:185], v233 offset:1536
    ds_read_b64_tr_b16 a[186:187], v233 offset:1600
    ds_read_b64_tr_b16 a[188:189], v233 offset:1664
    ds_read_b64_tr_b16 a[190:191], v233 offset:1728
    v_exp_f32 v112, v112
    v_exp_f32 v113, v113
    v_exp_f32 v114, v114
    v_mfma_f32_32x32x16_bf16 v[216:231], a[212:215], v[84:87], v[216:231]
    buffer_load_dwordx4 v251, s[32:35], s64 offen offset:3072 lds
    v_exp_f32 v115, v115
    v_exp_f32 v116, v116
    v_exp_f32_e64 v117, v117
    v_mfma_f32_32x32x16_bf16 v[216:231], a[216:219], v[96:99], v[216:231]
    ds_read_b64_tr_b16 a[192:193], v233 offset:1792
    ds_read_b64_tr_b16 a[194:195], v233 offset:1856
    ds_read_b64_tr_b16 a[196:197], v233 offset:1920
    ds_read_b64_tr_b16 a[198:199], v233 offset:1984
    v_exp_f32 v118, v118
    v_exp_f32 v119, v119
    v_exp_f32_e64 v120, v120
    v_mfma_f32_32x32x16_bf16 v[216:231], a[220:223], v[100:103], v[216:231]
    v_exp_f32 v121, v121
    v_exp_f32 v122, v122
    v_exp_f32 v123, v123
    v_exp_f32 v124, v124
    v_exp_f32 v125, v125
    v_exp_f32 v126, v126
    v_exp_f32_e64 v127, v127
    v_cvt_pk_bf16_f32 v112, v112, v113
    v_cvt_pk_bf16_f32 v113, v114, v115
    v_cvt_pk_bf16_f32 v114, v116, v117
    v_cvt_pk_bf16_f32 v115, v118, v119
    v_cvt_pk_bf16_f32 v116, v120, v121
    v_cvt_pk_bf16_f32 v117, v122, v123
    v_cvt_pk_bf16_f32 v118, v124, v125
    v_cvt_pk_bf16_f32 v119, v126, v127
    v_pk_fma_f32 v[128:129], v[128:129], v[236:237], v[236:237] op_sel:[0,1,0] op_sel_hi:[1,1,0]
    v_pk_fma_f32 v[130:131], v[130:131], v[236:237], v[236:237] op_sel:[0,1,0] op_sel_hi:[1,1,0]
    v_pk_fma_f32 v[132:133], v[132:133], v[236:237], v[236:237] op_sel:[0,1,0] op_sel_hi:[1,1,0]
    v_pk_fma_f32 v[134:135], v[134:135], v[236:237], v[236:237] op_sel:[0,1,0] op_sel_hi:[1,1,0]
    v_pk_fma_f32 v[136:137], v[136:137], v[236:237], v[236:237] op_sel:[0,1,0] op_sel_hi:[1,1,0]
    v_pk_fma_f32 v[138:139], v[138:139], v[236:237], v[236:237] op_sel:[0,1,0] op_sel_hi:[1,1,0]
    v_pk_fma_f32 v[140:141], v[140:141], v[236:237], v[236:237] op_sel:[0,1,0] op_sel_hi:[1,1,0]
    v_pk_fma_f32 v[142:143], v[142:143], v[236:237], v[236:237] op_sel:[0,1,0] op_sel_hi:[1,1,0]
    s_waitcnt lgkmcnt(8)
    v_mfma_f32_32x32x16_bf16 v[216:231], a[224:227], v[112:115], v[216:231]
    ds_read_b64_tr_b16 a[200:201], v233 offset:2048
    ds_read_b64_tr_b16 a[202:203], v233 offset:2112
    ds_read_b64_tr_b16 a[204:205], v233 offset:2176
    ds_read_b64_tr_b16 a[206:207], v233 offset:2240
    v_exp_f32 v128, v128
    v_exp_f32 v129, v129
    v_exp_f32 v130, v130
    v_mfma_f32_32x32x16_bf16 v[216:231], a[228:231], v[116:119], v[216:231]
    v_exp_f32 v131, v131
    v_exp_f32 v132, v132
    v_exp_f32 v133, v133
    v_exp_f32 v134, v134
    v_exp_f32 v135, v135
    v_exp_f32 v136, v136
    v_exp_f32 v137, v137
    v_exp_f32 v138, v138
    v_exp_f32 v139, v139
    v_exp_f32 v140, v140
    v_exp_f32 v141, v141
    v_exp_f32 v142, v142
    v_exp_f32_e64 v143, v143
    v_cvt_pk_bf16_f32 v128, v128, v129
    v_cvt_pk_bf16_f32 v129, v130, v131
    v_cvt_pk_bf16_f32 v130, v132, v133
    v_cvt_pk_bf16_f32 v131, v134, v135
    v_cvt_pk_bf16_f32 v132, v136, v137
    v_cvt_pk_bf16_f32 v133, v138, v139
    v_cvt_pk_bf16_f32 v134, v140, v141
    v_cvt_pk_bf16_f32 v135, v142, v143
    v_pk_fma_f32 v[144:145], v[144:145], v[236:237], v[236:237] op_sel:[0,1,0] op_sel_hi:[1,1,0]
    v_pk_fma_f32 v[146:147], v[146:147], v[236:237], v[236:237] op_sel:[0,1,0] op_sel_hi:[1,1,0]
    v_pk_fma_f32 v[148:149], v[148:149], v[236:237], v[236:237] op_sel:[0,1,0] op_sel_hi:[1,1,0]
    v_pk_fma_f32 v[150:151], v[150:151], v[236:237], v[236:237] op_sel:[0,1,0] op_sel_hi:[1,1,0]
    v_pk_fma_f32 v[152:153], v[152:153], v[236:237], v[236:237] op_sel:[0,1,0] op_sel_hi:[1,1,0]
    v_pk_fma_f32 v[154:155], v[154:155], v[236:237], v[236:237] op_sel:[0,1,0] op_sel_hi:[1,1,0]
    v_pk_fma_f32 v[156:157], v[156:157], v[236:237], v[236:237] op_sel:[0,1,0] op_sel_hi:[1,1,0]
    v_pk_fma_f32 v[158:159], v[158:159], v[236:237], v[236:237] op_sel:[0,1,0] op_sel_hi:[1,1,0]
    s_waitcnt lgkmcnt(8)
    v_mfma_f32_32x32x16_bf16 v[216:231], a[184:187], v[128:131], v[216:231]
    v_exp_f32 v144, v144
    v_exp_f32 v145, v145
    v_exp_f32 v146, v146
    v_mfma_f32_32x32x16_bf16 v[216:231], a[188:191], v[132:135], v[216:231]
    v_exp_f32 v147, v147
    v_exp_f32 v148, v148
    v_exp_f32 v149, v149
    v_exp_f32 v150, v150
    v_exp_f32 v151, v151
    v_exp_f32 v152, v152
    v_exp_f32 v153, v153
    v_exp_f32 v154, v154
    v_exp_f32 v155, v155
    v_exp_f32 v156, v156
    v_exp_f32 v157, v157
    v_exp_f32 v158, v158
    v_exp_f32_e64 v159, v159
    v_cvt_pk_bf16_f32 v144, v144, v145
    v_cvt_pk_bf16_f32 v145, v146, v147
    v_cvt_pk_bf16_f32 v146, v148, v149
    v_cvt_pk_bf16_f32 v147, v150, v151
    v_cvt_pk_bf16_f32 v148, v152, v153
    v_cvt_pk_bf16_f32 v149, v154, v155
    v_cvt_pk_bf16_f32 v150, v156, v157
    v_cvt_pk_bf16_f32 v151, v158, v159
    v_pk_fma_f32 v[160:161], v[160:161], v[236:237], v[236:237] op_sel:[0,1,0] op_sel_hi:[1,1,0]
    v_pk_fma_f32 v[162:163], v[162:163], v[236:237], v[236:237] op_sel:[0,1,0] op_sel_hi:[1,1,0]
    v_pk_fma_f32 v[164:165], v[164:165], v[236:237], v[236:237] op_sel:[0,1,0] op_sel_hi:[1,1,0]
    v_pk_fma_f32 v[166:167], v[166:167], v[236:237], v[236:237] op_sel:[0,1,0] op_sel_hi:[1,1,0]
    v_pk_fma_f32 v[168:169], v[168:169], v[236:237], v[236:237] op_sel:[0,1,0] op_sel_hi:[1,1,0]
    v_pk_fma_f32 v[170:171], v[170:171], v[236:237], v[236:237] op_sel:[0,1,0] op_sel_hi:[1,1,0]
    v_pk_fma_f32 v[172:173], v[172:173], v[236:237], v[236:237] op_sel:[0,1,0] op_sel_hi:[1,1,0]
    v_pk_fma_f32 v[174:175], v[174:175], v[236:237], v[236:237] op_sel:[0,1,0] op_sel_hi:[1,1,0]
    s_waitcnt lgkmcnt(4)
    v_mfma_f32_32x32x16_bf16 v[216:231], a[192:195], v[144:147], v[216:231]
    v_exp_f32 v160, v160
    v_exp_f32 v161, v161
    v_exp_f32 v162, v162
    v_mfma_f32_32x32x16_bf16 v[216:231], a[196:199], v[148:151], v[216:231]
    v_exp_f32 v163, v163
    v_exp_f32 v164, v164
    v_exp_f32_e64 v165, v165
    s_mov_b32 s62, 100000
    s_mov_b32 s63, 65536
    s_mov_b32 exec_lo, 0x7f7f0000
    s_mov_b32 exec_hi, 0
    s_waitcnt vmcnt(15)
L_sp_22:
    v_xor_b32 v239, s45, v255
    v_cmp_lt_u32 vcc, 15, v239
    s_sub_u32 s62, s62, 1
    s_cbranch_vccz L_spok_23
L_spr_24:
    buffer_load_dword v255, v254, s[4:7], s63 offen sc1
    s_waitcnt vmcnt(0)
    s_cmp_gt_i32 s62, 0
    s_cbranch_scc1 L_sp_22
L_spok_23:
    s_mov_b64 exec, 0x7f7f0000
    v_cmp_ne_u32 vcc, s61, v239
    s_nop 0
    s_cmp_eq_u64 vcc, 0
    s_cselect_b32 s60, 1, 0
    s_mov_b64 exec, -1
    s_lshl_b32 s62, s40, 4
    v_add_lshl_u32 v254, s62, v1, 8
    s_sub_u32 s62, 256, s62
    s_min_u32 s62, s62, 48
    s_bfm_b64 s[58:59], s62, 0
    s_mov_b32 s63, 720896
    s_mov_b64 exec, s[58:59]
    buffer_load_dword v255, v254, s[4:7], s63 offen sc1
    s_mov_b64 exec, -1
    v_exp_f32 v166, v166
    v_exp_f32 v167, v167
    v_exp_f32 v168, v168
    v_exp_f32 v169, v169
    v_exp_f32 v170, v170
    v_exp_f32 v171, v171
    v_exp_f32 v172, v172
    v_exp_f32 v173, v173
    v_exp_f32 v174, v174
    v_exp_f32_e64 v175, v175
    v_cvt_pk_bf16_f32 v160, v160, v161
    v_cvt_pk_bf16_f32 v161, v162, v163
    v_cvt_pk_bf16_f32 v162, v164, v165
    v_cvt_pk_bf16_f32 v163, v166, v167
    v_cvt_pk_bf16_f32 v164, v168, v169
    v_cvt_pk_bf16_f32 v165, v170, v171
    v_cvt_pk_bf16_f32 v166, v172, v173
    v_cvt_pk_bf16_f32 v167, v174, v175
    s_waitcnt lgkmcnt(0)
    v_mfma_f32_32x32x16_bf16 v[216:231], a[200:203], v[160:163], v[216:231]
    v_mfma_f32_32x32x16_bf16 v[216:231], a[204:207], v[164:167], v[216:231]
    s_add_u32 s57, s55, 5120
    s_add_u32 s54, s56, 4096
    s_nop 9
    v_mov_b32 v236, v228
    v_mov_b32 v237, v228
    s_nop 1
    v_permlane32_swap_b32 v236, v237
    v_rcp_f32 v236, v237
    s_nop 0
    v_pk_mul_f32 v[216:217], v[216:217], v[236:237] op_sel_hi:[1,0]
    v_pk_mul_f32 v[218:219], v[218:219], v[236:237] op_sel_hi:[1,0]
    v_pk_mul_f32 v[220:221], v[220:221], v[236:237] op_sel_hi:[1,0]
    v_pk_mul_f32 v[222:223], v[222:223], v[236:237] op_sel_hi:[1,0]
    v_cvt_pk_bf16_f32 v32, v216, v217
    v_cvt_pk_bf16_f32 v33, v218, v219
    v_cvt_pk_bf16_f32 v34, v220, v221
    v_cvt_pk_bf16_f32 v35, v222, v223
    v_pk_mul_f32 v[224:225], v[224:225], v[236:237] op_sel_hi:[1,0]
    v_pk_mul_f32 v[226:227], v[226:227], v[236:237] op_sel_hi:[1,0]
    v_pk_mul_f32 v[228:229], v[228:229], v[236:237] op_sel_hi:[1,0]
    v_pk_mul_f32 v[230:231], v[230:231], v[236:237] op_sel_hi:[1,0]
    v_cvt_pk_bf16_f32 v36, v224, v225
    v_cvt_pk_bf16_f32 v37, v226, v227
    v_cvt_pk_bf16_f32 v38, v228, v229
    v_cvt_pk_bf16_f32 v39, v230, v231
    s_cmp_lg_u32 s60, 0
    s_cbranch_scc0 L_fs_25
    buffer_store_dwordx4 v[32:35], v238, s[4:7], s56 offen
    s_mov_b32 exec_hi, 0
    buffer_store_dwordx4 v[36:39], v238, s[4:7], s54 offen
    s_not_b64 exec, exec
    buffer_store_dwordx2 v[36:37], v234, s[4:7], s57 offen
    s_mov_b64 exec, -1
    s_branch L_fe_26
L_fs_25:
    buffer_store_dwordx4 v[32:35], v238, s[4:7], s56 offen sc1
    s_mov_b32 exec_hi, 0
    buffer_store_dwordx4 v[36:39], v238, s[4:7], s54 offen sc1
    s_not_b64 exec, exec
    buffer_store_dwordx2 v[36:37], v234, s[4:7], s57 offen sc1
    s_mov_b64 exec, -1
L_fe_26:
    s_cmp_ge_u32 s41, 14
    s_cbranch_scc1 L_ht
L_p3:
    s_waitcnt lgkmcnt(0)
    s_barrier
    s_nop 0
    v_accvgpr_read_b32 v248, a250
    v_add_u32 v249, 6144, v248
    v_add_u32 v250, 12288, v248
    v_add_u32 v251, 18432, v248
    s_add_u32 m0, s66, 0x0000e000
    s_add_u32 s64, s68, 0
    s_nop 0
    buffer_load_dwordx4 v248, s[20:23], s64 offen offset:0 lds
    s_mul_i32 s55, s40, 344064
    s_add_u32 s55, s55, 1048576
    v_accvgpr_read_b32 v4, a248
    v_and_b32 v5, 1024, v3
    buffer_load_dwordx4 v249, s[20:23], s64 offen offset:1024 lds
    v_add_u32 v4, v4, v5
    v_xor_b32 v5, 32, v4
    v_xor_b32_e64 v6, 64, v4
    v_xor_b32 v7, 96, v4
    v_add_u32 v244, 16, v1
    v_lshrrev_b32 v244, 6, v244
    v_mul_u32_u24 v244, 0x30000, v244
    v_add_u32 v240, v244, v4
    v_add_u32 v241, v244, v5
    v_add_u32_e64 v242, v244, v6
    buffer_load_dwordx4 v250, s[20:23], s64 offen offset:2048 lds
    v_add_u32_e64 v243, v244, v7
    s_mov_b32 s62, 100000
    s_mov_b64 exec, s[58:59]
    s_waitcnt vmcnt(6)
L_wp_27:
    v_cmp_ne_u32 vcc, s45, v255
    s_sub_u32 s62, s62, 1
    s_cbranch_vccz L_wpok_28
    buffer_load_dword v255, v254, s[4:7], s63 offen sc1
    s_waitcnt vmcnt(0)
    s_cmp_gt_i32 s62, 0
    s_cbranch_scc1 L_wp_27
L_wpok_28:
    s_mov_b64 exec, -1
    v_lshlrev_b32 v96, 16, v8
    v_and_b32 v97, 0xffff0000, v8
    v_lshlrev_b32_e64 v98, 16, v9
    v_and_b32 v99, 0xffff0000, v9
    v_lshlrev_b32_e64 v100, 16, v10
    v_and_b32 v101, 0xffff0000, v10
    v_lshlrev_b32_e64 v102, 16, v11
    v_and_b32 v103, 0xffff0000, v11
    buffer_load_dwordx4 v251, s[20:23], s64 offen offset:3072 lds
    v_lshlrev_b32_e64 v104, 16, v12
    v_and_b32 v105, 0xffff0000, v12
    v_lshlrev_b32_e64 v106, 16, v13
    v_and_b32 v107, 0xffff0000, v13
    v_lshlrev_b32_e64 v108, 16, v14
    v_and_b32 v109, 0xffff0000, v14
    v_lshlrev_b32_e64 v110, 16, v15
    v_and_b32 v111, 0xffff0000, v15
    ds_read_b64_tr_b16 v[112:113], v4 offset:0
    s_add_u32 m0, s66, 0x0000f000
    s_add_u32 s64, s68, 28672
    buffer_load_dwordx4 v248, s[20:23], s64 offen offset:0 lds
    ds_read_b64_tr_b16 v[114:115], v240 offset:1024
    s_lshl_b32 s51, s3, 8
    s_add_u32 s51, s51, 131072
    v_mov_b32 v254, s45
    v_lshlrev_b32 v255, 2, s44
    s_mov_b64 exec, 1
    s_waitcnt vmcnt(5)
    s_cmp_lg_u32 s60, 0
    s_cbranch_scc0 L_fs_29
    buffer_store_dword v254, v255, s[4:7], s51 offen
    s_branch L_fe_30
L_fs_29:
    buffer_store_dword v254, v255, s[4:7], s51 offen sc1
L_fe_30:
    s_mov_b64 exec, -1
    ds_read_b64_tr_b16 v[116:117], v5 offset:0
    ds_read_b64_tr_b16 v[118:119], v241 offset:1024
    ds_read_b64_tr_b16 v[120:121], v6 offset:0
    ds_read_b64_tr_b16 v[122:123], v242 offset:1024
    buffer_load_dwordx4 v249, s[20:23], s64 offen offset:1024 lds
    ds_read_b64_tr_b16 v[124:125], v7 offset:0
    ds_read_b64_tr_b16 v[126:127], v243 offset:1024
    ds_read_b64_tr_b16 v[128:129], v6 offset:3584
    ds_read_b64_tr_b16 v[130:131], v242 offset:4608
    ds_read_b64_tr_b16 v[132:133], v7 offset:3584
    ds_read_b64_tr_b16 v[134:135], v243 offset:4608
    buffer_load_dwordx4 v250, s[20:23], s64 offen offset:2048 lds
    ds_read_b64_tr_b16 v[136:137], v4 offset:3584
    ds_read_b64_tr_b16 v[138:139], v240 offset:4608
    ds_read_b64_tr_b16 v[140:141], v5 offset:3584
    ds_read_b64_tr_b16 v[142:143], v241 offset:4608
    ds_read_b64_tr_b16 v[144:145], v4 offset:7168
    ds_read_b64_tr_b16 v[146:147], v240 offset:8192
    buffer_load_dwordx4 v251, s[20:23], s64 offen offset:3072 lds
    ds_read_b64_tr_b16 v[148:149], v5 offset:7168
    ds_read_b64_tr_b16 v[150:151], v241 offset:8192
    ds_read_b64_tr_b16 v[152:153], v6 offset:7168
    ds_read_b64_tr_b16 v[154:155], v242 offset:8192
    ds_read_b64_tr_b16 v[156:157], v7 offset:7168
    ds_read_b64_tr_b16 v[158:159], v243 offset:8192
    ds_read_b64_tr_b16 v[160:161], v6 offset:10752
    ds_read_b64_tr_b16 v[162:163], v242 offset:11776
    ds_read_b64_tr_b16 v[164:165], v7 offset:10752
    ds_read_b64_tr_b16 v[166:167], v243 offset:11776
    ds_read_b64_tr_b16 v[168:169], v4 offset:10752
    ds_read_b64_tr_b16 v[170:171], v240 offset:11776
    ds_read_b64_tr_b16 v[172:173], v5 offset:10752
    ds_read_b64_tr_b16 v[174:175], v241 offset:11776
    ds_read_b64_tr_b16 v[176:177], v4 offset:14336
    ds_read_b64_tr_b16 v[178:179], v240 offset:15360
    ds_read_b64_tr_b16 v[180:181], v5 offset:14336
    ds_read_b64_tr_b16 v[182:183], v241 offset:15360
    ds_read_b64_tr_b16 v[184:185], v6 offset:14336
    ds_read_b64_tr_b16 v[186:187], v242 offset:15360
    ds_read_b64_tr_b16 v[188:189], v7 offset:14336
    ds_read_b64_tr_b16 v[190:191], v243 offset:15360
    ds_read_b64_tr_b16 v[192:193], v6 offset:17920
    ds_read_b64_tr_b16 v[194:195], v242 offset:18944
    ds_read_b64_tr_b16 v[196:197], v7 offset:17920
    ds_read_b64_tr_b16 v[198:199], v243 offset:18944
    ds_read_b64_tr_b16 v[200:201], v4 offset:17920
    ds_read_b64_tr_b16 v[202:203], v240 offset:18944
    ds_read_b64_tr_b16 v[204:205], v5 offset:17920
    ds_read_b64_tr_b16 v[206:207], v241 offset:18944
    ds_read_b64_tr_b16 v[208:209], v4 offset:21504
    ds_read_b64_tr_b16 v[210:211], v240 offset:22528
    ds_read_b64_tr_b16 v[212:213], v5 offset:21504
    ds_read_b64_tr_b16 v[214:215], v241 offset:22528
    ds_read_b64_tr_b16 v[216:217], v6 offset:21504
    ds_read_b64_tr_b16 v[218:219], v242 offset:22528
    ds_read_b64_tr_b16 v[220:221], v7 offset:21504
    ds_read_b64_tr_b16 v[222:223], v243 offset:22528
    s_lshl_b32 s62, s40, 12
    v_accvgpr_read_b32 v254, a254
    s_mov_b32 vcc_lo, -1
    s_mov_b32 vcc_hi, -1
    v_add_u32 v254, s62, v254
    s_mov_b32 s63, 131072
    s_mov_b64 exec, vcc
    buffer_load_dword v255, v254, s[4:7], s63 offen sc1
    s_mov_b64 exec, -1
    ds_read_b64_tr_b16 v[224:225], v6 offset:25088
    ds_read_b64_tr_b16 v[226:227], v242 offset:26112
    ds_read_b64_tr_b16 v[228:229], v7 offset:25088
    ds_read_b64_tr_b16 v[230:231], v243 offset:26112
    ds_read_b64_tr_b16 v[232:233], v4 offset:25088
    ds_read_b64_tr_b16 v[234:235], v240 offset:26112
    ds_read_b64_tr_b16 v[236:237], v5 offset:25088
    ds_read_b64_tr_b16 v[238:239], v241 offset:26112
    ds_read_b64_tr_b16 a[96:97], v4 offset:28672
    ds_read_b64_tr_b16 a[98:99], v240 offset:29696
    ds_read_b64_tr_b16 a[100:101], v5 offset:28672
    ds_read_b64_tr_b16 a[102:103], v241 offset:29696
    ds_read_b64_tr_b16 a[104:105], v6 offset:28672
    ds_read_b64_tr_b16 a[106:107], v242 offset:29696
    ds_read_b64_tr_b16 a[108:109], v7 offset:28672
    ds_read_b64_tr_b16 a[110:111], v243 offset:29696
    ds_read_b64_tr_b16 a[112:113], v6 offset:32256
    ds_read_b64_tr_b16 a[114:115], v242 offset:33280
    ds_read_b64_tr_b16 a[116:117], v7 offset:32256
    ds_read_b64_tr_b16 a[118:119], v243 offset:33280
    ds_read_b64_tr_b16 a[120:121], v4 offset:32256
    ds_read_b64_tr_b16 a[122:123], v240 offset:33280
    ds_read_b64_tr_b16 a[124:125], v5 offset:32256
    ds_read_b64_tr_b16 a[126:127], v241 offset:33280
    ds_read_b64_tr_b16 a[128:129], v4 offset:35840
    ds_read_b64_tr_b16 a[130:131], v240 offset:36864
    ds_read_b64_tr_b16 a[132:133], v5 offset:35840
    ds_read_b64_tr_b16 a[134:135], v241 offset:36864
    ds_read_b64_tr_b16 a[136:137], v6 offset:35840
    ds_read_b64_tr_b16 a[138:139], v242 offset:36864
    ds_read_b64_tr_b16 a[140:141], v7 offset:35840
    ds_read_b64_tr_b16 a[142:143], v243 offset:36864
    ds_read_b64_tr_b16 a[144:145], v6 offset:39424
    ds_read_b64_tr_b16 a[146:147], v242 offset:40448
    ds_read_b64_tr_b16 a[148:149], v7 offset:39424
    ds_read_b64_tr_b16 a[150:151], v243 offset:40448
    ds_read_b64_tr_b16 a[152:153], v4 offset:39424
    ds_read_b64_tr_b16 a[154:155], v240 offset:40448
    s_mov_b32 s62, 100000
    s_mov_b32 exec_lo, -1
    s_mov_b32 exec_hi, -1
    s_waitcnt vmcnt(0)
L_wp_31:
    v_cmp_ne_u32 vcc, s45, v255
    s_sub_u32 s62, s62, 1
    s_cbranch_vccz L_wpok_32
    buffer_load_dword v255, v254, s[4:7], s63 offen sc1
    s_waitcnt vmcnt(0)
    s_cmp_gt_i32 s62, 0
    s_cbranch_scc1 L_wp_31
L_wpok_32:
    s_mov_b64 exec, -1
    buffer_load_dwordx4 v[32:35], v0, s[4:7], s55 offen sc1
    ds_read_b64_tr_b16 a[156:157], v5 offset:39424
    ds_read_b64_tr_b16 a[158:159], v241 offset:40448
    ds_read_b64_tr_b16 a[160:161], v4 offset:43008
    ds_read_b64_tr_b16 a[162:163], v240 offset:44032
    ds_read_b64_tr_b16 a[164:165], v5 offset:43008
    ds_read_b64_tr_b16 a[166:167], v241 offset:44032
    s_add_u32 s55, s55, 7168
    buffer_load_dwordx4 v[36:39], v0, s[4:7], s55 offen sc1
    ds_read_b64_tr_b16 a[168:169], v6 offset:43008
    ds_read_b64_tr_b16 a[170:171], v242 offset:44032
    ds_read_b64_tr_b16 a[172:173], v7 offset:43008
    ds_read_b64_tr_b16 a[174:175], v243 offset:44032
    ds_read_b64_tr_b16 a[176:177], v6 offset:46592
    s_add_u32 s55, s55, 7168
    buffer_load_dwordx4 v[40:43], v0, s[4:7], s55 offen sc1
    ds_read_b64_tr_b16 a[178:179], v242 offset:47616
    ds_read_b64_tr_b16 a[180:181], v7 offset:46592
    ds_read_b64_tr_b16 a[182:183], v243 offset:47616
    ds_read_b64_tr_b16 a[184:185], v4 offset:46592
    ds_read_b64_tr_b16 a[186:187], v240 offset:47616
    s_add_u32 s55, s55, 7168
    buffer_load_dwordx4 v[44:47], v0, s[4:7], s55 offen sc1
    ds_read_b64_tr_b16 a[188:189], v5 offset:46592
    ds_read_b64_tr_b16 a[190:191], v241 offset:47616
    ds_read_b64_tr_b16 a[192:193], v4 offset:50176
    ds_read_b64_tr_b16 a[194:195], v240 offset:51200
    ds_read_b64_tr_b16 a[196:197], v5 offset:50176
    s_add_u32 s55, s55, 7168
    buffer_load_dwordx4 v[48:51], v0, s[4:7], s55 offen sc1
    ds_read_b64_tr_b16 a[198:199], v241 offset:51200
    ds_read_b64_tr_b16 a[200:201], v6 offset:50176
    ds_read_b64_tr_b16 a[202:203], v242 offset:51200
    ds_read_b64_tr_b16 a[204:205], v7 offset:50176
    ds_read_b64_tr_b16 a[206:207], v243 offset:51200
    s_add_u32 s55, s55, 7168
    buffer_load_dwordx4 v[52:55], v0, s[4:7], s55 offen sc1
    ds_read_b64_tr_b16 a[208:209], v6 offset:53760
    ds_read_b64_tr_b16 a[210:211], v242 offset:54784
    ds_read_b64_tr_b16 a[212:213], v7 offset:53760
    ds_read_b64_tr_b16 a[214:215], v243 offset:54784
    ds_read_b64_tr_b16 a[216:217], v4 offset:53760
    s_add_u32 s55, s55, 7168
    buffer_load_dwordx4 v[56:59], v0, s[4:7], s55 offen sc1
    ds_read_b64_tr_b16 a[218:219], v240 offset:54784
    ds_read_b64_tr_b16 a[220:221], v5 offset:53760
    ds_read_b64_tr_b16 a[222:223], v241 offset:54784
    s_waitcnt vmcnt(6) lgkmcnt(15)
    v_mfma_f32_16x16x32_bf16 v[96:99], v[112:115], v[32:35], v[96:99]
    s_add_u32 s55, s55, 7168
    buffer_load_dwordx4 v[60:63], v0, s[4:7], s55 offen sc1
    v_mfma_f32_16x16x32_bf16 v[100:103], v[116:119], v[32:35], v[100:103]
    s_add_u32 s55, s55, 7168
    v_mfma_f32_16x16x32_bf16 v[104:107], v[120:123], v[32:35], v[104:107]
    v_accvgpr_read_b32 v253, a255
    v_add_u32 v253, s67, v253
    v_mfma_f32_16x16x32_bf16 v[108:111], v[124:127], v[32:35], v[108:111]
    v_xor_b32 v252, 64, v253
    s_waitcnt vmcnt(6)
    v_mfma_f32_16x16x32_bf16 v[96:99], v[128:131], v[36:39], v[96:99]
    buffer_load_dwordx4 v[64:67], v0, s[4:7], s55 offen sc1
    v_mfma_f32_16x16x32_bf16 v[100:103], v[132:135], v[36:39], v[100:103]
    s_add_u32 s55, s55, 7168
    v_mfma_f32_16x16x32_bf16 v[104:107], v[136:139], v[36:39], v[104:107]
    ds_read_b64_tr_b16 a[0:1], v253 offset:0
    ds_read_b64_tr_b16 a[2:3], v253 offset:1024
    v_mfma_f32_16x16x32_bf16 v[108:111], v[140:143], v[36:39], v[108:111]
    ds_read_b64_tr_b16 a[4:5], v253 offset:32
    ds_read_b64_tr_b16 a[6:7], v253 offset:1056
    s_waitcnt vmcnt(6)
    v_mfma_f32_16x16x32_bf16 v[96:99], v[144:147], v[40:43], v[96:99]
    buffer_load_dwordx4 v[68:71], v0, s[4:7], s55 offen sc1
    v_mfma_f32_16x16x32_bf16 v[100:103], v[148:151], v[40:43], v[100:103]
    s_add_u32 s55, s55, 7168
    v_mfma_f32_16x16x32_bf16 v[104:107], v[152:155], v[40:43], v[104:107]
    ds_read_b64_tr_b16 a[8:9], v252 offset:0
    ds_read_b64_tr_b16 a[10:11], v252 offset:1024
    v_mfma_f32_16x16x32_bf16 v[108:111], v[156:159], v[40:43], v[108:111]
    ds_read_b64_tr_b16 a[12:13], v252 offset:32
    ds_read_b64_tr_b16 a[14:15], v252 offset:1056
    s_waitcnt vmcnt(6)
    v_mfma_f32_16x16x32_bf16 v[96:99], v[160:163], v[44:47], v[96:99]
    buffer_load_dwordx4 v[72:75], v0, s[4:7], s55 offen sc1
    v_mfma_f32_16x16x32_bf16 v[100:103], v[164:167], v[44:47], v[100:103]
    s_add_u32 s55, s55, 7168
    v_mfma_f32_16x16x32_bf16 v[104:107], v[168:171], v[44:47], v[104:107]
    ds_read_b64_tr_b16 a[16:17], v253 offset:4096
    ds_read_b64_tr_b16 a[18:19], v253 offset:5120
    v_mfma_f32_16x16x32_bf16 v[108:111], v[172:175], v[44:47], v[108:111]
    ds_read_b64_tr_b16 a[20:21], v253 offset:4128
    ds_read_b64_tr_b16 a[22:23], v253 offset:5152
    s_waitcnt vmcnt(6)
    v_mfma_f32_16x16x32_bf16 v[96:99], v[176:179], v[48:51], v[96:99]
    buffer_load_dwordx4 v[76:79], v0, s[4:7], s55 offen sc1
    v_mfma_f32_16x16x32_bf16 v[100:103], v[180:183], v[48:51], v[100:103]
    s_add_u32 s55, s55, 7168
    v_mfma_f32_16x16x32_bf16 v[104:107], v[184:187], v[48:51], v[104:107]
    ds_read_b64_tr_b16 a[24:25], v252 offset:4096
    ds_read_b64_tr_b16 a[26:27], v252 offset:5120
    v_mfma_f32_16x16x32_bf16 v[108:111], v[188:191], v[48:51], v[108:111]
    ds_read_b64_tr_b16 a[28:29], v252 offset:4128
    ds_read_b64_tr_b16 a[30:31], v252 offset:5152
    s_waitcnt vmcnt(6)
    v_mfma_f32_16x16x32_bf16 v[96:99], v[192:195], v[52:55], v[96:99]
    buffer_load_dwordx4 v[80:83], v0, s[4:7], s55 offen sc1
    v_mfma_f32_16x16x32_bf16 v[100:103], v[196:199], v[52:55], v[100:103]
    s_add_u32 s55, s55, 7168
    v_mfma_f32_16x16x32_bf16 v[104:107], v[200:203], v[52:55], v[104:107]
    ds_read_b64_tr_b16 a[32:33], v253 offset:8192
    ds_read_b64_tr_b16 a[34:35], v253 offset:9216
    v_mfma_f32_16x16x32_bf16 v[108:111], v[204:207], v[52:55], v[108:111]
    ds_read_b64_tr_b16 a[36:37], v253 offset:8224
    ds_read_b64_tr_b16 a[38:39], v253 offset:9248
    s_waitcnt vmcnt(6)
    v_mfma_f32_16x16x32_bf16 v[96:99], v[208:211], v[56:59], v[96:99]
    buffer_load_dwordx4 v[84:87], v0, s[4:7], s55 offen sc1
    v_mfma_f32_16x16x32_bf16 v[100:103], v[212:215], v[56:59], v[100:103]
    s_add_u32 s55, s55, 7168
    v_mfma_f32_16x16x32_bf16 v[104:107], v[216:219], v[56:59], v[104:107]
    ds_read_b64_tr_b16 a[40:41], v252 offset:8192
    ds_read_b64_tr_b16 a[42:43], v252 offset:9216
    v_mfma_f32_16x16x32_bf16 v[108:111], v[220:223], v[56:59], v[108:111]
    ds_read_b64_tr_b16 a[44:45], v252 offset:8224
    ds_read_b64_tr_b16 a[46:47], v252 offset:9248
    s_waitcnt vmcnt(6)
    v_mfma_f32_16x16x32_bf16 v[96:99], v[224:227], v[60:63], v[96:99]
    buffer_load_dwordx4 v[88:91], v0, s[4:7], s55 offen sc1
    v_mfma_f32_16x16x32_bf16 v[100:103], v[228:231], v[60:63], v[100:103]
    s_add_u32 s55, s55, 7168
    v_mfma_f32_16x16x32_bf16 v[104:107], v[232:235], v[60:63], v[104:107]
    v_mfma_f32_16x16x32_bf16 v[108:111], v[236:239], v[60:63], v[108:111]
    s_waitcnt vmcnt(6)
    v_mfma_f32_16x16x32_bf16 v[96:99], a[96:99], v[64:67], v[96:99]
    buffer_load_dwordx4 v[92:95], v0, s[4:7], s55 offen sc1
    v_mfma_f32_16x16x32_bf16 v[100:103], a[100:103], v[64:67], v[100:103]
    s_add_u32 m0, s66, 0x00010000
    s_branch L_skip5
.p2align 12
L_stub5:
    s_setpc_b64 s[56:57]
    s_nop 0
L_skip5:
    s_add_u32 s64, s68, 57344
    v_mfma_f32_16x16x32_bf16 v[104:107], a[104:107], v[64:67], v[104:107]
    v_mfma_f32_16x16x32_bf16 v[108:111], a[108:111], v[64:67], v[108:111]
    s_waitcnt vmcnt(6)
    v_mfma_f32_16x16x32_bf16 v[96:99], a[112:115], v[68:71], v[96:99]
    buffer_load_dwordx4 v248, s[20:23], s64 offen offset:0 lds
    v_mfma_f32_16x16x32_bf16 v[100:103], a[116:119], v[68:71], v[100:103]
    v_mfma_f32_16x16x32_bf16 v[104:107], a[120:123], v[68:71], v[104:107]
    v_mfma_f32_16x16x32_bf16 v[108:111], a[124:127], v[68:71], v[108:111]
    s_waitcnt vmcnt(6)
    v_mfma_f32_16x16x32_bf16 v[96:99], a[128:131], v[72:75], v[96:99]
    buffer_load_dwordx4 v249, s[20:23], s64 offen offset:1024 lds
    v_mfma_f32_16x16x32_bf16 v[100:103], a[132:135], v[72:75], v[100:103]
    v_mfma_f32_16x16x32_bf16 v[104:107], a[136:139], v[72:75], v[104:107]
    v_mfma_f32_16x16x32_bf16 v[108:111], a[140:143], v[72:75], v[108:111]
    s_waitcnt vmcnt(6)
    v_mfma_f32_16x16x32_bf16 v[96:99], a[144:147], v[76:79], v[96:99]
    buffer_load_dwordx4 v250, s[20:23], s64 offen offset:2048 lds
    v_mfma_f32_16x16x32_bf16 v[100:103], a[148:151], v[76:79], v[100:103]
    v_mfma_f32_16x16x32_bf16 v[104:107], a[152:155], v[76:79], v[104:107]
    v_mfma_f32_16x16x32_bf16 v[108:111], a[156:159], v[76:79], v[108:111]
    s_waitcnt vmcnt(6)
    v_mfma_f32_16x16x32_bf16 v[96:99], a[160:163], v[80:83], v[96:99]
    buffer_load_dwordx4 v251, s[20:23], s64 offen offset:3072 lds
    v_mfma_f32_16x16x32_bf16 v[100:103], a[164:167], v[80:83], v[100:103]
    s_add_u32 m0, s66, 0x00011000
    s_add_u32 s64, s68, 86016
    v_mfma_f32_16x16x32_bf16 v[104:107], a[168:171], v[80:83], v[104:107]
    v_mfma_f32_16x16x32_bf16 v[108:111], a[172:175], v[80:83], v[108:111]
    s_waitcnt vmcnt(6)
    v_mfma_f32_16x16x32_bf16 v[96:99], a[176:179], v[84:87], v[96:99]
    buffer_load_dwordx4 v248, s[20:23], s64 offen offset:0 lds
    v_mfma_f32_16x16x32_bf16 v[100:103], a[180:183], v[84:87], v[100:103]
    v_mfma_f32_16x16x32_bf16 v[104:107], a[184:187], v[84:87], v[104:107]
    v_mfma_f32_16x16x32_bf16 v[108:111], a[188:191], v[84:87], v[108:111]
    s_waitcnt vmcnt(6) lgkmcnt(15)
    v_mfma_f32_16x16x32_bf16 v[96:99], a[192:195], v[88:91], v[96:99]
    buffer_load_dwordx4 v249, s[20:23], s64 offen offset:1024 lds
    v_mfma_f32_16x16x32_bf16 v[100:103], a[196:199], v[88:91], v[100:103]
    v_mfma_f32_16x16x32_bf16 v[104:107], a[200:203], v[88:91], v[104:107]
    v_mfma_f32_16x16x32_bf16 v[108:111], a[204:207], v[88:91], v[108:111]
    s_waitcnt vmcnt(6)
    v_mfma_f32_16x16x32_bf16 v[96:99], a[208:211], v[92:95], v[96:99]
    v_mfma_f32_16x16x32_bf16 v[100:103], a[212:215], v[92:95], v[100:103]
    v_mfma_f32_16x16x32_bf16 v[104:107], a[216:219], v[92:95], v[104:107]
    v_mfma_f32_16x16x32_bf16 v[108:111], a[220:223], v[92:95], v[108:111]
    s_add_u32 s56, s71, 1163264
    s_add_u32 s57, s71, 1167360
    s_add_u32 s58, s72, 786432
    v_lshlrev_b32 v244, 3, v1
    s_nop 0
    s_nop 0
    v_cvt_pk_bf16_f32 v8, v96, v97
    v_cvt_pk_bf16_f32 v9, v98, v99
    v_cvt_pk_bf16_f32 v10, v100, v101
    v_cvt_pk_bf16_f32 v11, v102, v103
    v_cvt_pk_bf16_f32 v12, v104, v105
    v_cvt_pk_bf16_f32 v13, v106, v107
    v_cvt_pk_bf16_f32 v14, v108, v109
    v_cvt_pk_bf16_f32 v15, v110, v111
    s_cmp_lg_u32 s60, 0
    s_cbranch_scc0 L_fs_33
    buffer_store_dwordx4 v[8:11], v2, s[4:7], s56 offen
    buffer_store_dwordx4 v[12:15], v2, s[4:7], s57 offen
    s_branch L_fe_34
L_fs_33:
    s_nop 0
    buffer_store_dwordx4 v[8:11], v2, s[4:7], s56 offen sc1
    buffer_store_dwordx4 v[12:15], v2, s[4:7], s57 offen sc1
L_fe_34:
    v_pk_add_f32 v[240:241], v[96:97], v[98:99]
    v_pk_mul_f32 v[242:243], v[96:97], v[96:97]
    v_pk_fma_f32 v[242:243], v[98:99], v[98:99], v[242:243]
    v_pk_add_f32 v[240:241], v[240:241], v[100:101]
    v_pk_fma_f32 v[242:243], v[100:101], v[100:101], v[242:243]
    v_pk_add_f32 v[240:241], v[240:241], v[102:103]
    v_pk_fma_f32 v[242:243], v[102:103], v[102:103], v[242:243]
    v_pk_add_f32 v[240:241], v[240:241], v[104:105]
    v_pk_fma_f32 v[242:243], v[104:105], v[104:105], v[242:243]
    v_pk_add_f32 v[240:241], v[240:241], v[106:107]
    v_pk_fma_f32 v[242:243], v[106:107], v[106:107], v[242:243]
    v_pk_add_f32 v[240:241], v[240:241], v[108:109]
    v_pk_fma_f32 v[242:243], v[108:109], v[108:109], v[242:243]
    v_pk_add_f32 v[240:241], v[240:241], v[110:111]
    v_pk_fma_f32 v[242:243], v[110:111], v[110:111], v[242:243]
    v_add_f32 v240, v240, v241
    v_add_f32 v241, v242, v243
    v_mov_b32_e64 v242, v240
    v_mov_b32 v243, v241
    s_nop 0
    v_permlane16_swap_b32 v240, v242
    v_permlane16_swap_b32 v241, v243
    v_pk_add_f32 v[240:241], v[240:241], v[242:243]
    v_mov_b32_e64 v242, v240
    v_mov_b32 v243, v241
    s_nop 0
    v_permlane32_swap_b32 v240, v242
    v_permlane32_swap_b32 v241, v243
    v_pk_add_f32 v[240:241], v[240:241], v[242:243]
    s_mov_b64 exec, 0xffff
    s_cmp_lg_u32 s60, 0
    s_cbranch_scc0 L_fs_35
    buffer_store_dwordx2 v[240:241], v244, s[4:7], s58 offen
    s_branch L_fe_36
L_fs_35:
    buffer_store_dwordx2 v[240:241], v244, s[4:7], s58 offen sc1
L_fe_36:
    s_mov_b64 exec, -1
    s_waitcnt vmcnt(3)
    s_waitcnt lgkmcnt(0)
    s_barrier
    v_accvgpr_read_b32 v248, a250
    v_add_u32 v249, 6144, v248
    v_add_u32 v250, 12288, v248
    v_add_u32 v251, 18432, v248
    s_add_u32 m0, s66, 0x00000000
    s_add_u32 s64, s68, 0
    buffer_load_dwordx4 v248, s[24:27], s64 offen offset:0 lds
    v_lshrrev_b32 v244, 1, v2
    v_add_u32 v245, 2048, v244
    v_lshrrev_b32 v242, 4, v1
    v_add_u32 v242, 1, v242
    buffer_load_dwordx4 v249, s[24:27], s64 offen offset:1024 lds
    v_lshrrev_b32_e64 v242, 2, v242
    v_lshl_add_u32 v245, v242, 30, v245
    s_lshl_b32 s58, s42, 12
    s_add_u32 s58, s58, 786432
    s_add_u32 s55, s73, 1163264
    v_accvgpr_read_b32 v4, a248
    v_add_u32 v4, 57344, v4
    v_xor_b32 v5, 32, v4
    v_xor_b32_e64 v6, 64, v4
    v_xor_b32 v7, 96, v4
    buffer_load_dwordx4 v250, s[24:27], s64 offen offset:2048 lds
    v_mov_b32 v88, s48
    v_mov_b32 v89, s48
    v_mov_b32 v90, s48
    v_mov_b32 v91, s48
    ds_read_b64_tr_b16 v[112:113], v4 offset:0
    ds_read_b64_tr_b16 v[114:115], v4 offset:2048
    ds_read_b64_tr_b16 v[116:117], v5 offset:0
    buffer_load_dwordx4 v251, s[24:27], s64 offen offset:3072 lds
    ds_read_b64_tr_b16 v[118:119], v5 offset:2048
    ds_read_b64_tr_b16 v[120:121], v6 offset:0
    ds_read_b64_tr_b16 v[122:123], v6 offset:2048
    ds_read_b64_tr_b16 v[124:125], v7 offset:0
    ds_read_b64_tr_b16 v[126:127], v7 offset:2048
    ds_read_b64_tr_b16 v[128:129], v4 offset:4096
    s_add_u32 m0, s66, 0x00001000
    s_add_u32 s64, s68, 28672
    buffer_load_dwordx4 v248, s[24:27], s64 offen offset:0 lds
    ds_read_b64_tr_b16 v[130:131], v4 offset:6144
    s_lshl_b32 s51, s47, 8
    s_add_u32 s51, s51, 196608
    v_mov_b32 v254, s45
    v_lshlrev_b32 v255, 2, s44
    s_mov_b64 exec, 1
    s_waitcnt vmcnt(5)
    s_cmp_lg_u32 s60, 0
    s_cbranch_scc0 L_fs_37
    buffer_store_dword v254, v255, s[4:7], s51 offen
    s_branch L_fe_38
L_fs_37:
    buffer_store_dword v254, v255, s[4:7], s51 offen sc1
L_fe_38:
    s_mov_b64 exec, -1
    ds_read_b64_tr_b16 v[132:133], v5 offset:4096
    ds_read_b64_tr_b16 v[134:135], v5 offset:6144
    ds_read_b64_tr_b16 v[136:137], v6 offset:4096
    ds_read_b64_tr_b16 v[138:139], v6 offset:6144
    buffer_load_dwordx4 v249, s[24:27], s64 offen offset:1024 lds
    ds_read_b64_tr_b16 v[140:141], v7 offset:4096
    ds_read_b64_tr_b16 v[142:143], v7 offset:6144
    s_waitcnt lgkmcnt(8)
    v_mfma_f32_16x16x32_bf16 v[16:19], v[112:115], v[88:91], 0
    ds_read_b64_tr_b16 v[144:145], v4 offset:8192
    ds_read_b64_tr_b16 v[146:147], v4 offset:10240
    buffer_load_dwordx4 v250, s[24:27], s64 offen offset:2048 lds
    v_mfma_f32_16x16x32_bf16 v[20:23], v[116:119], v[88:91], 0
    ds_read_b64_tr_b16 v[148:149], v5 offset:8192
    ds_read_b64_tr_b16 v[150:151], v5 offset:10240
    v_mfma_f32_16x16x32_bf16 v[24:27], v[120:123], v[88:91], 0
    ds_read_b64_tr_b16 v[152:153], v6 offset:8192
    ds_read_b64_tr_b16 v[154:155], v6 offset:10240
    buffer_load_dwordx4 v251, s[24:27], s64 offen offset:3072 lds
    v_mfma_f32_16x16x32_bf16 v[28:31], v[124:127], v[88:91], 0
    ds_read_b64_tr_b16 v[156:157], v7 offset:8192
    ds_read_b64_tr_b16 v[158:159], v7 offset:10240
    s_waitcnt lgkmcnt(8)
    v_mfma_f32_16x16x32_bf16 v[16:19], v[128:131], v[88:91], v[16:19]
    ds_read_b64_tr_b16 v[160:161], v4 offset:12288
    ds_read_b64_tr_b16 v[162:163], v4 offset:14336
    s_add_u32 m0, s66, 0x00002000
    s_add_u32 s64, s68, 57344
    buffer_load_dwordx4 v248, s[24:27], s64 offen offset:0 lds
    v_mfma_f32_16x16x32_bf16 v[20:23], v[132:135], v[88:91], v[20:23]
    ds_read_b64_tr_b16 v[164:165], v5 offset:12288
    ds_read_b64_tr_b16 v[166:167], v5 offset:14336
    v_mfma_f32_16x16x32_bf16 v[24:27], v[136:139], v[88:91], v[24:27]
    ds_read_b64_tr_b16 v[168:169], v6 offset:12288
    buffer_load_dwordx4 v249, s[24:27], s64 offen offset:1024 lds
    ds_read_b64_tr_b16 v[170:171], v6 offset:14336
    v_mfma_f32_16x16x32_bf16 v[28:31], v[140:143], v[88:91], v[28:31]
    ds_read_b64_tr_b16 v[172:173], v7 offset:12288
    ds_read_b64_tr_b16 v[174:175], v7 offset:14336
    s_waitcnt lgkmcnt(8)
    v_mfma_f32_16x16x32_bf16 v[16:19], v[144:147], v[88:91], v[16:19]
    ds_read_b64_tr_b16 v[176:177], v4 offset:16384
    ds_read_b64_tr_b16 v[178:179], v4 offset:18432
    v_mfma_f32_16x16x32_bf16 v[20:23], v[148:151], v[88:91], v[20:23]
    ds_read_b64_tr_b16 v[180:181], v5 offset:16384
    ds_read_b64_tr_b16 v[182:183], v5 offset:18432
    v_mfma_f32_16x16x32_bf16 v[24:27], v[152:155], v[88:91], v[24:27]
    ds_read_b64_tr_b16 v[184:185], v6 offset:16384
    ds_read_b64_tr_b16 v[186:187], v6 offset:18432
    v_mfma_f32_16x16x32_bf16 v[28:31], v[156:159], v[88:91], v[28:31]
    ds_read_b64_tr_b16 v[188:189], v7 offset:16384
    ds_read_b64_tr_b16 v[190:191], v7 offset:18432
    s_waitcnt lgkmcnt(8)
    v_mfma_f32_16x16x32_bf16 v[16:19], v[160:163], v[88:91], v[16:19]
    ds_read_b64_tr_b16 v[192:193], v4 offset:20480
    ds_read_b64_tr_b16 v[194:195], v4 offset:22528
    v_mfma_f32_16x16x32_bf16 v[20:23], v[164:167], v[88:91], v[20:23]
    ds_read_b64_tr_b16 v[196:197], v5 offset:20480
    ds_read_b64_tr_b16 v[198:199], v5 offset:22528
    v_mfma_f32_16x16x32_bf16 v[24:27], v[168:171], v[88:91], v[24:27]
    s_lshl_b32 s62, s40, 12
    v_accvgpr_read_b32 v254, a254
    s_mov_b32 vcc_lo, 0x0fffffff
    s_mov_b32 vcc_hi, 0x0fffffff
    v_add_u32 v254, s62, v254
    s_mov_b32 s63, 196608
    s_mov_b64 exec, vcc
    buffer_load_dword v255, v254, s[4:7], s63 offen sc1
    s_mov_b64 exec, -1
    ds_read_b64_tr_b16 v[200:201], v6 offset:20480
    ds_read_b64_tr_b16 v[202:203], v6 offset:22528
    v_mfma_f32_16x16x32_bf16 v[28:31], v[172:175], v[88:91], v[28:31]
    ds_read_b64_tr_b16 v[204:205], v7 offset:20480
    ds_read_b64_tr_b16 v[206:207], v7 offset:22528
    s_waitcnt lgkmcnt(8)
    v_mfma_f32_16x16x32_bf16 v[16:19], v[176:179], v[88:91], v[16:19]
    ds_read_b64_tr_b16 v[208:209], v4 offset:24576
    ds_read_b64_tr_b16 v[210:211], v4 offset:26624
    v_mfma_f32_16x16x32_bf16 v[20:23], v[180:183], v[88:91], v[20:23]
    ds_read_b64_tr_b16 v[212:213], v5 offset:24576
    ds_read_b64_tr_b16 v[214:215], v5 offset:26624
    v_mfma_f32_16x16x32_bf16 v[24:27], v[184:187], v[88:91], v[24:27]
    ds_read_b64_tr_b16 v[216:217], v6 offset:24576
    ds_read_b64_tr_b16 v[218:219], v6 offset:26624
    v_mfma_f32_16x16x32_bf16 v[28:31], v[188:191], v[88:91], v[28:31]
    ds_read_b64_tr_b16 v[220:221], v7 offset:24576
    ds_read_b64_tr_b16 v[222:223], v7 offset:26624
    s_waitcnt lgkmcnt(8)
    v_mfma_f32_16x16x32_bf16 v[16:19], v[192:195], v[88:91], v[16:19]
    ds_read_b64_tr_b16 v[224:225], v4 offset:28672
    ds_read_b64_tr_b16 v[226:227], v4 offset:30720
    v_mfma_f32_16x16x32_bf16 v[20:23], v[196:199], v[88:91], v[20:23]
    ds_read_b64_tr_b16 v[228:229], v5 offset:28672
    ds_read_b64_tr_b16 v[230:231], v5 offset:30720
    v_mfma_f32_16x16x32_bf16 v[24:27], v[200:203], v[88:91], v[24:27]
    ds_read_b64_tr_b16 v[232:233], v6 offset:28672
    ds_read_b64_tr_b16 v[234:235], v6 offset:30720
    v_mfma_f32_16x16x32_bf16 v[28:31], v[204:207], v[88:91], v[28:31]
    ds_read_b64_tr_b16 v[236:237], v7 offset:28672
    ds_read_b64_tr_b16 v[238:239], v7 offset:30720
    s_waitcnt lgkmcnt(8)
    v_mfma_f32_16x16x32_bf16 v[16:19], v[208:211], v[88:91], v[16:19]
    ds_read_b64_tr_b16 a[144:145], v4 offset:32768
    ds_read_b64_tr_b16 a[146:147], v4 offset:34816
    v_mfma_f32_16x16x32_bf16 v[20:23], v[212:215], v[88:91], v[20:23]
    ds_read_b64_tr_b16 a[148:149], v5 offset:32768
    ds_read_b64_tr_b16 a[150:151], v5 offset:34816
    v_mfma_f32_16x16x32_bf16 v[24:27], v[216:219], v[88:91], v[24:27]
    ds_read_b64_tr_b16 a[152:153], v6 offset:32768
    ds_read_b64_tr_b16 a[154:155], v6 offset:34816
    v_mfma_f32_16x16x32_bf16 v[28:31], v[220:223], v[88:91], v[28:31]
    s_mov_b32 s62, 100000
    s_mov_b32 exec_lo, 0x0fffffff
    s_mov_b32 exec_hi, 0x0fffffff
    s_waitcnt vmcnt(0)
L_wp_39:
    v_cmp_ne_u32 vcc, s45, v255
    s_sub_u32 s62, s62, 1
    s_cbranch_vccz L_wpok_40
    buffer_load_dword v255, v254, s[4:7], s63 offen sc1
    s_waitcnt vmcnt(0)
    s_cmp_gt_i32 s62, 0
    s_cbranch_scc1 L_wp_39
L_wpok_40:
    s_mov_b64 exec, -1
    s_nop 0
    buffer_load_dwordx2 v[240:241], v244, s[4:7], s58 offen sc1
    buffer_load_dwordx2 v[242:243], v245, s[4:7], s58 offen sc1
    buffer_load_dwordx4 v[32:35], v2, s[4:7], s55 offen sc1
    ds_read_b64_tr_b16 a[156:157], v7 offset:32768
    ds_read_b64_tr_b16 a[158:159], v7 offset:34816
    s_waitcnt lgkmcnt(8)
    v_mfma_f32_16x16x32_bf16 v[16:19], v[224:227], v[88:91], v[16:19]
    ds_read_b64_tr_b16 a[160:161], v4 offset:36864
    ds_read_b64_tr_b16 a[162:163], v4 offset:38912
    s_add_u32 s55, s55, 4096
    buffer_load_dwordx4 v[36:39], v2, s[4:7], s55 offen sc1
    v_mfma_f32_16x16x32_bf16 v[20:23], v[228:231], v[88:91], v[20:23]
    ds_read_b64_tr_b16 a[164:165], v5 offset:36864
    ds_read_b64_tr_b16 a[166:167], v5 offset:38912
    v_mfma_f32_16x16x32_bf16 v[24:27], v[232:235], v[88:91], v[24:27]
    ds_read_b64_tr_b16 a[168:169], v6 offset:36864
    ds_read_b64_tr_b16 a[170:171], v6 offset:38912
    s_add_u32 s55, s55, 4096
    buffer_load_dwordx4 v[40:43], v2, s[4:7], s55 offen sc1
    v_mfma_f32_16x16x32_bf16 v[28:31], v[236:239], v[88:91], v[28:31]
    ds_read_b64_tr_b16 a[172:173], v7 offset:36864
    ds_read_b64_tr_b16 a[174:175], v7 offset:38912
    s_waitcnt lgkmcnt(8)
    v_mfma_f32_16x16x32_bf16 v[16:19], a[144:147], v[88:91], v[16:19]
    ds_read_b64_tr_b16 a[176:177], v4 offset:40960
    s_add_u32 s55, s55, 4096
    buffer_load_dwordx4 v[44:47], v2, s[4:7], s55 offen sc1
    ds_read_b64_tr_b16 a[178:179], v4 offset:43008
    v_mfma_f32_16x16x32_bf16 v[20:23], a[148:151], v[88:91], v[20:23]
    ds_read_b64_tr_b16 a[180:181], v5 offset:40960
    ds_read_b64_tr_b16 a[182:183], v5 offset:43008
    v_mfma_f32_16x16x32_bf16 v[24:27], a[152:155], v[88:91], v[24:27]
    ds_read_b64_tr_b16 a[184:185], v6 offset:40960
    s_add_u32 s55, s55, 4096
    buffer_load_dwordx4 v[48:51], v2, s[4:7], s55 offen sc1
    ds_read_b64_tr_b16 a[186:187], v6 offset:43008
    v_mfma_f32_16x16x32_bf16 v[28:31], a[156:159], v[88:91], v[28:31]
    ds_read_b64_tr_b16 a[188:189], v7 offset:40960
    ds_read_b64_tr_b16 a[190:191], v7 offset:43008
    s_waitcnt lgkmcnt(8)
    v_mfma_f32_16x16x32_bf16 v[16:19], a[160:163], v[88:91], v[16:19]
    s_add_u32 s55, s55, 4096
    buffer_load_dwordx4 v[52:55], v2, s[4:7], s55 offen sc1
    ds_read_b64_tr_b16 a[192:193], v4 offset:45056
    ds_read_b64_tr_b16 a[194:195], v4 offset:47104
    v_mfma_f32_16x16x32_bf16 v[20:23], a[164:167], v[88:91], v[20:23]
    ds_read_b64_tr_b16 a[196:197], v5 offset:45056
    ds_read_b64_tr_b16 a[198:199], v5 offset:47104
    s_add_u32 s55, s55, 4096
    buffer_load_dwordx4 v[56:59], v2, s[4:7], s55 offen sc1
    v_mfma_f32_16x16x32_bf16 v[24:27], a[168:171], v[88:91], v[24:27]
    ds_read_b64_tr_b16 a[200:201], v6 offset:45056
    ds_read_b64_tr_b16 a[202:203], v6 offset:47104
    v_mfma_f32_16x16x32_bf16 v[28:31], a[172:175], v[88:91], v[28:31]
    ds_read_b64_tr_b16 a[204:205], v7 offset:45056
    ds_read_b64_tr_b16 a[206:207], v7 offset:47104
    s_add_u32 s55, s55, 4096
    buffer_load_dwordx4 v[60:63], v2, s[4:7], s55 offen sc1
    s_waitcnt lgkmcnt(8)
    v_mfma_f32_16x16x32_bf16 v[16:19], a[176:179], v[88:91], v[16:19]
    ds_read_b64_tr_b16 a[208:209], v4 offset:49152
    ds_read_b64_tr_b16 a[210:211], v4 offset:51200
    v_mfma_f32_16x16x32_bf16 v[20:23], a[180:183], v[88:91], v[20:23]
    ds_read_b64_tr_b16 a[212:213], v5 offset:49152
    s_add_u32 s55, s55, 4096
    buffer_load_dwordx4 v[64:67], v2, s[4:7], s55 offen sc1
    ds_read_b64_tr_b16 a[214:215], v5 offset:51200
    v_mfma_f32_16x16x32_bf16 v[24:27], a[184:187], v[88:91], v[24:27]
    ds_read_b64_tr_b16 a[216:217], v6 offset:49152
    ds_read_b64_tr_b16 a[218:219], v6 offset:51200
    v_mfma_f32_16x16x32_bf16 v[28:31], a[188:191], v[88:91], v[28:31]
    ds_read_b64_tr_b16 a[220:221], v7 offset:49152
    s_add_u32 s55, s55, 4096
    buffer_load_dwordx4 v[68:71], v2, s[4:7], s55 offen sc1
    ds_read_b64_tr_b16 a[222:223], v7 offset:51200
    s_waitcnt lgkmcnt(8)
    v_mfma_f32_16x16x32_bf16 v[16:19], a[192:195], v[88:91], v[16:19]
    ds_read_b64_tr_b16 a[224:225], v4 offset:53248
    ds_read_b64_tr_b16 a[226:227], v4 offset:55296
    v_mfma_f32_16x16x32_bf16 v[20:23], a[196:199], v[88:91], v[20:23]
    s_add_u32 s55, s55, 4096
    buffer_load_dwordx4 v[72:75], v2, s[4:7], s55 offen sc1
    ds_read_b64_tr_b16 a[228:229], v5 offset:53248
    ds_read_b64_tr_b16 a[230:231], v5 offset:55296
    v_mfma_f32_16x16x32_bf16 v[24:27], a[200:203], v[88:91], v[24:27]
    ds_read_b64_tr_b16 a[232:233], v6 offset:53248
    ds_read_b64_tr_b16 a[234:235], v6 offset:55296
    s_add_u32 s55, s55, 4096
    buffer_load_dwordx4 v[76:79], v2, s[4:7], s55 offen sc1
    v_mfma_f32_16x16x32_bf16 v[28:31], a[204:207], v[88:91], v[28:31]
    ds_read_b64_tr_b16 a[236:237], v7 offset:53248
    ds_read_b64_tr_b16 a[238:239], v7 offset:55296
    s_waitcnt lgkmcnt(8)
    v_mfma_f32_16x16x32_bf16 v[16:19], a[208:211], v[88:91], v[16:19]
    v_mfma_f32_16x16x32_bf16 v[20:23], a[212:215], v[88:91], v[20:23]
    s_add_u32 s55, s55, 4096
    buffer_load_dwordx4 v[80:83], v2, s[4:7], s55 offen sc1
    v_mfma_f32_16x16x32_bf16 v[24:27], a[216:219], v[88:91], v[24:27]
    v_mfma_f32_16x16x32_bf16 v[28:31], a[220:223], v[88:91], v[28:31]
    s_waitcnt lgkmcnt(0)
    v_mfma_f32_16x16x32_bf16 v[16:19], a[224:227], v[88:91], v[16:19]
    v_mfma_f32_16x16x32_bf16 v[20:23], a[228:231], v[88:91], v[20:23]
    v_mfma_f32_16x16x32_bf16 v[24:27], a[232:235], v[88:91], v[24:27]
    v_mfma_f32_16x16x32_bf16 v[28:31], a[236:239], v[88:91], v[28:31]
    s_waitcnt vmcnt(12)
    v_mfma_f32_16x16x32_bf16 v[96:99], v[112:115], v[32:35], 0
    s_add_u32 s55, s55, 4096
    buffer_load_dwordx4 v[84:87], v2, s[4:7], s55 offen sc1
    v_mfma_f32_16x16x32_bf16 v[100:103], v[116:119], v[32:35], 0
    v_add_f32 v240, v240, v242
    v_add_f32 v241, v241, v243
    v_mfma_f32_16x16x32_bf16 v[104:107], v[120:123], v[32:35], 0
    v_mov_b32 v242, v240
    v_mov_b32 v243, v241
    v_mfma_f32_16x16x32_bf16 v[108:111], v[124:127], v[32:35], 0
    v_permlane16_swap_b32 v240, v242
    v_permlane16_swap_b32 v241, v243
    s_waitcnt vmcnt(12)
    v_mfma_f32_16x16x32_bf16 v[96:99], v[128:131], v[36:39], v[96:99]
    buffer_load_dwordx4 v250, s[24:27], s64 offen offset:2048 lds
    v_mfma_f32_16x16x32_bf16 v[100:103], v[132:135], v[36:39], v[100:103]
    v_add_f32 v240, v240, v242
    v_add_f32_e64 v241, v241, v243
    v_mfma_f32_16x16x32_bf16 v[104:107], v[136:139], v[36:39], v[104:107]
    v_mov_b32 v242, v240
    v_mov_b32 v243, v241
    v_mfma_f32_16x16x32_bf16 v[108:111], v[140:143], v[36:39], v[108:111]
    v_permlane32_swap_b32 v240, v242
    v_permlane32_swap_b32 v241, v243
    s_waitcnt vmcnt(12)
    v_mfma_f32_16x16x32_bf16 v[96:99], v[144:147], v[40:43], v[96:99]
    buffer_load_dwordx4 v251, s[24:27], s64 offen offset:3072 lds
    v_mfma_f32_16x16x32_bf16 v[100:103], v[148:151], v[40:43], v[100:103]
    s_add_u32 m0, s66, 0x00003000
    s_add_u32 s64, s68, 86016
    v_mfma_f32_16x16x32_bf16 v[104:107], v[152:155], v[40:43], v[104:107]
    v_add_f32 v240, v240, v242
    v_add_f32_e64 v241, v241, v243
    v_mfma_f32_16x16x32_bf16 v[108:111], v[156:159], v[40:43], v[108:111]
    v_mul_f32 v240, 0xbb124925, v240
    v_mul_f32 v242, 0x3b124925, v241
    s_waitcnt vmcnt(12)
    v_mfma_f32_16x16x32_bf16 v[96:99], v[160:163], v[44:47], v[96:99]
    buffer_load_dwordx4 v248, s[24:27], s64 offen offset:0 lds
    v_mfma_f32_16x16x32_bf16 v[100:103], v[164:167], v[44:47], v[100:103]
    v_fma_f32 v242, -v240, v240, v242
    v_max_f32 v242, 0, v242
    v_mfma_f32_16x16x32_bf16 v[104:107], v[168:171], v[44:47], v[104:107]
    v_add_f32 v243, 0x3727c5ac, v242
    v_rsq_f32_e64 v241, v243
    v_mfma_f32_16x16x32_bf16 v[108:111], v[172:175], v[44:47], v[108:111]
    v_mul_f32_e64 v243, v241, v241
    v_mov_b32 v247, 0x3727c5ac
    s_waitcnt vmcnt(12)
    v_mfma_f32_16x16x32_bf16 v[96:99], v[176:179], v[48:51], v[96:99]
    buffer_load_dwordx4 v249, s[24:27], s64 offen offset:1024 lds
    v_mfma_f32_16x16x32_bf16 v[100:103], v[180:183], v[48:51], v[100:103]
    v_fmac_f32 v247, v243, v242
    v_rsq_f32_e64 v247, v247
    v_mfma_f32_16x16x32_bf16 v[104:107], v[184:187], v[48:51], v[104:107]
    v_mul_f32_e64 v247, v247, v241
    v_mul_f32 v244, 0xc0135761, v247
    v_mfma_f32_16x16x32_bf16 v[108:111], v[188:191], v[48:51], v[108:111]
    v_mul_f32_e64 v245, v247, v247
    v_mul_f32 v245, v245, v247
    s_waitcnt vmcnt(12)
    v_mfma_f32_16x16x32_bf16 v[96:99], v[192:195], v[52:55], v[96:99]
    v_accvgpr_read_b32 v248, a251
    v_add_u32 v249, 6144, v248
    v_add_u32 v250, 12288, v248
    v_add_u32 v251, 18432, v248
    s_add_u32 m0, s67, 0x00000000
    s_add_u32 s64, s69, 86016
    buffer_load_dwordx4 v248, s[32:35], s64 offen offset:0 lds
    v_mfma_f32_16x16x32_bf16 v[100:103], v[196:199], v[52:55], v[100:103]
    v_mul_f32 v245, 0xbdd2d3e8, v245
    v_rcp_f32 v246, v247
    v_mfma_f32_16x16x32_bf16 v[104:107], v[200:203], v[52:55], v[104:107]
    s_mul_i32 s56, s40, 344064
    s_lshl_b32 s57, s43, 13
    v_mfma_f32_16x16x32_bf16 v[108:111], v[204:207], v[52:55], v[108:111]
    s_add_u32 s56, s56, s57
    s_add_u32 s56, s56, 1048576
    s_waitcnt vmcnt(12)
    v_mfma_f32_16x16x32_bf16 v[96:99], v[208:211], v[56:59], v[96:99]
    buffer_load_dwordx4 v249, s[32:35], s64 offen offset:1024 lds
    v_mfma_f32_16x16x32_bf16 v[100:103], v[212:215], v[56:59], v[100:103]
    s_add_u32 s57, s56, 4096
    s_mul_i32 s49, s46, 3
    v_mfma_f32_16x16x32_bf16 v[104:107], v[216:219], v[56:59], v[104:107]
    buffer_load_dwordx4 v250, s[32:35], s64 offen offset:2048 lds
    v_mfma_f32_16x16x32_bf16 v[108:111], v[220:223], v[56:59], v[108:111]
    s_lshl_b32 s58, s42, 3
    s_add_u32 s58, s58, s47
    s_waitcnt vmcnt(13)
    v_mfma_f32_16x16x32_bf16 v[96:99], v[224:227], v[60:63], v[96:99]
    buffer_load_dwordx4 v251, s[32:35], s64 offen offset:3072 lds
    v_mfma_f32_16x16x32_bf16 v[100:103], v[228:231], v[60:63], v[100:103]
    s_add_u32 m0, s67, 0x00001000
    s_add_u32 s64, s69, 114688
    v_mfma_f32_16x16x32_bf16 v[104:107], v[232:235], v[60:63], v[104:107]
    buffer_load_dwordx4 v248, s[32:35], s64 offen offset:0 lds
    v_mfma_f32_16x16x32_bf16 v[108:111], v[236:239], v[60:63], v[108:111]
    s_lshl_b32 s58, s58, 8
    s_add_u32 s58, s58, 11534336
    s_waitcnt vmcnt(14)
    v_mfma_f32_16x16x32_bf16 v[96:99], a[144:147], v[64:67], v[96:99]
    buffer_load_dwordx4 v249, s[32:35], s64 offen offset:1024 lds
    v_mfma_f32_16x16x32_bf16 v[100:103], a[148:151], v[64:67], v[100:103]
    s_cmp_eq_u32 s44, s49
    s_cselect_b32 s58, s58, 1073741824
    s_mov_b32 s59, 0xC000C000
    s_cmp_eq_u32 s46, 0
    s_cselect_b32 s59, 0x00030003, s59
    v_mfma_f32_16x16x32_bf16 v[104:107], a[152:155], v[64:67], v[104:107]
    buffer_load_dwordx4 v250, s[32:35], s64 offen offset:2048 lds
    v_mfma_f32_16x16x32_bf16 v[108:111], a[156:159], v[64:67], v[108:111]
    v_accvgpr_read_b32 v88, a243
    v_mov_b32 v117, s45
    s_waitcnt vmcnt(15)
    v_mfma_f32_16x16x32_bf16 v[96:99], a[160:163], v[68:71], v[96:99]
    buffer_load_dwordx4 v251, s[32:35], s64 offen offset:3072 lds
    v_mfma_f32_16x16x32_bf16 v[100:103], a[164:167], v[68:71], v[100:103]
    s_add_u32 m0, s67, 0x00002000
    s_add_u32 s64, s69, 143360
    v_mfma_f32_16x16x32_bf16 v[104:107], a[168:171], v[68:71], v[104:107]
    v_mov_b32 v119, s45
    v_mov_b32 v121, s45
    v_mfma_f32_16x16x32_bf16 v[108:111], a[172:175], v[68:71], v[108:111]
    v_mov_b32_e64 v123, s45
    v_mov_b32 v125, s45
    s_waitcnt vmcnt(15)
    v_mfma_f32_16x16x32_bf16 v[96:99], a[176:179], v[72:75], v[96:99]
    buffer_load_dwordx4 v248, s[32:35], s64 offen offset:0 lds
    v_mfma_f32_16x16x32_bf16 v[100:103], a[180:183], v[72:75], v[100:103]
    v_mov_b32 v127, s45
    v_mov_b32 v129, s45
    v_mfma_f32_16x16x32_bf16 v[104:107], a[184:187], v[72:75], v[104:107]
    v_mov_b32_e64 v131, s45
    v_accvgpr_read_b32 v92, a244
    v_mfma_f32_16x16x32_bf16 v[108:111], a[188:191], v[72:75], v[108:111]
    v_accvgpr_read_b32 v93, a245
    v_accvgpr_read_b32 v94, a246
    s_waitcnt vmcnt(15)
    v_mfma_f32_16x16x32_bf16 v[96:99], a[192:195], v[76:79], v[96:99]
    buffer_load_dwordx4 v249, s[32:35], s64 offen offset:1024 lds
    v_mfma_f32_16x16x32_bf16 v[100:103], a[196:199], v[76:79], v[100:103]
    v_accvgpr_read_b32 v95, a247
    v_mfma_f32_16x16x32_bf16 v[104:107], a[200:203], v[76:79], v[104:107]
    v_mfma_f32_16x16x32_bf16 v[108:111], a[204:207], v[76:79], v[108:111]
    s_waitcnt vmcnt(15)
    v_mfma_f32_16x16x32_bf16 v[96:99], a[208:211], v[80:83], v[96:99]
    buffer_load_dwordx4 v250, s[32:35], s64 offen offset:2048 lds
    v_mfma_f32_16x16x32_bf16 v[100:103], a[212:215], v[80:83], v[100:103]
    v_mfma_f32_16x16x32_bf16 v[104:107], a[216:219], v[80:83], v[104:107]
    v_mfma_f32_16x16x32_bf16 v[108:111], a[220:223], v[80:83], v[108:111]
    s_waitcnt vmcnt(15)
    v_mfma_f32_16x16x32_bf16 v[96:99], a[224:227], v[84:87], v[96:99]
    buffer_load_dwordx4 v251, s[32:35], s64 offen offset:3072 lds
    v_mfma_f32_16x16x32_bf16 v[100:103], a[228:231], v[84:87], v[100:103]
    v_mfma_f32_16x16x32_bf16 v[104:107], a[232:235], v[84:87], v[104:107]
    v_mfma_f32_16x16x32_bf16 v[108:111], a[236:239], v[84:87], v[108:111]
    s_nop 3
    v_pk_fma_f32 v[96:97], v[16:17], v[240:241], v[96:97] op_sel_hi:[1,0,1]
    v_pk_fma_f32 v[98:99], v[18:19], v[240:241], v[98:99] op_sel_hi:[1,0,1]
    v_pk_fma_f32 v[100:101], v[20:21], v[240:241], v[100:101] op_sel_hi:[1,0,1]
    v_pk_fma_f32 v[102:103], v[22:23], v[240:241], v[102:103] op_sel_hi:[1,0,1]
    v_pk_mul_f32 v[48:49], v[96:97], v[96:97]
    v_pk_mul_f32 v[50:51], v[98:99], v[98:99]
    v_pk_mul_f32 v[52:53], v[100:101], v[100:101]
    v_pk_mul_f32 v[54:55], v[102:103], v[102:103]
    v_pk_fma_f32 v[48:49], v[48:49], v[244:245], v[244:245] op_sel:[0,1,0] op_sel_hi:[1,1,0]
    v_pk_fma_f32 v[50:51], v[50:51], v[244:245], v[244:245] op_sel:[0,1,0] op_sel_hi:[1,1,0]
    v_pk_fma_f32 v[52:53], v[52:53], v[244:245], v[244:245] op_sel:[0,1,0] op_sel_hi:[1,1,0]
    v_pk_fma_f32 v[54:55], v[54:55], v[244:245], v[244:245] op_sel:[0,1,0] op_sel_hi:[1,1,0]
    v_pk_mul_f32 v[48:49], v[48:49], v[96:97]
    v_pk_mul_f32 v[50:51], v[50:51], v[98:99]
    v_pk_mul_f32 v[52:53], v[52:53], v[100:101]
    v_pk_mul_f32 v[54:55], v[54:55], v[102:103]
    v_exp_f32 v48, v48
    v_exp_f32 v49, v49
    v_exp_f32 v50, v50
    v_exp_f32 v51, v51
    v_exp_f32 v52, v52
    v_exp_f32 v53, v53
    v_exp_f32 v54, v54
    v_exp_f32 v55, v55
    v_pk_fma_f32 v[48:49], v[48:49], v[246:247], v[246:247] op_sel_hi:[1,0,0]
    v_pk_fma_f32 v[50:51], v[50:51], v[246:247], v[246:247] op_sel_hi:[1,0,0]
    v_pk_fma_f32 v[52:53], v[52:53], v[246:247], v[246:247] op_sel_hi:[1,0,0]
    v_pk_fma_f32 v[54:55], v[54:55], v[246:247], v[246:247] op_sel_hi:[1,0,0]
    v_rcp_f32 v48, v48
    s_branch L_skip6
.p2align 12
L_stub6:
    s_setpc_b64 s[56:57]
    s_nop 0
L_skip6:
    v_rcp_f32 v49, v49
    v_rcp_f32 v50, v50
    v_rcp_f32 v51, v51
    v_rcp_f32 v52, v52
    v_rcp_f32 v53, v53
    v_rcp_f32 v54, v54
    v_rcp_f32_e64 v55, v55
    v_pk_mul_f32 v[96:97], v[96:97], v[48:49]
    v_pk_mul_f32 v[98:99], v[98:99], v[50:51]
    v_pk_mul_f32 v[100:101], v[100:101], v[52:53]
    v_pk_mul_f32 v[102:103], v[102:103], v[54:55]
    v_cvt_pk_bf16_f32 v32, v96, v97
    v_cvt_pk_bf16_f32 v33, v98, v99
    v_cvt_pk_bf16_f32 v34, v100, v101
    v_cvt_pk_bf16_f32 v35, v102, v103
    s_cmp_eq_u32 s43, 5
    s_cbranch_scc1 L_mix_41
    s_cmp_lg_u32 s60, 0
    s_cbranch_scc0 L_fs_43
    buffer_store_dwordx4 v[32:35], v92, s[4:7], s56 offen
    s_branch L_fe_44
L_fs_43:
    buffer_store_dwordx4 v[32:35], v92, s[4:7], s56 offen sc1
L_fe_44:
    s_branch L_mixe_42
L_mix_41:
    s_cmp_lg_u32 s60, 0
    s_cbranch_scc0 L_fs_45
    buffer_store_dwordx2 v[32:33], v92, s[4:7], s56 offen
    buffer_store_dwordx2 v[34:35], v93, s[4:7], s56 offen offset:2048
    s_branch L_fe_46
L_fs_45:
    s_nop 0
    buffer_store_dwordx2 v[32:33], v92, s[4:7], s56 offen sc1
    buffer_store_dwordx2 v[34:35], v93, s[4:7], s56 offen offset:2048 sc1
L_fe_46:
L_mixe_42:
    v_pk_fma_f32 v[104:105], v[24:25], v[240:241], v[104:105] op_sel_hi:[1,0,1]
    v_pk_fma_f32 v[106:107], v[26:27], v[240:241], v[106:107] op_sel_hi:[1,0,1]
    v_pk_fma_f32 v[108:109], v[28:29], v[240:241], v[108:109] op_sel_hi:[1,0,1]
    v_pk_fma_f32 v[110:111], v[30:31], v[240:241], v[110:111] op_sel_hi:[1,0,1]
    v_pk_mul_f32 v[48:49], v[104:105], v[104:105]
    v_pk_mul_f32 v[50:51], v[106:107], v[106:107]
    v_pk_mul_f32 v[52:53], v[108:109], v[108:109]
    v_pk_mul_f32 v[54:55], v[110:111], v[110:111]
    v_pk_fma_f32 v[48:49], v[48:49], v[244:245], v[244:245] op_sel:[0,1,0] op_sel_hi:[1,1,0]
    v_pk_fma_f32 v[50:51], v[50:51], v[244:245], v[244:245] op_sel:[0,1,0] op_sel_hi:[1,1,0]
    v_pk_fma_f32 v[52:53], v[52:53], v[244:245], v[244:245] op_sel:[0,1,0] op_sel_hi:[1,1,0]
    v_pk_fma_f32 v[54:55], v[54:55], v[244:245], v[244:245] op_sel:[0,1,0] op_sel_hi:[1,1,0]
    v_pk_mul_f32 v[48:49], v[48:49], v[104:105]
    v_pk_mul_f32 v[50:51], v[50:51], v[106:107]
    v_pk_mul_f32 v[52:53], v[52:53], v[108:109]
    v_pk_mul_f32 v[54:55], v[54:55], v[110:111]
    v_exp_f32 v48, v48
    v_exp_f32 v49, v49
    v_exp_f32 v50, v50
    v_exp_f32 v51, v51
    v_exp_f32 v52, v52
    v_exp_f32 v53, v53
    v_exp_f32 v54, v54
    v_exp_f32 v55, v55
    v_pk_fma_f32 v[48:49], v[48:49], v[246:247], v[246:247] op_sel_hi:[1,0,0]
    v_pk_fma_f32 v[50:51], v[50:51], v[246:247], v[246:247] op_sel_hi:[1,0,0]
    v_pk_fma_f32 v[52:53], v[52:53], v[246:247], v[246:247] op_sel_hi:[1,0,0]
    v_pk_fma_f32 v[54:55], v[54:55], v[246:247], v[246:247] op_sel_hi:[1,0,0]
    v_rcp_f32 v48, v48
    v_rcp_f32 v49, v49
    v_rcp_f32 v50, v50
    v_rcp_f32 v51, v51
    v_rcp_f32 v52, v52
    v_rcp_f32 v53, v53
    v_rcp_f32 v54, v54
    v_rcp_f32 v55, v55
    v_pk_mul_f32 v[104:105], v[104:105], v[48:49]
    v_pk_mul_f32 v[106:107], v[106:107], v[50:51]
    v_pk_mul_f32 v[108:109], v[108:109], v[52:53]
    v_pk_mul_f32 v[110:111], v[110:111], v[54:55]
    v_cvt_pk_bf16_f32 v36, v104, v105
    v_cvt_pk_bf16_f32 v37, v106, v107
    v_cvt_pk_bf16_f32 v38, v108, v109
    v_cvt_pk_bf16_f32 v39, v110, v111
    s_cmp_eq_u32 s43, 1
    s_cbranch_scc1 L_mix_47
    s_cmp_lg_u32 s60, 0
    s_cbranch_scc0 L_fs_49
    buffer_store_dwordx4 v[36:39], v94, s[4:7], s57 offen
    s_branch L_fe_50
L_fs_49:
    buffer_store_dwordx4 v[36:39], v94, s[4:7], s57 offen sc1
L_fe_50:
    s_branch L_mixe_48
L_mix_47:
    s_cmp_lg_u32 s60, 0
    s_cbranch_scc0 L_fs_51
    buffer_store_dwordx2 v[36:37], v94, s[4:7], s57 offen
    buffer_store_dwordx2 v[38:39], v95, s[4:7], s57 offen offset:2048
    s_branch L_fe_52
L_fs_51:
    buffer_store_dwordx2 v[36:37], v94, s[4:7], s57 offen sc1
    buffer_store_dwordx2 v[38:39], v95, s[4:7], s57 offen offset:2048 sc1
L_fe_52:
L_mixe_48:
    s_waitcnt vmcnt(14)
    s_waitcnt lgkmcnt(0)
    s_barrier
    v_mov_b32 v116, v32
    v_mov_b32 v118, v33
    v_mov_b32 v120, v34
    v_mov_b32 v122, v35
    v_mov_b32 v124, v36
    v_mov_b32 v126, v37
    v_mov_b32 v128, v38
    v_mov_b32 v130, v39
    s_mov_b32 exec_lo, s59
    s_mov_b32 exec_hi, s59
    buffer_store_dwordx4 v[116:119], v88, s[4:7], s58 offen offset:0 sc1
    buffer_store_dwordx4 v[120:123], v88, s[4:7], s58 offen offset:2048 sc1
    buffer_store_dwordx4 v[124:127], v88, s[4:7], s58 offen offset:128 sc1
    buffer_store_dwordx4 v[128:131], v88, s[4:7], s58 offen offset:2176 sc1
    s_mov_b64 exec, -1
    s_lshl_b32 s54, s46, 14
    s_xor_b32 s52, s54, 16384
    s_add_u32 s55, s73, 1048576
    s_add_u32 s56, s55, s52
    s_add_u32 s57, s55, s54
    s_sub_u32 s53, s54, s52
    v_lshrrev_b32 v96, 1, v2
    v_accvgpr_read_b32 v4, a248
    v_add_u32 v4, s52, v4
    v_xor_b32 v5, 32, v4
    v_xor_b32_e64 v6, 64, v4
    v_xor_b32 v7, 96, v4
    ds_read_b64_tr_b16 v[112:113], v4 offset:0
    ds_read_b64_tr_b16 v[114:115], v4 offset:2048
    v_accvgpr_read_b32 v248, a252
    v_add_u32 v249, 27648, v248
    v_add_u32 v250, 55296, v248
    v_add_u32 v251, 82944, v248
    s_add_u32 m0, s66, 0x0000e000
    s_add_u32 s64, s70, 0
    s_nop 0
    buffer_load_dwordx4 v248, s[28:31], s64 offen offset:0 lds
    ds_read_b64_tr_b16 v[116:117], v5 offset:0
    ds_read_b64_tr_b16 v[118:119], v5 offset:2048
    buffer_load_dwordx4 v249, s[28:31], s64 offen offset:1024 lds
    ds_read_b64_tr_b16 v[120:121], v6 offset:0
    ds_read_b64_tr_b16 v[122:123], v6 offset:2048
    ds_read_b64_tr_b16 v[124:125], v7 offset:0
    ds_read_b64_tr_b16 v[126:127], v7 offset:2048
    ds_read_b64_tr_b16 v[128:129], v4 offset:4096
    ds_read_b64_tr_b16 v[130:131], v4 offset:6144
    buffer_load_dwordx4 v250, s[28:31], s64 offen offset:2048 lds
    ds_read_b64_tr_b16 v[132:133], v5 offset:4096
    ds_read_b64_tr_b16 v[134:135], v5 offset:6144
    ds_read_b64_tr_b16 v[136:137], v6 offset:4096
    ds_read_b64_tr_b16 v[138:139], v6 offset:6144
    ds_read_b64_tr_b16 v[140:141], v7 offset:4096
    ds_read_b64_tr_b16 v[142:143], v7 offset:6144
    buffer_load_dwordx4 v251, s[28:31], s64 offen offset:3072 lds
    ds_read_b64_tr_b16 v[144:145], v4 offset:8192
    s_lshl_b32 s51, s47, 8
    s_add_u32 s51, s51, 262144
    v_mov_b32 v254, s45
    v_lshlrev_b32 v255, 2, s44
    s_mov_b64 exec, 1
    s_waitcnt vmcnt(8)
    s_cmp_lg_u32 s60, 0
    s_cbranch_scc0 L_fs_53
    buffer_store_dword v254, v255, s[4:7], s51 offen
    s_branch L_fe_54
L_fs_53:
    buffer_store_dword v254, v255, s[4:7], s51 offen sc1
L_fe_54:
    s_mov_b64 exec, -1
    ds_read_b64_tr_b16 v[146:147], v4 offset:10240
    ds_read_b64_tr_b16 v[148:149], v5 offset:8192
    ds_read_b64_tr_b16 v[150:151], v5 offset:10240
    ds_read_b64_tr_b16 v[152:153], v6 offset:8192
    ds_read_b64_tr_b16 v[154:155], v6 offset:10240
    ds_read_b64_tr_b16 v[156:157], v7 offset:8192
    ds_read_b64_tr_b16 v[158:159], v7 offset:10240
    ds_read_b64_tr_b16 v[160:161], v4 offset:28672
    ds_read_b64_tr_b16 v[162:163], v4 offset:30720
    ds_read_b64_tr_b16 v[164:165], v5 offset:28672
    ds_read_b64_tr_b16 v[166:167], v5 offset:30720
    ds_read_b64_tr_b16 v[168:169], v6 offset:28672
    ds_read_b64_tr_b16 v[170:171], v6 offset:30720
    ds_read_b64_tr_b16 v[172:173], v7 offset:28672
    ds_read_b64_tr_b16 v[174:175], v7 offset:30720
    ds_read_b64_tr_b16 v[176:177], v4 offset:32768
    ds_read_b64_tr_b16 v[178:179], v4 offset:34816
    ds_read_b64_tr_b16 v[180:181], v5 offset:32768
    ds_read_b64_tr_b16 v[182:183], v5 offset:34816
    ds_read_b64_tr_b16 v[184:185], v6 offset:32768
    ds_read_b64_tr_b16 v[186:187], v6 offset:34816
    ds_read_b64_tr_b16 v[188:189], v7 offset:32768
    ds_read_b64_tr_b16 v[190:191], v7 offset:34816
    ds_read_b64_tr_b16 v[192:193], v4 offset:36864
    ds_read_b64_tr_b16 v[194:195], v4 offset:38912
    ds_read_b64_tr_b16 v[196:197], v5 offset:36864
    ds_read_b64_tr_b16 v[198:199], v5 offset:38912
    ds_read_b64_tr_b16 v[200:201], v6 offset:36864
    ds_read_b64_tr_b16 v[202:203], v6 offset:38912
    ds_read_b64_tr_b16 v[204:205], v7 offset:36864
    ds_read_b64_tr_b16 v[206:207], v7 offset:38912
    v_lshlrev_b32_e64 v16, 16, v8
    v_and_b32 v17, 0xffff0000, v8
    v_lshlrev_b32_e64 v18, 16, v9
    v_and_b32 v19, 0xffff0000, v9
    v_lshlrev_b32_e64 v20, 16, v10
    v_and_b32 v21, 0xffff0000, v10
    v_lshlrev_b32_e64 v22, 16, v11
    v_and_b32 v23, 0xffff0000, v11
    v_lshlrev_b32_e64 v24, 16, v12
    v_and_b32 v25, 0xffff0000, v12
    v_lshlrev_b32_e64 v26, 16, v13
    v_and_b32 v27, 0xffff0000, v13
    v_lshlrev_b32_e64 v28, 16, v14
    v_and_b32 v29, 0xffff0000, v14
    v_lshlrev_b32_e64 v30, 16, v15
    v_and_b32 v31, 0xffff0000, v15
    v_pk_add_f32 v[16:17], v[16:17], v[240:241] op_sel_hi:[1,0]
    v_pk_mul_f32 v[16:17], v[16:17], v[240:241] op_sel:[0,1] op_sel_hi:[1,1]
    v_pk_add_f32 v[18:19], v[18:19], v[240:241] op_sel_hi:[1,0]
    v_pk_mul_f32 v[18:19], v[18:19], v[240:241] op_sel:[0,1] op_sel_hi:[1,1]
    v_pk_add_f32 v[20:21], v[20:21], v[240:241] op_sel_hi:[1,0]
    v_pk_mul_f32 v[20:21], v[20:21], v[240:241] op_sel:[0,1] op_sel_hi:[1,1]
    v_pk_add_f32 v[22:23], v[22:23], v[240:241] op_sel_hi:[1,0]
    v_pk_mul_f32 v[22:23], v[22:23], v[240:241] op_sel:[0,1] op_sel_hi:[1,1]
    v_pk_add_f32 v[24:25], v[24:25], v[240:241] op_sel_hi:[1,0]
    v_pk_mul_f32 v[24:25], v[24:25], v[240:241] op_sel:[0,1] op_sel_hi:[1,1]
    v_pk_add_f32 v[26:27], v[26:27], v[240:241] op_sel_hi:[1,0]
    v_pk_mul_f32 v[26:27], v[26:27], v[240:241] op_sel:[0,1] op_sel_hi:[1,1]
    v_pk_add_f32 v[28:29], v[28:29], v[240:241] op_sel_hi:[1,0]
    v_pk_mul_f32 v[28:29], v[28:29], v[240:241] op_sel:[0,1] op_sel_hi:[1,1]
    v_pk_add_f32 v[30:31], v[30:31], v[240:241] op_sel_hi:[1,0]
    v_pk_mul_f32 v[30:31], v[30:31], v[240:241] op_sel:[0,1] op_sel_hi:[1,1]
    v_add_u32 v4, s53, v4
    v_add_u32 v5, s53, v5
    v_add_u32 v6, s53, v6
    v_add_u32 v7, s53, v7
    ds_read_b64_tr_b16 v[208:209], v4 offset:0
    ds_read_b64_tr_b16 v[210:211], v4 offset:2048
    ds_read_b64_tr_b16 v[212:213], v5 offset:0
    ds_read_b64_tr_b16 v[214:215], v5 offset:2048
    ds_read_b64_tr_b16 v[216:217], v6 offset:0
    ds_read_b64_tr_b16 v[218:219], v6 offset:2048
    ds_read_b64_tr_b16 v[220:221], v7 offset:0
    ds_read_b64_tr_b16 v[222:223], v7 offset:2048
    ds_read_b64_tr_b16 v[224:225], v4 offset:4096
    ds_read_b64_tr_b16 v[226:227], v4 offset:6144
    ds_read_b64_tr_b16 v[228:229], v5 offset:4096
    s_lshl_b32 s62, s40, 12
    v_accvgpr_read_b32 v254, a254
    s_mov_b32 vcc_lo, 0x0fffffff
    s_mov_b32 vcc_hi, 0x0fffffff
    v_add_u32 v254, s62, v254
    s_mov_b32 s63, 262144
    s_mov_b64 exec, vcc
    buffer_load_dword v255, v254, s[4:7], s63 offen sc1
    s_mov_b64 exec, -1
    ds_read_b64_tr_b16 v[230:231], v5 offset:6144
    ds_read_b64_tr_b16 v[232:233], v6 offset:4096
    ds_read_b64_tr_b16 v[234:235], v6 offset:6144
    ds_read_b64_tr_b16 v[236:237], v7 offset:4096
    ds_read_b64_tr_b16 v[238:239], v7 offset:6144
    ds_read_b64_tr_b16 a[144:145], v4 offset:8192
    ds_read_b64_tr_b16 a[146:147], v4 offset:10240
    ds_read_b64_tr_b16 a[148:149], v5 offset:8192
    ds_read_b64_tr_b16 a[150:151], v5 offset:10240
    ds_read_b64_tr_b16 a[152:153], v6 offset:8192
    ds_read_b64_tr_b16 a[154:155], v6 offset:10240
    ds_read_b64_tr_b16 a[156:157], v7 offset:8192
    ds_read_b64_tr_b16 a[158:159], v7 offset:10240
    ds_read_b64_tr_b16 a[160:161], v4 offset:28672
    ds_read_b64_tr_b16 a[162:163], v4 offset:30720
    ds_read_b64_tr_b16 a[164:165], v5 offset:28672
    ds_read_b64_tr_b16 a[166:167], v5 offset:30720
    ds_read_b64_tr_b16 a[168:169], v6 offset:28672
    ds_read_b64_tr_b16 a[170:171], v6 offset:30720
    ds_read_b64_tr_b16 a[172:173], v7 offset:28672
    ds_read_b64_tr_b16 a[174:175], v7 offset:30720
    ds_read_b64_tr_b16 a[176:177], v4 offset:32768
    ds_read_b64_tr_b16 a[178:179], v4 offset:34816
    ds_read_b64_tr_b16 a[180:181], v5 offset:32768
    ds_read_b64_tr_b16 a[182:183], v5 offset:34816
    ds_read_b64_tr_b16 a[184:185], v6 offset:32768
    ds_read_b64_tr_b16 a[186:187], v6 offset:34816
    ds_read_b64_tr_b16 a[188:189], v7 offset:32768
    ds_read_b64_tr_b16 a[190:191], v7 offset:34816
    ds_read_b64_tr_b16 a[192:193], v4 offset:36864
    ds_read_b64_tr_b16 a[194:195], v4 offset:38912
    ds_read_b64_tr_b16 a[196:197], v5 offset:36864
    ds_read_b64_tr_b16 a[198:199], v5 offset:38912
    ds_read_b64_tr_b16 a[200:201], v6 offset:36864
    ds_read_b64_tr_b16 a[202:203], v6 offset:38912
    ds_read_b64_tr_b16 a[204:205], v7 offset:36864
    ds_read_b64_tr_b16 a[206:207], v7 offset:38912
    v_subrev_u32_e64 v4, s54, v4
    s_mov_b32 s62, 100000
    s_mov_b32 exec_lo, 0x0fffffff
    s_mov_b32 exec_hi, 0x0fffffff
    s_waitcnt vmcnt(0)
L_wp_55:
    v_cmp_ne_u32 vcc, s45, v255
    s_sub_u32 s62, s62, 1
    s_cbranch_vccz L_wpok_56
    buffer_load_dword v255, v254, s[4:7], s63 offen sc1
    s_waitcnt vmcnt(0)
    s_cmp_gt_i32 s62, 0
    s_cbranch_scc1 L_wp_55
L_wpok_56:
    s_mov_b64 exec, -1
    s_add_u32 s52, s56, 0
    buffer_load_dwordx4 v[32:35], v2, s[4:7], s52 offen sc1
    v_subrev_u32 v5, s54, v5
    v_subrev_u32 v6, s54, v6
    v_subrev_u32 v7, s54, v7
    ds_read_b64_tr_b16 a[208:209], v4 offset:12288
    ds_read_b64_tr_b16 a[210:211], v4 offset:14336
    ds_read_b64_tr_b16 a[212:213], v5 offset:12288
    s_add_u32 s52, s56, 4096
    buffer_load_dwordx4 v[36:39], v2, s[4:7], s52 offen sc1
    ds_read_b64_tr_b16 a[214:215], v5 offset:14336
    ds_read_b64_tr_b16 a[216:217], v6 offset:12288
    ds_read_b64_tr_b16 a[218:219], v6 offset:14336
    ds_read_b64_tr_b16 a[220:221], v7 offset:12288
    ds_read_b64_tr_b16 a[222:223], v7 offset:14336
    s_add_u32 s52, s56, 8192
    buffer_load_dwordx4 v[40:43], v2, s[4:7], s52 offen sc1
    ds_read_b64_tr_b16 a[224:225], v4 offset:40960
    ds_read_b64_tr_b16 a[226:227], v4 offset:43008
    ds_read_b64_tr_b16 a[228:229], v5 offset:40960
    ds_read_b64_tr_b16 a[230:231], v5 offset:43008
    ds_read_b64_tr_b16 a[232:233], v6 offset:40960
    s_add_u32 s52, s56, 28672
    buffer_load_dwordx4 v[44:47], v2, s[4:7], s52 offen sc1
    ds_read_b64_tr_b16 a[234:235], v6 offset:43008
    ds_read_b64_tr_b16 a[236:237], v7 offset:40960
    ds_read_b64_tr_b16 a[238:239], v7 offset:43008
    v_accvgpr_read_b32 v253, a255
    v_add_u32 v253, s67, v253
    v_xor_b32 v252, 64, v253
    s_add_u32 s52, s56, 32768
    buffer_load_dwordx4 v[48:51], v2, s[4:7], s52 offen sc1
    ds_read_b64_tr_b16 a[48:49], v253 offset:0
    ds_read_b64_tr_b16 a[50:51], v253 offset:1024
    ds_read_b64_tr_b16 a[52:53], v253 offset:32
    ds_read_b64_tr_b16 a[54:55], v253 offset:1056
    ds_read_b64_tr_b16 a[56:57], v252 offset:0
    s_lshl_b32 s58, s46, 1
    s_add_u32 s58, s58, s42
    s_sub_u32 s58, s58, 1
    s_lshl_b32 s63, s58, 12
    s_add_u32 s63, s63, 11534336
    v_accvgpr_read_b32 v97, a240
    v_mul_u32_u24 v254, 28672, v1
    s_cmp_gt_u32 s58, 31
    s_cselect_b32 s63, 1073741824, s63
    s_cmp_eq_u32 s44, s49
    s_cselect_b32 s63, s63, 1073741824
    s_cselect_b64 exec, -1, 1
    buffer_load_dwordx4 v[100:103], v97, s[4:7], s63 offen sc1
    buffer_load_dwordx4 v[104:107], v97, s[4:7], s63 offen offset:2048 sc1
    s_lshl_b32 s51, s41, 11
    s_add_u32 s51, s51, 526080
    s_cmp_eq_u32 s44, 1
    s_cselect_b32 s51, s51, 1073741824
    s_mov_b64 exec, 3
    buffer_load_dword v255, v254, s[4:7], s51 offen sc1
    s_mov_b64 exec, -1
    ds_read_b64_tr_b16 a[58:59], v252 offset:1024
    ds_read_b64_tr_b16 a[60:61], v252 offset:32
    ds_read_b64_tr_b16 a[62:63], v252 offset:1056
    ds_read_b64_tr_b16 a[64:65], v253 offset:4096
    ds_read_b64_tr_b16 a[66:67], v253 offset:5120
    ds_read_b64_tr_b16 a[68:69], v253 offset:4128
    ds_read_b64_tr_b16 a[70:71], v253 offset:5152
    ds_read_b64_tr_b16 a[72:73], v252 offset:4096
    s_add_u32 s52, s56, 36864
    buffer_load_dwordx4 v[52:55], v2, s[4:7], s52 offen sc1
    ds_read_b64_tr_b16 a[74:75], v252 offset:5120
    ds_read_b64_tr_b16 a[76:77], v252 offset:4128
    ds_read_b64_tr_b16 a[78:79], v252 offset:5152
    ds_read_b64_tr_b16 a[80:81], v253 offset:8192
    ds_read_b64_tr_b16 a[82:83], v253 offset:9216
    s_add_u32 s52, s57, 0
    s_mov_b64 exec, s[8:9]
    buffer_load_dwordx4 v[56:59], v2, s[4:7], s52 offen sc1
    s_mov_b64 exec, -1
    s_nop 0
    ds_read_b64_tr_b16 a[84:85], v253 offset:8224
    ds_read_b64_tr_b16 a[86:87], v253 offset:9248
    ds_read_b64_tr_b16 a[88:89], v252 offset:8192
    ds_read_b64_tr_b16 a[90:91], v252 offset:9216
    s_add_u32 s52, s57, 4096
    s_mov_b64 exec, s[8:9]
    buffer_load_dwordx4 v[60:63], v2, s[4:7], s52 offen sc1
    s_mov_b64 exec, -1
    ds_read_b64_tr_b16 a[92:93], v252 offset:8224
    ds_read_b64_tr_b16 a[94:95], v252 offset:9248
    s_waitcnt lgkmcnt(0)
    s_barrier
    s_waitcnt vmcnt(10)
    v_mfma_f32_16x16x32_bf16 v[16:19], v[112:115], v[32:35], v[16:19]
    s_add_u32 s52, s57, 8192
    s_mov_b64 exec, s[8:9]
    buffer_load_dwordx4 v[64:67], v2, s[4:7], s52 offen sc1
    s_mov_b64 exec, -1
    v_mfma_f32_16x16x32_bf16 v[20:23], v[116:119], v[32:35], v[20:23]
    s_add_u32 s52, s57, 28672
    v_mfma_f32_16x16x32_bf16 v[24:27], v[120:123], v[32:35], v[24:27]
    v_mfma_f32_16x16x32_bf16 v[28:31], v[124:127], v[32:35], v[28:31]
    s_waitcnt vmcnt(10)
    v_mfma_f32_16x16x32_bf16 v[16:19], v[128:131], v[36:39], v[16:19]
    s_mov_b64 exec, s[10:11]
    buffer_load_dwordx4 v[68:71], v2, s[4:7], s52 offen sc1
    s_mov_b64 exec, -1
    v_mfma_f32_16x16x32_bf16 v[20:23], v[132:135], v[36:39], v[20:23]
    s_add_u32 s52, s57, 32768
    v_mfma_f32_16x16x32_bf16 v[24:27], v[136:139], v[36:39], v[24:27]
    v_mfma_f32_16x16x32_bf16 v[28:31], v[140:143], v[36:39], v[28:31]
    s_waitcnt vmcnt(10)
    v_mfma_f32_16x16x32_bf16 v[16:19], v[144:147], v[40:43], v[16:19]
    s_mov_b64 exec, s[10:11]
    buffer_load_dwordx4 v[72:75], v2, s[4:7], s52 offen sc1
    s_mov_b64 exec, -1
    v_mfma_f32_16x16x32_bf16 v[20:23], v[148:151], v[40:43], v[20:23]
    s_add_u32 s52, s57, 36864
    v_mfma_f32_16x16x32_bf16 v[24:27], v[152:155], v[40:43], v[24:27]
    v_mfma_f32_16x16x32_bf16 v[28:31], v[156:159], v[40:43], v[28:31]
    s_waitcnt vmcnt(10)
    v_mfma_f32_16x16x32_bf16 v[16:19], v[160:163], v[44:47], v[16:19]
    s_mov_b64 exec, s[10:11]
    buffer_load_dwordx4 v[76:79], v2, s[4:7], s52 offen sc1
    s_mov_b64 exec, -1
    v_mfma_f32_16x16x32_bf16 v[20:23], v[164:167], v[44:47], v[20:23]
    s_add_u32 s52, s55, 12288
    v_mfma_f32_16x16x32_bf16 v[24:27], v[168:171], v[44:47], v[24:27]
    v_mfma_f32_16x16x32_bf16 v[28:31], v[172:175], v[44:47], v[28:31]
    s_waitcnt vmcnt(10)
    v_mfma_f32_16x16x32_bf16 v[16:19], v[176:179], v[48:51], v[16:19]
    s_cmp_eq_u32 s46, 0
    s_cselect_b64 exec, s[8:9], -1
    buffer_load_dwordx2 v[80:81], v96, s[4:7], s52 offen offset:0 sc1
    s_cselect_b64 exec, -1, s[8:9]
    buffer_load_dwordx2 v[82:83], v96, s[4:7], s52 offen offset:2048 sc1
    s_mov_b64 exec, -1
    v_mfma_f32_16x16x32_bf16 v[20:23], v[180:183], v[48:51], v[20:23]
    v_mfma_f32_16x16x32_bf16 v[24:27], v[184:187], v[48:51], v[24:27]
    v_mfma_f32_16x16x32_bf16 v[28:31], v[188:191], v[48:51], v[28:31]
    s_waitcnt vmcnt(9)
    s_cmp_lg_u32 s44, s49
    s_cbranch_scc1 L_hl_57
    v_accvgpr_read_b32 v98, a241
    v_accvgpr_read_b32 v99, a242
    v_lshl_add_u32 v108, v1, 4, s67
    s_cmp_gt_u32 s58, 31
    s_cbranch_scc1 L_hk_59
    s_mov_b32 s62, 100000
L_hp_58:
    v_xor_b32 v101, s45, v101
    v_xor_b32 v103, s45, v103
    v_xor_b32 v105, s45, v105
    v_xor_b32 v107, s45, v107
    v_or3_b32 v101, v101, v103, v105
    v_or_b32 v101, v101, v107
    v_cmp_ne_u32 vcc, 0, v101
    s_sub_u32 s62, s62, 1
    s_cbranch_vccz L_hk_59
    buffer_load_dwordx4 v[100:103], v97, s[4:7], s63 offen sc1
    buffer_load_dwordx4 v[104:107], v97, s[4:7], s63 offen offset:2048 sc1
    s_waitcnt vmcnt(0)
    s_cmp_gt_i32 s62, 0
    s_cbranch_scc1 L_hp_58
L_hk_59:
    v_mov_b32 v101, v102
    v_mov_b32 v102, v104
    v_mov_b32 v103, v106
    ds_write_b128 v108, v[100:103]
    s_not_b64 exec, s[8:9]
    s_cmp_eq_u32 s46, 0
    ds_read_b128 v[56:59], v98 offset:0
    ds_read_b128 v[60:63], v98 offset:128
    ds_read_b128 v[64:67], v98 offset:256
    s_cbranch_scc0 L_ha_60
    ds_read_b64 v[80:81], v98 offset:768
    s_branch L_hc_61
L_ha_60:
    ds_read_b64 v[82:83], v98 offset:776
L_hc_61:
    s_not_b64 exec, s[10:11]
    s_cmp_eq_u32 s46, 0
    ds_read_b128 v[68:71], v99 offset:384
    ds_read_b128 v[72:75], v99 offset:512
    ds_read_b128 v[76:79], v99 offset:640
    s_cbranch_scc0 L_ha_62
    ds_read_b64 v[84:85], v99 offset:896
    s_branch L_hc_63
L_ha_62:
    ds_read_b64 v[86:87], v99 offset:904
L_hc_63:
    s_mov_b64 exec, -1
L_hl_57:
    s_waitcnt vmcnt(8)
    v_mfma_f32_16x16x32_bf16 v[16:19], v[192:195], v[52:55], v[16:19]
    s_add_u32 s52, s55, 40960
    s_cmp_eq_u32 s46, 0
    s_cselect_b64 exec, s[10:11], -1
    buffer_load_dwordx2 v[84:85], v96, s[4:7], s52 offen offset:0 sc1
    s_cselect_b64 exec, -1, s[10:11]
    buffer_load_dwordx2 v[86:87], v96, s[4:7], s52 offen offset:2048 sc1
    s_mov_b64 exec, -1
    v_mfma_f32_16x16x32_bf16 v[20:23], v[196:199], v[52:55], v[20:23]
    v_mfma_f32_16x16x32_bf16 v[24:27], v[200:203], v[52:55], v[24:27]
    v_mfma_f32_16x16x32_bf16 v[28:31], v[204:207], v[52:55], v[28:31]
    s_waitcnt lgkmcnt(0)
    s_cmp_lg_u32 s44, 1
    s_cbranch_scc1 L_c3_64
    s_mov_b32 s62, 100000
    s_mov_b64 exec, 3
L_cp_65:
    v_cmp_ne_u32 vcc, s45, v255
    s_sub_u32 s62, s62, 1
    s_cbranch_vccz L_ck_66
    buffer_load_dword v255, v254, s[4:7], s51 offen sc1
    s_waitcnt vmcnt(0)
    s_cmp_gt_i32 s62, 0
    s_cbranch_scc1 L_cp_65
L_ck_66:
    s_mov_b32 exec_lo, -1
    v_lshrrev_b32 v254, 4, v1
    v_mul_u32_u24 v254, 3328, v254
    v_lshl_add_u32 v254, v1, 4, v254
    s_lshl_b32 s63, s41, 8
    s_add_u32 s63, s63, 917504
    s_mov_b32 m0, 162816
    s_nop 0
    buffer_load_dwordx4 v254, s[4:7], s63 offen sc1 lds
    s_mov_b64 exec, -1
L_c3_64:
    s_waitcnt vmcnt(9)
    v_mfma_f32_16x16x32_bf16 v[16:19], v[208:211], v[56:59], v[16:19]
    s_add_u32 m0, s66, 0x0000f000
    s_add_u32 s64, s70, 114688
    buffer_load_dwordx4 v248, s[28:31], s64 offen offset:0 lds
    v_mfma_f32_16x16x32_bf16 v[20:23], v[212:215], v[56:59], v[20:23]
    v_mfma_f32_16x16x32_bf16 v[24:27], v[216:219], v[56:59], v[24:27]
    buffer_load_dwordx4 v249, s[28:31], s64 offen offset:1024 lds
    v_mfma_f32_16x16x32_bf16 v[28:31], v[220:223], v[56:59], v[28:31]
    s_waitcnt vmcnt(10)
    v_mfma_f32_16x16x32_bf16 v[16:19], v[224:227], v[60:63], v[16:19]
    buffer_load_dwordx4 v250, s[28:31], s64 offen offset:2048 lds
    v_mfma_f32_16x16x32_bf16 v[20:23], v[228:231], v[60:63], v[20:23]
    v_mfma_f32_16x16x32_bf16 v[24:27], v[232:235], v[60:63], v[24:27]
    buffer_load_dwordx4 v251, s[28:31], s64 offen offset:3072 lds
    v_mfma_f32_16x16x32_bf16 v[28:31], v[236:239], v[60:63], v[28:31]
    s_add_u32 m0, s66, 0x00010000
    s_add_u32 s64, s70, 229376
    s_waitcnt vmcnt(11)
    v_mfma_f32_16x16x32_bf16 v[16:19], a[144:147], v[64:67], v[16:19]
    buffer_load_dwordx4 v248, s[28:31], s64 offen offset:0 lds
    v_mfma_f32_16x16x32_bf16 v[20:23], a[148:151], v[64:67], v[20:23]
    v_mfma_f32_16x16x32_bf16 v[24:27], a[152:155], v[64:67], v[24:27]
    v_mfma_f32_16x16x32_bf16 v[28:31], a[156:159], v[64:67], v[28:31]
    s_waitcnt vmcnt(11)
    v_mfma_f32_16x16x32_bf16 v[16:19], a[160:163], v[68:71], v[16:19]
    buffer_load_dwordx4 v249, s[28:31], s64 offen offset:1024 lds
    v_mfma_f32_16x16x32_bf16 v[20:23], a[164:167], v[68:71], v[20:23]
    v_mfma_f32_16x16x32_bf16 v[24:27], a[168:171], v[68:71], v[24:27]
    v_mfma_f32_16x16x32_bf16 v[28:31], a[172:175], v[68:71], v[28:31]
    s_waitcnt vmcnt(11)
    v_mfma_f32_16x16x32_bf16 v[16:19], a[176:179], v[72:75], v[16:19]
    buffer_load_dwordx4 v250, s[28:31], s64 offen offset:2048 lds
    v_mfma_f32_16x16x32_bf16 v[20:23], a[180:183], v[72:75], v[20:23]
    v_mfma_f32_16x16x32_bf16 v[24:27], a[184:187], v[72:75], v[24:27]
    v_mfma_f32_16x16x32_bf16 v[28:31], a[188:191], v[72:75], v[28:31]
    s_waitcnt vmcnt(11)
    v_mfma_f32_16x16x32_bf16 v[16:19], a[192:195], v[76:79], v[16:19]
    buffer_load_dwordx4 v251, s[28:31], s64 offen offset:3072 lds
    v_mfma_f32_16x16x32_bf16 v[20:23], a[196:199], v[76:79], v[20:23]
    s_add_u32 m0, s66, 0x00011000
    s_add_u32 s64, s70, 344064
    v_mfma_f32_16x16x32_bf16 v[24:27], a[200:203], v[76:79], v[24:27]
    v_mfma_f32_16x16x32_bf16 v[28:31], a[204:207], v[76:79], v[28:31]
    s_waitcnt vmcnt(10)
    v_mfma_f32_16x16x32_bf16 v[16:19], a[208:211], v[80:83], v[16:19]
    buffer_load_dwordx4 v248, s[28:31], s64 offen offset:0 lds
    v_mfma_f32_16x16x32_bf16 v[20:23], a[212:215], v[80:83], v[20:23]
    v_mfma_f32_16x16x32_bf16 v[24:27], a[216:219], v[80:83], v[24:27]
    v_mfma_f32_16x16x32_bf16 v[28:31], a[220:223], v[80:83], v[28:31]
    s_waitcnt vmcnt(9)
    v_mfma_f32_16x16x32_bf16 v[16:19], a[224:227], v[84:87], v[16:19]
    buffer_load_dwordx4 v249, s[28:31], s64 offen offset:1024 lds
    v_mfma_f32_16x16x32_bf16 v[20:23], a[228:231], v[84:87], v[20:23]
    v_mfma_f32_16x16x32_bf16 v[24:27], a[232:235], v[84:87], v[24:27]
    v_mfma_f32_16x16x32_bf16 v[28:31], a[236:239], v[84:87], v[28:31]
    s_add_u32 s56, s71, 1163264
    s_add_u32 s57, s71, 1167360
    s_add_u32 s58, s72, 786432
    v_lshlrev_b32 v244, 3, v1
    v_cvt_pk_bf16_f32 v32, v16, v17
    v_cvt_pk_bf16_f32 v33, v18, v19
    v_cvt_pk_bf16_f32 v34, v20, v21
    v_cvt_pk_bf16_f32 v35, v22, v23
    v_cvt_pk_bf16_f32 v36, v24, v25
    v_cvt_pk_bf16_f32 v37, v26, v27
    v_cvt_pk_bf16_f32 v38, v28, v29
    v_cvt_pk_bf16_f32 v39, v30, v31
    s_cmp_lg_u32 s60, 0
    s_cbranch_scc0 L_fs_67
    buffer_store_dwordx4 v[32:35], v2, s[4:7], s56 offen
    buffer_store_dwordx4 v[36:39], v2, s[4:7], s57 offen
    s_branch L_fe_68
L_fs_67:
    s_nop 0
    buffer_store_dwordx4 v[32:35], v2, s[4:7], s56 offen sc1
    buffer_store_dwordx4 v[36:39], v2, s[4:7], s57 offen sc1
L_fe_68:
    v_pk_add_f32 v[240:241], v[16:17], v[18:19]
    v_pk_mul_f32 v[242:243], v[16:17], v[16:17]
    v_pk_fma_f32 v[242:243], v[18:19], v[18:19], v[242:243]
    v_pk_add_f32 v[240:241], v[240:241], v[20:21]
    v_pk_fma_f32 v[242:243], v[20:21], v[20:21], v[242:243]
    v_pk_add_f32 v[240:241], v[240:241], v[22:23]
    v_pk_fma_f32 v[242:243], v[22:23], v[22:23], v[242:243]
    v_pk_add_f32 v[240:241], v[240:241], v[24:25]
    v_pk_fma_f32 v[242:243], v[24:25], v[24:25], v[242:243]
    v_pk_add_f32 v[240:241], v[240:241], v[26:27]
    v_pk_fma_f32 v[242:243], v[26:27], v[26:27], v[242:243]
    v_pk_add_f32 v[240:241], v[240:241], v[28:29]
    v_pk_fma_f32 v[242:243], v[28:29], v[28:29], v[242:243]
    v_pk_add_f32 v[240:241], v[240:241], v[30:31]
    v_pk_fma_f32 v[242:243], v[30:31], v[30:31], v[242:243]
    v_add_f32 v240, v240, v241
    s_branch L_skip7
.p2align 12
L_stub7:
    s_setpc_b64 s[56:57]
    s_nop 0
L_skip7:
    v_add_f32 v241, v242, v243
    v_mov_b32 v242, v240
    v_mov_b32 v243, v241
    s_nop 0
    v_permlane16_swap_b32 v240, v242
    v_permlane16_swap_b32 v241, v243
    v_pk_add_f32 v[240:241], v[240:241], v[242:243]
    v_mov_b32_e64 v242, v240
    v_mov_b32 v243, v241
    s_nop 0
    v_permlane32_swap_b32 v240, v242
    v_permlane32_swap_b32 v241, v243
    v_pk_add_f32 v[240:241], v[240:241], v[242:243]
    s_mov_b64 exec, 0xffff
    s_cmp_lg_u32 s60, 0
    s_cbranch_scc0 L_fs_69
    buffer_store_dwordx2 v[240:241], v244, s[4:7], s58 offen
    s_branch L_fe_70
L_fs_69:
    buffer_store_dwordx2 v[240:241], v244, s[4:7], s58 offen sc1
L_fe_70:
    s_mov_b64 exec, -1
    v_accvgpr_read_b32 v248, a252
    v_add_u32 v249, 27648, v248
    v_add_u32 v250, 55296, v248
    v_add_u32 v251, 82944, v248
    s_add_u32 m0, s66, 0x00000000
    s_add_u32 s64, s70, 1792
    buffer_load_dwordx4 v248, s[28:31], s64 offen offset:0 lds
    v_lshlrev_b32 v48, 16, v8
    v_and_b32 v49, 0xffff0000, v8
    v_lshlrev_b32_e64 v50, 16, v9
    v_and_b32 v51, 0xffff0000, v9
    buffer_load_dwordx4 v249, s[28:31], s64 offen offset:1024 lds
    v_lshlrev_b32_e64 v52, 16, v10
    v_and_b32 v53, 0xffff0000, v10
    v_lshlrev_b32_e64 v54, 16, v11
    v_and_b32 v55, 0xffff0000, v11
    v_lshlrev_b32_e64 v56, 16, v12
    v_and_b32 v57, 0xffff0000, v12
    v_lshlrev_b32_e64 v58, 16, v13
    v_and_b32 v59, 0xffff0000, v13
    v_lshlrev_b32_e64 v60, 16, v14
    v_and_b32 v61, 0xffff0000, v14
    buffer_load_dwordx4 v250, s[28:31], s64 offen offset:2048 lds
    v_lshlrev_b32_e64 v62, 16, v15
    v_and_b32 v63, 0xffff0000, v15
    v_pk_add_f32 v[16:17], v[16:17], v[48:49]
    v_pk_add_f32 v[18:19], v[18:19], v[50:51]
    v_pk_add_f32 v[20:21], v[20:21], v[52:53]
    v_pk_add_f32 v[22:23], v[22:23], v[54:55]
    v_pk_add_f32 v[24:25], v[24:25], v[56:57]
    v_pk_add_f32 v[26:27], v[26:27], v[58:59]
    v_pk_add_f32 v[28:29], v[28:29], v[60:61]
    v_pk_add_f32 v[30:31], v[30:31], v[62:63]
    buffer_load_dwordx4 v251, s[28:31], s64 offen offset:3072 lds
    v_accvgpr_read_b32 v8, a251
    v_accvgpr_read_b32 v9, a254
    v_accvgpr_read_b32 v4, a249
    v_xor_b32_e64 v5, 64, v4
    v_add_u32 v6, 57344, v4
    v_add_u32 v7, 57344, v5
    s_and_b32 s57, s44, 1
    s_lshr_b32 s56, s44, 1
    v_lshrrev_b32 v11, 5, v1
    v_lshlrev_b32 v0, 6, v11
    s_add_u32 m0, s66, 0x00001000
    s_add_u32 s64, s70, 116480
    buffer_load_dwordx4 v248, s[28:31], s64 offen offset:0 lds
    v_add_u32 v0, 162816, v0
    s_lshl_b32 s52, s40, 1
    s_add_u32 s56, s56, s52
    s_lshl_b32 s57, s57, 9
    s_mul_i32 s55, s56, 57344
    s_mul_i32 s59, s40, 229376
    s_add_u32 s55, s55, s59
    s_add_u32 s55, s55, s57
    buffer_load_dwordx4 v249, s[28:31], s64 offen offset:1024 lds
    s_add_u32 s55, s55, 1163264
    s_lshl_b32 s58, s56, 12
    s_lshr_b32 s59, s57, 1
    s_add_u32 s58, s58, s59
    s_add_u32 s58, s58, 786432
    s_mul_i32 s56, s56, 229376
    s_add_u32 s56, s56, s57
    s_lshl_b32 s53, s41, 13
    s_add_u32 s56, s56, s53
    s_add_u32 s56, s56, 15728640
    buffer_load_dwordx4 v250, s[28:31], s64 offen offset:2048 lds
    v_and_b32 v10, 31, v1
    v_lshlrev_b32_e64 v10, 3, v10
    v_lshl_add_u32 v10, v11, 11, v10
    v_lshl_add_u32 v11, v11, 30, v10
    s_lshl_b32 s54, s40, 4
    s_lshl_b32 s51, s47, 8
    s_add_u32 s51, s51, 327680
    v_mov_b32_e64 v254, s45
    v_lshlrev_b32 v255, 2, s44
    s_mov_b64 exec, 1
    s_waitcnt vmcnt(7)
    s_cmp_lg_u32 s60, 0
    s_cbranch_scc0 L_fs_71
    buffer_store_dword v254, v255, s[4:7], s51 offen
    s_branch L_fe_72
L_fs_71:
    buffer_store_dword v254, v255, s[4:7], s51 offen sc1
L_fe_72:
    s_mov_b64 exec, -1
    s_barrier
    s_nop 0
    buffer_load_dwordx4 v251, s[28:31], s64 offen offset:3072 lds
    ds_read_b64_tr_b16 a[224:225], v6 offset:0
    ds_read_b64_tr_b16 a[226:227], v6 offset:2048
    ds_read_b64_tr_b16 a[228:229], v7 offset:0
    ds_read_b64_tr_b16 a[230:231], v7 offset:2048
    ds_read_b64_tr_b16 a[232:233], v6 offset:1024
    ds_read_b64_tr_b16 a[234:235], v6 offset:3072
    s_add_u32 m0, s66, 0x00002000
    s_add_u32 s64, s70, 231168
    buffer_load_dwordx4 v248, s[28:31], s64 offen offset:0 lds
    ds_read_b64_tr_b16 a[236:237], v7 offset:1024
    ds_read_b64_tr_b16 a[238:239], v7 offset:3072
    ds_read_b64_tr_b16 a[240:241], v6 offset:4096
    ds_read_b64_tr_b16 a[242:243], v6 offset:6144
    ds_read_b64_tr_b16 a[244:245], v7 offset:4096
    buffer_load_dwordx4 v249, s[28:31], s64 offen offset:1024 lds
    ds_read_b64_tr_b16 a[246:247], v7 offset:6144
    ds_read_b64_tr_b16 a[248:249], v6 offset:5120
    ds_read_b64_tr_b16 a[250:251], v6 offset:7168
    ds_read_b64_tr_b16 a[252:253], v7 offset:5120
    ds_read_b64_tr_b16 a[254:255], v7 offset:7168
    ds_read_b128 v[208:211], v0 offset:0
    buffer_load_dwordx4 v250, s[28:31], s64 offen offset:2048 lds
    ds_read_b128 v[212:215], v0 offset:16
    ds_read_b128 v[216:219], v0 offset:32
    ds_read_b128 v[220:223], v0 offset:48
    buffer_load_dwordx4 v251, s[28:31], s64 offen offset:3072 lds
    ds_read_b128 v[224:227], v0 offset:128
    ds_read_b128 v[228:231], v0 offset:144
    ds_read_b128 v[232:235], v0 offset:160
    s_lshl_b32 s62, s40, 12
    v_mov_b32 v254, v9
    s_mov_b32 vcc_lo, 0x0fffffff
    s_mov_b32 vcc_hi, 0x0fffffff
    v_add_u32_e64 v254, s62, v254
    s_mov_b32 s63, 327680
    s_mov_b64 exec, vcc
    buffer_load_dword v255, v254, s[4:7], s63 offen sc1
    s_mov_b64 exec, -1
    s_add_u32 m0, s66, 0x00003000
    s_add_u32 s64, s70, 345856
    buffer_load_dwordx4 v248, s[28:31], s64 offen offset:0 lds
    ds_read_b128 v[236:239], v0 offset:176
    ds_read_b128 v[192:195], v0 offset:384
    ds_read_b128 v[196:199], v0 offset:400
    buffer_load_dwordx4 v249, s[28:31], s64 offen offset:1024 lds
    ds_read_b128 v[200:203], v0 offset:416
    ds_read_b128 v[204:207], v0 offset:432
    s_mov_b32 s62, 100000
    s_mov_b32 exec_lo, 0x0fffffff
    s_mov_b32 exec_hi, 0x0fffffff
    s_waitcnt vmcnt(2)
L_wp_73:
    v_cmp_ne_u32 vcc, s45, v255
    s_sub_u32 s62, s62, 1
    s_cbranch_vccz L_wpok_74
    buffer_load_dword v255, v254, s[4:7], s63 offen sc1
    s_waitcnt vmcnt(0)
    s_cmp_gt_i32 s62, 0
    s_cbranch_scc1 L_wp_73
L_wpok_74:
    s_mov_b64 exec, -1
    buffer_load_dwordx4 v[32:35], v3, s[4:7], s55 offen offset:0 sc1
    buffer_load_dwordx4 v[36:39], v3, s[4:7], s55 offen offset:2048 sc1
    s_add_u32 s55, s55, 4096
    buffer_load_dwordx4 v[40:43], v3, s[4:7], s55 offen offset:0 sc1
    buffer_load_dwordx4 v[44:47], v3, s[4:7], s55 offen offset:2048 sc1
    s_add_u32 s55, s55, 4096
    buffer_load_dwordx4 v[48:51], v3, s[4:7], s55 offen offset:0 sc1
    buffer_load_dwordx4 v[52:55], v3, s[4:7], s55 offen offset:2048 sc1
    s_add_u32 s55, s55, 4096
    buffer_load_dwordx4 v[56:59], v3, s[4:7], s55 offen offset:0 sc1
    s_waitcnt vmcnt(6) lgkmcnt(15)
    v_mfma_f32_32x32x16_bf16 v[144:159], a[224:227], v[32:35], 0
    ds_read_b64_tr_b16 a[224:225], v6 offset:8192
    ds_read_b64_tr_b16 a[226:227], v6 offset:10240
    buffer_load_dwordx4 v[60:63], v3, s[4:7], s55 offen offset:2048 sc1
    v_mfma_f32_32x32x16_bf16 v[160:175], a[228:231], v[32:35], 0
    ds_read_b64_tr_b16 a[228:229], v7 offset:8192
    ds_read_b64_tr_b16 a[230:231], v7 offset:10240
    buffer_load_dwordx2 v[240:241], v10, s[4:7], s58 offen offset:0 sc1
    s_waitcnt vmcnt(7)
    v_mfma_f32_32x32x16_bf16 v[144:159], a[232:235], v[36:39], v[144:159]
    ds_read_b64_tr_b16 a[232:233], v6 offset:9216
    ds_read_b64_tr_b16 a[234:235], v6 offset:11264
    buffer_load_dwordx2 v[242:243], v10, s[4:7], s58 offen offset:512 sc1
    v_mfma_f32_32x32x16_bf16 v[160:175], a[236:239], v[36:39], v[160:175]
    ds_read_b64_tr_b16 a[236:237], v7 offset:9216
    ds_read_b64_tr_b16 a[238:239], v7 offset:11264
    buffer_load_dwordx2 v[244:245], v10, s[4:7], s58 offen offset:1024 sc1
    s_waitcnt vmcnt(8)
    v_mfma_f32_32x32x16_bf16 v[144:159], a[240:243], v[40:43], v[144:159]
    ds_read_b64_tr_b16 a[240:241], v6 offset:12288
    ds_read_b64_tr_b16 a[242:243], v6 offset:14336
    buffer_load_dwordx2 v[246:247], v11, s[4:7], s58 offen offset:1536 sc1
    v_mfma_f32_32x32x16_bf16 v[160:175], a[244:247], v[40:43], v[160:175]
    ds_read_b64_tr_b16 a[244:245], v7 offset:12288
    ds_read_b64_tr_b16 a[246:247], v7 offset:14336
    s_add_u32 s55, s55, 4096
    buffer_load_dwordx4 v[64:67], v3, s[4:7], s55 offen offset:0 sc1
    s_barrier
    s_waitcnt vmcnt(9) lgkmcnt(15)
    v_mfma_f32_32x32x16_bf16 v[144:159], a[248:251], v[44:47], v[144:159]
    ds_read_b64_tr_b16 a[248:249], v6 offset:13312
    ds_read_b64_tr_b16 a[250:251], v6 offset:15360
    buffer_load_dwordx4 v[68:71], v3, s[4:7], s55 offen offset:2048 sc1
    v_mfma_f32_32x32x16_bf16 v[160:175], a[252:255], v[44:47], v[160:175]
    ds_read_b64_tr_b16 a[252:253], v7 offset:13312
    ds_read_b64_tr_b16 a[254:255], v7 offset:15360
    s_add_u32 s55, s55, 4096
    buffer_load_dwordx4 v[72:75], v3, s[4:7], s55 offen offset:0 sc1
    s_waitcnt vmcnt(10) lgkmcnt(12)
    v_mfma_f32_32x32x16_bf16 v[144:159], a[224:227], v[48:51], v[144:159]
    ds_read_b64_tr_b16 a[224:225], v6 offset:16384
    ds_read_b64_tr_b16 a[226:227], v6 offset:18432
    buffer_load_dwordx4 v[76:79], v3, s[4:7], s55 offen offset:2048 sc1
    v_mfma_f32_32x32x16_bf16 v[160:175], a[228:231], v[48:51], v[160:175]
    ds_read_b64_tr_b16 a[228:229], v7 offset:16384
    ds_read_b64_tr_b16 a[230:231], v7 offset:18432
    s_add_u32 s55, s55, 4096
    buffer_load_dwordx4 v[80:83], v3, s[4:7], s55 offen offset:0 sc1
    s_waitcnt vmcnt(11) lgkmcnt(12)
    v_mfma_f32_32x32x16_bf16 v[144:159], a[232:235], v[52:55], v[144:159]
    ds_read_b64_tr_b16 a[232:233], v6 offset:17408
    ds_read_b64_tr_b16 a[234:235], v6 offset:19456
    buffer_load_dwordx4 v[84:87], v3, s[4:7], s55 offen offset:2048 sc1
    v_mfma_f32_32x32x16_bf16 v[160:175], a[236:239], v[52:55], v[160:175]
    ds_read_b64_tr_b16 a[236:237], v7 offset:17408
    ds_read_b64_tr_b16 a[238:239], v7 offset:19456
    s_waitcnt vmcnt(11) lgkmcnt(12)
    v_mfma_f32_32x32x16_bf16 v[144:159], a[240:243], v[56:59], v[144:159]
    ds_read_b64_tr_b16 a[240:241], v6 offset:20480
    ds_read_b64_tr_b16 a[242:243], v6 offset:22528
    s_add_u32 s55, s55, 4096
    buffer_load_dwordx4 v[88:91], v3, s[4:7], s55 offen offset:0 sc1
    v_mfma_f32_32x32x16_bf16 v[160:175], a[244:247], v[56:59], v[160:175]
    ds_read_b64_tr_b16 a[244:245], v7 offset:20480
    ds_read_b64_tr_b16 a[246:247], v7 offset:22528
    s_waitcnt vmcnt(11) lgkmcnt(12)
    v_mfma_f32_32x32x16_bf16 v[144:159], a[248:251], v[60:63], v[144:159]
    ds_read_b64_tr_b16 a[248:249], v6 offset:21504
    ds_read_b64_tr_b16 a[250:251], v6 offset:23552
    buffer_load_dwordx4 v[92:95], v3, s[4:7], s55 offen offset:2048 sc1
    v_mfma_f32_32x32x16_bf16 v[160:175], a[252:255], v[60:63], v[160:175]
    ds_read_b64_tr_b16 a[252:253], v7 offset:21504
    ds_read_b64_tr_b16 a[254:255], v7 offset:23552
    s_waitcnt vmcnt(7) lgkmcnt(12)
    v_mfma_f32_32x32x16_bf16 v[144:159], a[224:227], v[64:67], v[144:159]
    ds_read_b64_tr_b16 a[224:225], v6 offset:24576
    ds_read_b64_tr_b16 a[226:227], v6 offset:26624
    s_add_u32 s55, s55, 4096
    buffer_load_dwordx4 v[96:99], v3, s[4:7], s55 offen offset:0 sc1
    v_mfma_f32_32x32x16_bf16 v[160:175], a[228:231], v[64:67], v[160:175]
    ds_read_b64_tr_b16 a[228:229], v7 offset:24576
    ds_read_b64_tr_b16 a[230:231], v7 offset:26624
    s_waitcnt vmcnt(7) lgkmcnt(12)
    v_mfma_f32_32x32x16_bf16 v[144:159], a[232:235], v[68:71], v[144:159]
    ds_read_b64_tr_b16 a[232:233], v6 offset:25600
    ds_read_b64_tr_b16 a[234:235], v6 offset:27648
    buffer_load_dwordx4 v[100:103], v3, s[4:7], s55 offen offset:2048 sc1
    v_mfma_f32_32x32x16_bf16 v[160:175], a[236:239], v[68:71], v[160:175]
    ds_read_b64_tr_b16 a[236:237], v7 offset:25600
    ds_read_b64_tr_b16 a[238:239], v7 offset:27648
    v_add_f32 v240, v240, v242
    v_add_f32_e64 v241, v241, v243
    v_add_f32 v244, v244, v246
    s_waitcnt vmcnt(7) lgkmcnt(12)
    v_mfma_f32_32x32x16_bf16 v[144:159], a[240:243], v[72:75], v[144:159]
    ds_read_b64_tr_b16 a[240:241], v6 offset:28672
    ds_read_b64_tr_b16 a[242:243], v6 offset:30720
    s_add_u32 s55, s55, 4096
    buffer_load_dwordx4 v[104:107], v3, s[4:7], s55 offen offset:0 sc1
    v_mfma_f32_32x32x16_bf16 v[160:175], a[244:247], v[72:75], v[160:175]
    ds_read_b64_tr_b16 a[244:245], v7 offset:28672
    ds_read_b64_tr_b16 a[246:247], v7 offset:30720
    v_add_f32 v245, v245, v247
    v_add_f32 v240, v240, v244
    v_add_f32 v241, v241, v245
    s_waitcnt vmcnt(7) lgkmcnt(12)
    v_mfma_f32_32x32x16_bf16 v[144:159], a[248:251], v[76:79], v[144:159]
    ds_read_b64_tr_b16 a[248:249], v6 offset:29696
    ds_read_b64_tr_b16 a[250:251], v6 offset:31744
    buffer_load_dwordx4 v[108:111], v3, s[4:7], s55 offen offset:2048 sc1
    v_mfma_f32_32x32x16_bf16 v[160:175], a[252:255], v[76:79], v[160:175]
    ds_read_b64_tr_b16 a[252:253], v7 offset:29696
    ds_read_b64_tr_b16 a[254:255], v7 offset:31744
    v_mov_b32_e64 v242, v240
    v_mov_b32 v243, v241
    s_nop 0
    v_permlane32_swap_b32 v240, v242
    s_waitcnt vmcnt(7) lgkmcnt(12)
    v_mfma_f32_32x32x16_bf16 v[144:159], a[224:227], v[80:83], v[144:159]
    ds_read_b64_tr_b16 a[224:225], v6 offset:32768
    ds_read_b64_tr_b16 a[226:227], v6 offset:34816
    s_add_u32 s55, s55, 4096
    buffer_load_dwordx4 v[112:115], v3, s[4:7], s55 offen offset:0 sc1
    v_mfma_f32_32x32x16_bf16 v[160:175], a[228:231], v[80:83], v[160:175]
    ds_read_b64_tr_b16 a[228:229], v7 offset:32768
    ds_read_b64_tr_b16 a[230:231], v7 offset:34816
    v_permlane32_swap_b32 v241, v243
    v_add_f32 v240, v240, v242
    v_add_f32 v241, v241, v243
    s_waitcnt vmcnt(7) lgkmcnt(12)
    v_mfma_f32_32x32x16_bf16 v[144:159], a[232:235], v[84:87], v[144:159]
    ds_read_b64_tr_b16 a[232:233], v6 offset:33792
    ds_read_b64_tr_b16 a[234:235], v6 offset:35840
    buffer_load_dwordx4 v[116:119], v3, s[4:7], s55 offen offset:2048 sc1
    v_mfma_f32_32x32x16_bf16 v[160:175], a[236:239], v[84:87], v[160:175]
    ds_read_b64_tr_b16 a[236:237], v7 offset:33792
    ds_read_b64_tr_b16 a[238:239], v7 offset:35840
    v_mul_f32 v240, 0xbb124925, v240
    v_mul_f32 v242, 0x3b124925, v241
    v_fma_f32 v242, -v240, v240, v242
    s_waitcnt vmcnt(7) lgkmcnt(12)
    v_mfma_f32_32x32x16_bf16 v[144:159], a[240:243], v[88:91], v[144:159]
    ds_read_b64_tr_b16 a[240:241], v6 offset:36864
    ds_read_b64_tr_b16 a[242:243], v6 offset:38912
    s_add_u32 s55, s55, 4096
    buffer_load_dwordx4 v[120:123], v3, s[4:7], s55 offen offset:0 sc1
    v_mfma_f32_32x32x16_bf16 v[160:175], a[244:247], v[88:91], v[160:175]
    ds_read_b64_tr_b16 a[244:245], v7 offset:36864
    ds_read_b64_tr_b16 a[246:247], v7 offset:38912
    v_max_f32 v242, 0, v242
    v_add_f32 v243, 0x3727c5ac, v242
    v_rsq_f32 v247, v243
    s_waitcnt vmcnt(7) lgkmcnt(12)
    v_mfma_f32_32x32x16_bf16 v[144:159], a[248:251], v[92:95], v[144:159]
    ds_read_b64_tr_b16 a[248:249], v6 offset:37888
    ds_read_b64_tr_b16 a[250:251], v6 offset:39936
    buffer_load_dwordx4 v[124:127], v3, s[4:7], s55 offen offset:2048 sc1
    v_mfma_f32_32x32x16_bf16 v[160:175], a[252:255], v[92:95], v[160:175]
    ds_read_b64_tr_b16 a[252:253], v7 offset:37888
    ds_read_b64_tr_b16 a[254:255], v7 offset:39936
    v_mul_f32 v244, 0xc0135761, v247
    v_mul_f32_e64 v245, v247, v247
    v_mul_f32 v245, v245, v247
    s_waitcnt vmcnt(7) lgkmcnt(12)
    v_mfma_f32_32x32x16_bf16 v[144:159], a[224:227], v[96:99], v[144:159]
    ds_read_b64_tr_b16 a[224:225], v6 offset:40960
    ds_read_b64_tr_b16 a[226:227], v6 offset:43008
    s_add_u32 s55, s55, 4096
    buffer_load_dwordx4 v[128:131], v3, s[4:7], s55 offen offset:0 sc1
    v_mfma_f32_32x32x16_bf16 v[160:175], a[228:231], v[96:99], v[160:175]
    ds_read_b64_tr_b16 a[228:229], v7 offset:40960
    ds_read_b64_tr_b16 a[230:231], v7 offset:43008
    v_mul_f32 v245, 0xbdd2d3e8, v245
    v_rcp_f32 v246, v247
    s_waitcnt vmcnt(7) lgkmcnt(12)
    v_mfma_f32_32x32x16_bf16 v[144:159], a[232:235], v[100:103], v[144:159]
    ds_read_b64_tr_b16 a[232:233], v6 offset:41984
    ds_read_b64_tr_b16 a[234:235], v6 offset:44032
    buffer_load_dwordx4 v[132:135], v3, s[4:7], s55 offen offset:2048 sc1
    v_mfma_f32_32x32x16_bf16 v[160:175], a[236:239], v[100:103], v[160:175]
    ds_read_b64_tr_b16 a[236:237], v7 offset:41984
    ds_read_b64_tr_b16 a[238:239], v7 offset:44032
    v_mul_f32 v192, v192, v240
    v_mul_f32 v193, v193, v240
    v_mul_f32 v194, v194, v240
    s_waitcnt vmcnt(7) lgkmcnt(12)
    v_mfma_f32_32x32x16_bf16 v[144:159], a[240:243], v[104:107], v[144:159]
    ds_read_b64_tr_b16 a[240:241], v6 offset:45056
    ds_read_b64_tr_b16 a[242:243], v6 offset:47104
    s_add_u32 s55, s55, 4096
    buffer_load_dwordx4 v[136:139], v3, s[4:7], s55 offen offset:0 sc1
    v_mfma_f32_32x32x16_bf16 v[160:175], a[244:247], v[104:107], v[160:175]
    ds_read_b64_tr_b16 a[244:245], v7 offset:45056
    ds_read_b64_tr_b16 a[246:247], v7 offset:47104
    v_mul_f32 v195, v195, v240
    v_mul_f32 v196, v196, v240
    v_mul_f32 v197, v197, v240
    s_waitcnt vmcnt(7) lgkmcnt(12)
    v_mfma_f32_32x32x16_bf16 v[144:159], a[248:251], v[108:111], v[144:159]
    ds_read_b64_tr_b16 a[248:249], v6 offset:46080
    ds_read_b64_tr_b16 a[250:251], v6 offset:48128
    buffer_load_dwordx4 v[140:143], v3, s[4:7], s55 offen offset:2048 sc1
    v_mfma_f32_32x32x16_bf16 v[160:175], a[252:255], v[108:111], v[160:175]
    ds_read_b64_tr_b16 a[252:253], v7 offset:46080
    ds_read_b64_tr_b16 a[254:255], v7 offset:48128
    v_mul_f32 v198, v198, v240
    v_mul_f32 v199, v199, v240
    v_mul_f32 v200, v200, v240
    s_waitcnt vmcnt(7) lgkmcnt(12)
    v_mfma_f32_32x32x16_bf16 v[144:159], a[224:227], v[112:115], v[144:159]
    ds_read_b64_tr_b16 a[224:225], v6 offset:49152
    ds_read_b64_tr_b16 a[226:227], v6 offset:51200
    v_add_u32_e64 v248, 0, v8
    v_add_u32 v249, 6144, v8
    v_add_u32 v250, 12288, v8
    v_add_u32 v251, 18432, v8
    s_add_u32 m0, s67, 0x00000000
    s_add_u32 s64, s69, 172032
    buffer_load_dwordx4 v248, s[32:35], s64 offen offset:0 lds
    v_mfma_f32_32x32x16_bf16 v[160:175], a[228:231], v[112:115], v[160:175]
    ds_read_b64_tr_b16 a[228:229], v7 offset:49152
    ds_read_b64_tr_b16 a[230:231], v7 offset:51200
    v_mul_f32 v201, v201, v240
    v_mul_f32_e64 v202, v202, v240
    v_mul_f32 v203, v203, v240
    s_waitcnt vmcnt(7) lgkmcnt(12)
    v_mfma_f32_32x32x16_bf16 v[144:159], a[232:235], v[116:119], v[144:159]
    ds_read_b64_tr_b16 a[232:233], v6 offset:50176
    ds_read_b64_tr_b16 a[234:235], v6 offset:52224
    buffer_load_dwordx4 v249, s[32:35], s64 offen offset:1024 lds
    v_mfma_f32_32x32x16_bf16 v[160:175], a[236:239], v[116:119], v[160:175]
    ds_read_b64_tr_b16 a[236:237], v7 offset:50176
    ds_read_b64_tr_b16 a[238:239], v7 offset:52224
    v_mul_f32 v204, v204, v240
    v_mul_f32 v205, v205, v240
    v_mul_f32 v206, v206, v240
    s_waitcnt vmcnt(7) lgkmcnt(12)
    v_mfma_f32_32x32x16_bf16 v[144:159], a[240:243], v[120:123], v[144:159]
    ds_read_b64_tr_b16 a[240:241], v6 offset:53248
    ds_read_b64_tr_b16 a[242:243], v6 offset:55296
    buffer_load_dwordx4 v250, s[32:35], s64 offen offset:2048 lds
    v_mfma_f32_32x32x16_bf16 v[160:175], a[244:247], v[120:123], v[160:175]
    ds_read_b64_tr_b16 a[244:245], v7 offset:53248
    ds_read_b64_tr_b16 a[246:247], v7 offset:55296
    v_mul_f32 v207, v207, v240
    s_waitcnt vmcnt(7) lgkmcnt(12)
    v_mfma_f32_32x32x16_bf16 v[144:159], a[248:251], v[124:127], v[144:159]
    ds_read_b64_tr_b16 a[248:249], v6 offset:54272
    ds_read_b64_tr_b16 a[250:251], v6 offset:56320
    buffer_load_dwordx4 v251, s[32:35], s64 offen offset:3072 lds
    v_mfma_f32_32x32x16_bf16 v[160:175], a[252:255], v[124:127], v[160:175]
    ds_read_b64_tr_b16 a[252:253], v7 offset:54272
    ds_read_b64_tr_b16 a[254:255], v7 offset:56320
    s_waitcnt vmcnt(7) lgkmcnt(12)
    v_mfma_f32_32x32x16_bf16 v[144:159], a[224:227], v[128:131], v[144:159]
    ds_read_b64_tr_b16 a[224:225], v4 offset:0
    ds_read_b64_tr_b16 a[226:227], v4 offset:2048
    s_add_u32 m0, s67, 0x00001000
    s_add_u32 s64, s50, 0
    buffer_load_dwordx4 v248, s[32:35], s64 offen offset:0 lds
    v_mfma_f32_32x32x16_bf16 v[160:175], a[228:231], v[128:131], v[160:175]
    ds_read_b64_tr_b16 a[228:229], v4 offset:1024
    ds_read_b64_tr_b16 a[230:231], v4 offset:3072
    s_waitcnt vmcnt(7) lgkmcnt(12)
    v_mfma_f32_32x32x16_bf16 v[144:159], a[232:235], v[132:135], v[144:159]
    ds_read_b64_tr_b16 a[232:233], v4 offset:4096
    ds_read_b64_tr_b16 a[234:235], v4 offset:6144
    buffer_load_dwordx4 v249, s[32:35], s64 offen offset:1024 lds
    v_mfma_f32_32x32x16_bf16 v[160:175], a[236:239], v[132:135], v[160:175]
    ds_read_b64_tr_b16 a[236:237], v4 offset:5120
    ds_read_b64_tr_b16 a[238:239], v4 offset:7168
    s_waitcnt vmcnt(7) lgkmcnt(12)
    v_mfma_f32_32x32x16_bf16 v[144:159], a[240:243], v[136:139], v[144:159]
    ds_read_b64_tr_b16 a[240:241], v4 offset:8192
    ds_read_b64_tr_b16 a[242:243], v4 offset:10240
    buffer_load_dwordx4 v250, s[32:35], s64 offen offset:2048 lds
    v_mfma_f32_32x32x16_bf16 v[160:175], a[244:247], v[136:139], v[160:175]
    ds_read_b64_tr_b16 a[244:245], v4 offset:9216
    ds_read_b64_tr_b16 a[246:247], v4 offset:11264
    s_waitcnt vmcnt(7) lgkmcnt(12)
    v_mfma_f32_32x32x16_bf16 v[144:159], a[248:251], v[140:143], v[144:159]
    ds_read_b64_tr_b16 a[248:249], v4 offset:12288
    ds_read_b64_tr_b16 a[250:251], v4 offset:14336
    buffer_load_dwordx4 v251, s[32:35], s64 offen offset:3072 lds
    v_mfma_f32_32x32x16_bf16 v[160:175], a[252:255], v[140:143], v[160:175]
    ds_read_b64_tr_b16 a[252:253], v4 offset:13312
    ds_read_b64_tr_b16 a[254:255], v4 offset:15360
    s_nop 5
    v_pk_fma_f32 v[144:145], v[208:209], v[240:241], v[144:145] op_sel_hi:[1,0,1]
    v_pk_fma_f32 v[146:147], v[210:211], v[240:241], v[146:147] op_sel_hi:[1,0,1]
    v_pk_fma_f32 v[148:149], v[212:213], v[240:241], v[148:149] op_sel_hi:[1,0,1]
    v_pk_fma_f32 v[150:151], v[214:215], v[240:241], v[150:151] op_sel_hi:[1,0,1]
    v_pk_fma_f32 v[152:153], v[216:217], v[240:241], v[152:153] op_sel_hi:[1,0,1]
    v_pk_fma_f32 v[154:155], v[218:219], v[240:241], v[154:155] op_sel_hi:[1,0,1]
    v_pk_fma_f32 v[156:157], v[220:221], v[240:241], v[156:157] op_sel_hi:[1,0,1]
    v_pk_fma_f32 v[158:159], v[222:223], v[240:241], v[158:159] op_sel_hi:[1,0,1]
    v_pk_fma_f32 v[160:161], v[224:225], v[240:241], v[160:161] op_sel_hi:[1,0,1]
    v_pk_fma_f32 v[162:163], v[226:227], v[240:241], v[162:163] op_sel_hi:[1,0,1]
    v_pk_fma_f32 v[164:165], v[228:229], v[240:241], v[164:165] op_sel_hi:[1,0,1]
    v_pk_fma_f32 v[166:167], v[230:231], v[240:241], v[166:167] op_sel_hi:[1,0,1]
    v_pk_fma_f32 v[168:169], v[232:233], v[240:241], v[168:169] op_sel_hi:[1,0,1]
    v_pk_fma_f32 v[170:171], v[234:235], v[240:241], v[170:171] op_sel_hi:[1,0,1]
    v_pk_fma_f32 v[172:173], v[236:237], v[240:241], v[172:173] op_sel_hi:[1,0,1]
    v_pk_fma_f32 v[174:175], v[238:239], v[240:241], v[174:175] op_sel_hi:[1,0,1]
    ds_read_b128 v[224:227], v0 offset:256
    ds_read_b128 v[228:231], v0 offset:272
    ds_read_b128 v[232:235], v0 offset:288
    ds_read_b128 v[236:239], v0 offset:304
    s_add_u32 s52, s56, 0
    s_nop 0
    v_pk_mul_f32 v[208:209], v[144:145], v[144:145]
    v_pk_mul_f32 v[210:211], v[146:147], v[146:147]
    v_pk_mul_f32 v[212:213], v[148:149], v[148:149]
    v_pk_mul_f32 v[214:215], v[150:151], v[150:151]
    v_pk_fma_f32 v[208:209], v[208:209], v[244:245], v[244:245] op_sel:[0,1,0] op_sel_hi:[1,1,0]
    v_pk_fma_f32 v[210:211], v[210:211], v[244:245], v[244:245] op_sel:[0,1,0] op_sel_hi:[1,1,0]
    v_pk_fma_f32 v[212:213], v[212:213], v[244:245], v[244:245] op_sel:[0,1,0] op_sel_hi:[1,1,0]
    v_pk_fma_f32 v[214:215], v[214:215], v[244:245], v[244:245] op_sel:[0,1,0] op_sel_hi:[1,1,0]
    v_pk_mul_f32 v[208:209], v[208:209], v[144:145]
    v_pk_mul_f32 v[210:211], v[210:211], v[146:147]
    v_pk_mul_f32 v[212:213], v[212:213], v[148:149]
    v_pk_mul_f32 v[214:215], v[214:215], v[150:151]
    v_exp_f32 v208, v208
    v_exp_f32 v209, v209
    v_exp_f32 v210, v210
    v_exp_f32 v211, v211
    v_exp_f32 v212, v212
    v_exp_f32 v213, v213
    v_exp_f32 v214, v214
    v_exp_f32 v215, v215
    v_pk_fma_f32 v[208:209], v[208:209], v[246:247], v[246:247] op_sel_hi:[1,0,0]
    v_pk_fma_f32 v[210:211], v[210:211], v[246:247], v[246:247] op_sel_hi:[1,0,0]
    v_pk_fma_f32 v[212:213], v[212:213], v[246:247], v[246:247] op_sel_hi:[1,0,0]
    v_pk_fma_f32 v[214:215], v[214:215], v[246:247], v[246:247] op_sel_hi:[1,0,0]
    v_rcp_f32 v208, v208
    v_rcp_f32 v209, v209
    v_rcp_f32 v210, v210
    v_rcp_f32 v211, v211
    v_rcp_f32 v212, v212
    v_rcp_f32 v213, v213
    v_rcp_f32 v214, v214
    v_rcp_f32 v215, v215
    v_pk_mul_f32 v[144:145], v[144:145], v[208:209]
    v_pk_mul_f32 v[146:147], v[146:147], v[210:211]
    v_pk_mul_f32 v[148:149], v[148:149], v[212:213]
    v_pk_mul_f32 v[150:151], v[150:151], v[214:215]
    v_cvt_pk_bf16_f32 v8, v144, v145
    v_cvt_pk_bf16_f32 v9, v146, v147
    v_cvt_pk_bf16_f32 v10, v148, v149
    v_cvt_pk_bf16_f32 v11, v150, v151
    buffer_store_dwordx4 v[8:11], v3, s[4:7], s52 offen offset:0 sc1
    v_pk_mul_f32 v[208:209], v[152:153], v[152:153]
    v_pk_mul_f32 v[210:211], v[154:155], v[154:155]
    v_pk_mul_f32 v[212:213], v[156:157], v[156:157]
    v_pk_mul_f32 v[214:215], v[158:159], v[158:159]
    v_pk_fma_f32 v[208:209], v[208:209], v[244:245], v[244:245] op_sel:[0,1,0] op_sel_hi:[1,1,0]
    v_pk_fma_f32 v[210:211], v[210:211], v[244:245], v[244:245] op_sel:[0,1,0] op_sel_hi:[1,1,0]
    v_pk_fma_f32 v[212:213], v[212:213], v[244:245], v[244:245] op_sel:[0,1,0] op_sel_hi:[1,1,0]
    v_pk_fma_f32 v[214:215], v[214:215], v[244:245], v[244:245] op_sel:[0,1,0] op_sel_hi:[1,1,0]
    v_pk_mul_f32 v[208:209], v[208:209], v[152:153]
    v_pk_mul_f32 v[210:211], v[210:211], v[154:155]
    v_pk_mul_f32 v[212:213], v[212:213], v[156:157]
    v_pk_mul_f32 v[214:215], v[214:215], v[158:159]
    v_exp_f32 v208, v208
    v_exp_f32 v209, v209
    v_exp_f32 v210, v210
    v_exp_f32 v211, v211
    v_exp_f32 v212, v212
    v_exp_f32 v213, v213
    v_exp_f32 v214, v214
    v_exp_f32 v215, v215
    v_pk_fma_f32 v[208:209], v[208:209], v[246:247], v[246:247] op_sel_hi:[1,0,0]
    v_pk_fma_f32 v[210:211], v[210:211], v[246:247], v[246:247] op_sel_hi:[1,0,0]
    v_pk_fma_f32 v[212:213], v[212:213], v[246:247], v[246:247] op_sel_hi:[1,0,0]
    v_pk_fma_f32 v[214:215], v[214:215], v[246:247], v[246:247] op_sel_hi:[1,0,0]
    v_rcp_f32 v208, v208
    v_rcp_f32 v209, v209
    v_rcp_f32 v210, v210
    v_rcp_f32 v211, v211
    v_rcp_f32 v212, v212
    v_rcp_f32 v213, v213
    v_rcp_f32 v214, v214
    v_rcp_f32 v215, v215
    v_pk_mul_f32 v[152:153], v[152:153], v[208:209]
    v_pk_mul_f32 v[154:155], v[154:155], v[210:211]
    v_pk_mul_f32 v[156:157], v[156:157], v[212:213]
    v_pk_mul_f32 v[158:159], v[158:159], v[214:215]
    v_cvt_pk_bf16_f32 v12, v152, v153
    v_cvt_pk_bf16_f32 v13, v154, v155
    v_cvt_pk_bf16_f32 v14, v156, v157
    v_cvt_pk_bf16_f32 v15, v158, v159
    buffer_store_dwordx4 v[12:15], v3, s[4:7], s52 offen offset:2048 sc1
    s_add_u32 s52, s56, 4096
    v_pk_mul_f32 v[208:209], v[160:161], v[160:161]
    v_pk_mul_f32 v[210:211], v[162:163], v[162:163]
    v_pk_mul_f32 v[212:213], v[164:165], v[164:165]
    v_pk_mul_f32 v[214:215], v[166:167], v[166:167]
    v_pk_fma_f32 v[208:209], v[208:209], v[244:245], v[244:245] op_sel:[0,1,0] op_sel_hi:[1,1,0]
    v_pk_fma_f32 v[210:211], v[210:211], v[244:245], v[244:245] op_sel:[0,1,0] op_sel_hi:[1,1,0]
    v_pk_fma_f32 v[212:213], v[212:213], v[244:245], v[244:245] op_sel:[0,1,0] op_sel_hi:[1,1,0]
    v_pk_fma_f32 v[214:215], v[214:215], v[244:245], v[244:245] op_sel:[0,1,0] op_sel_hi:[1,1,0]
    v_pk_mul_f32 v[208:209], v[208:209], v[160:161]
    v_pk_mul_f32 v[210:211], v[210:211], v[162:163]
    v_pk_mul_f32 v[212:213], v[212:213], v[164:165]
    v_pk_mul_f32 v[214:215], v[214:215], v[166:167]
    v_exp_f32 v208, v208
    v_exp_f32 v209, v209
    v_exp_f32 v210, v210
    v_exp_f32 v211, v211
    v_exp_f32 v212, v212
    s_branch L_skip8
.p2align 12
L_stub8:
    s_setpc_b64 s[56:57]
    s_nop 0
L_skip8:
    v_exp_f32 v213, v213
    v_exp_f32 v214, v214
    v_exp_f32_e64 v215, v215
    v_pk_fma_f32 v[208:209], v[208:209], v[246:247], v[246:247] op_sel_hi:[1,0,0]
    v_pk_fma_f32 v[210:211], v[210:211], v[246:247], v[246:247] op_sel_hi:[1,0,0]
    v_pk_fma_f32 v[212:213], v[212:213], v[246:247], v[246:247] op_sel_hi:[1,0,0]
    v_pk_fma_f32 v[214:215], v[214:215], v[246:247], v[246:247] op_sel_hi:[1,0,0]
    v_rcp_f32 v208, v208
    v_rcp_f32 v209, v209
    v_rcp_f32 v210, v210
    v_rcp_f32 v211, v211
    v_rcp_f32 v212, v212
    v_rcp_f32 v213, v213
    v_rcp_f32 v214, v214
    v_rcp_f32 v215, v215
    v_pk_mul_f32 v[160:161], v[160:161], v[208:209]
    v_pk_mul_f32 v[162:163], v[162:163], v[210:211]
    v_pk_mul_f32 v[164:165], v[164:165], v[212:213]
    v_pk_mul_f32 v[166:167], v[166:167], v[214:215]
    v_cvt_pk_bf16_f32 v8, v160, v161
    v_cvt_pk_bf16_f32 v9, v162, v163
    v_cvt_pk_bf16_f32 v10, v164, v165
    v_cvt_pk_bf16_f32 v11, v166, v167
    buffer_store_dwordx4 v[8:11], v3, s[4:7], s52 offen offset:0 sc1
    v_pk_mul_f32 v[208:209], v[168:169], v[168:169]
    v_pk_mul_f32 v[210:211], v[170:171], v[170:171]
    v_pk_mul_f32 v[212:213], v[172:173], v[172:173]
    v_pk_mul_f32 v[214:215], v[174:175], v[174:175]
    v_pk_fma_f32 v[208:209], v[208:209], v[244:245], v[244:245] op_sel:[0,1,0] op_sel_hi:[1,1,0]
    v_pk_fma_f32 v[210:211], v[210:211], v[244:245], v[244:245] op_sel:[0,1,0] op_sel_hi:[1,1,0]
    v_pk_fma_f32 v[212:213], v[212:213], v[244:245], v[244:245] op_sel:[0,1,0] op_sel_hi:[1,1,0]
    v_pk_fma_f32 v[214:215], v[214:215], v[244:245], v[244:245] op_sel:[0,1,0] op_sel_hi:[1,1,0]
    v_pk_mul_f32 v[208:209], v[208:209], v[168:169]
    v_pk_mul_f32 v[210:211], v[210:211], v[170:171]
    v_pk_mul_f32 v[212:213], v[212:213], v[172:173]
    v_pk_mul_f32 v[214:215], v[214:215], v[174:175]
    v_exp_f32 v208, v208
    v_exp_f32 v209, v209
    v_exp_f32 v210, v210
    v_exp_f32 v211, v211
    v_exp_f32 v212, v212
    v_exp_f32 v213, v213
    v_exp_f32 v214, v214
    v_exp_f32 v215, v215
    v_pk_fma_f32 v[208:209], v[208:209], v[246:247], v[246:247] op_sel_hi:[1,0,0]
    v_pk_fma_f32 v[210:211], v[210:211], v[246:247], v[246:247] op_sel_hi:[1,0,0]
    v_pk_fma_f32 v[212:213], v[212:213], v[246:247], v[246:247] op_sel_hi:[1,0,0]
    v_pk_fma_f32 v[214:215], v[214:215], v[246:247], v[246:247] op_sel_hi:[1,0,0]
    v_rcp_f32 v208, v208
    v_rcp_f32 v209, v209
    v_rcp_f32 v210, v210
    v_rcp_f32 v211, v211
    v_rcp_f32 v212, v212
    v_rcp_f32 v213, v213
    v_rcp_f32 v214, v214
    v_rcp_f32 v215, v215
    v_pk_mul_f32 v[168:169], v[168:169], v[208:209]
    v_pk_mul_f32 v[170:171], v[170:171], v[210:211]
    v_pk_mul_f32 v[172:173], v[172:173], v[212:213]
    v_pk_mul_f32 v[174:175], v[174:175], v[214:215]
    v_cvt_pk_bf16_f32 v12, v168, v169
    v_cvt_pk_bf16_f32 v13, v170, v171
    v_cvt_pk_bf16_f32 v14, v172, v173
    v_cvt_pk_bf16_f32 v15, v174, v175
    buffer_store_dwordx4 v[12:15], v3, s[4:7], s52 offen offset:2048 sc1
    s_barrier
    s_waitcnt lgkmcnt(15)
    v_mfma_f32_32x32x16_bf16 v[176:191], a[224:227], v[32:35], 0
    ds_read_b64_tr_b16 a[224:225], v4 offset:16384
    ds_read_b64_tr_b16 a[226:227], v4 offset:18432
    s_add_u32 m0, s67, 0xffff2000
    s_add_u32 s64, s50, 229376
    buffer_load_dwordx4 v248, s[32:35], s64 offen offset:0 lds
    s_waitcnt vmcnt(5)
    ds_read_b64_tr_b16 a[96:97], v253 offset:0
    v_mfma_f32_32x32x16_bf16 v[176:191], a[228:231], v[36:39], v[176:191]
    ds_read_b64_tr_b16 a[228:229], v4 offset:17408
    ds_read_b64_tr_b16 a[230:231], v4 offset:19456
    buffer_load_dwordx4 v249, s[32:35], s64 offen offset:1024 lds
    ds_read_b64_tr_b16 a[98:99], v253 offset:1024
    s_waitcnt lgkmcnt(15)
    v_mfma_f32_32x32x16_bf16 v[176:191], a[232:235], v[40:43], v[176:191]
    ds_read_b64_tr_b16 a[232:233], v4 offset:20480
    ds_read_b64_tr_b16 a[234:235], v4 offset:22528
    ds_read_b64_tr_b16 a[100:101], v253 offset:32
    v_mfma_f32_32x32x16_bf16 v[176:191], a[236:239], v[44:47], v[176:191]
    ds_read_b64_tr_b16 a[236:237], v4 offset:21504
    ds_read_b64_tr_b16 a[238:239], v4 offset:23552
    buffer_load_dwordx4 v250, s[32:35], s64 offen offset:2048 lds
    ds_read_b64_tr_b16 a[102:103], v253 offset:1056
    s_waitcnt lgkmcnt(15)
    v_mfma_f32_32x32x16_bf16 v[176:191], a[240:243], v[48:51], v[176:191]
    ds_read_b64_tr_b16 a[240:241], v4 offset:24576
    ds_read_b64_tr_b16 a[242:243], v4 offset:26624
    ds_read_b64_tr_b16 a[104:105], v252 offset:0
    v_mfma_f32_32x32x16_bf16 v[176:191], a[244:247], v[52:55], v[176:191]
    ds_read_b64_tr_b16 a[244:245], v4 offset:25600
    ds_read_b64_tr_b16 a[246:247], v4 offset:27648
    buffer_load_dwordx4 v251, s[32:35], s64 offen offset:3072 lds
    ds_read_b64_tr_b16 a[106:107], v252 offset:1024
    v_mfma_f32_32x32x16_bf16 v[176:191], a[248:251], v[56:59], v[176:191]
    ds_read_b64_tr_b16 a[248:249], v4 offset:28672
    ds_read_b64_tr_b16 a[250:251], v4 offset:30720
    s_add_u32 m0, s67, 0xffff3000
    s_add_u32 s64, s50, 286720
    buffer_load_dwordx4 v248, s[32:35], s64 offen offset:0 lds
    ds_read_b64_tr_b16 a[108:109], v252 offset:32
    v_mfma_f32_32x32x16_bf16 v[176:191], a[252:255], v[60:63], v[176:191]
    ds_read_b64_tr_b16 a[252:253], v4 offset:29696
    ds_read_b64_tr_b16 a[254:255], v4 offset:31744
    ds_read_b64_tr_b16 a[110:111], v252 offset:1056
    s_waitcnt lgkmcnt(15)
    v_mfma_f32_32x32x16_bf16 v[176:191], a[224:227], v[64:67], v[176:191]
    ds_read_b64_tr_b16 a[224:225], v4 offset:32768
    ds_read_b64_tr_b16 a[226:227], v4 offset:34816
    buffer_load_dwordx4 v249, s[32:35], s64 offen offset:1024 lds
    ds_read_b64_tr_b16 a[112:113], v253 offset:4096
    v_mfma_f32_32x32x16_bf16 v[176:191], a[228:231], v[68:71], v[176:191]
    ds_read_b64_tr_b16 a[228:229], v4 offset:33792
    ds_read_b64_tr_b16 a[230:231], v4 offset:35840
    ds_read_b64_tr_b16 a[114:115], v253 offset:5120
    s_waitcnt lgkmcnt(15)
    v_mfma_f32_32x32x16_bf16 v[176:191], a[232:235], v[72:75], v[176:191]
    ds_read_b64_tr_b16 a[232:233], v4 offset:36864
    ds_read_b64_tr_b16 a[234:235], v4 offset:38912
    buffer_load_dwordx4 v250, s[32:35], s64 offen offset:2048 lds
    ds_read_b64_tr_b16 a[116:117], v253 offset:4128
    v_mfma_f32_32x32x16_bf16 v[176:191], a[236:239], v[76:79], v[176:191]
    ds_read_b64_tr_b16 a[236:237], v4 offset:37888
    ds_read_b64_tr_b16 a[238:239], v4 offset:39936
    buffer_load_dwordx4 v251, s[32:35], s64 offen offset:3072 lds
    ds_read_b64_tr_b16 a[118:119], v253 offset:5152
    s_waitcnt lgkmcnt(15)
    v_mfma_f32_32x32x16_bf16 v[176:191], a[240:243], v[80:83], v[176:191]
    ds_read_b64_tr_b16 a[240:241], v4 offset:40960
    ds_read_b64_tr_b16 a[242:243], v4 offset:43008
    ds_read_b64_tr_b16 a[120:121], v252 offset:4096
    v_mfma_f32_32x32x16_bf16 v[176:191], a[244:247], v[84:87], v[176:191]
    ds_read_b64_tr_b16 a[244:245], v4 offset:41984
    ds_read_b64_tr_b16 a[246:247], v4 offset:44032
    s_add_u32 m0, s67, 0xffff4000
    s_add_u32 s64, s50, 344064
    buffer_load_dwordx4 v248, s[32:35], s64 offen offset:0 lds
    ds_read_b64_tr_b16 a[122:123], v252 offset:5120
    s_waitcnt lgkmcnt(15)
    v_mfma_f32_32x32x16_bf16 v[176:191], a[248:251], v[88:91], v[176:191]
    ds_read_b64_tr_b16 a[248:249], v4 offset:45056
    ds_read_b64_tr_b16 a[250:251], v4 offset:47104
    ds_read_b64_tr_b16 a[124:125], v252 offset:4128
    v_mfma_f32_32x32x16_bf16 v[176:191], a[252:255], v[92:95], v[176:191]
    ds_read_b64_tr_b16 a[252:253], v4 offset:46080
    ds_read_b64_tr_b16 a[254:255], v4 offset:48128
    buffer_load_dwordx4 v249, s[32:35], s64 offen offset:1024 lds
    ds_read_b64_tr_b16 a[126:127], v252 offset:5152
    s_waitcnt lgkmcnt(15)
    v_mfma_f32_32x32x16_bf16 v[176:191], a[224:227], v[96:99], v[176:191]
    ds_read_b64_tr_b16 a[224:225], v4 offset:49152
    ds_read_b64_tr_b16 a[226:227], v4 offset:51200
    buffer_load_dwordx4 v250, s[32:35], s64 offen offset:2048 lds
    s_lshl_b32 s54, s40, 4
    v_add_lshl_u32 v254, s54, v1, 8
    v_and_b32 v0, 0xcff, v2
    v_mfma_f32_32x32x16_bf16 v[176:191], a[228:231], v[100:103], v[176:191]
    ds_read_b64_tr_b16 a[228:229], v4 offset:50176
    ds_read_b64_tr_b16 a[230:231], v4 offset:52224
    s_mul_i32 s58, s42, 229376
    s_mul_i32 s53, s44, 28672
    s_add_u32 s58, s58, s53
    s_waitcnt lgkmcnt(15)
    v_mfma_f32_32x32x16_bf16 v[176:191], a[232:235], v[104:107], v[176:191]
    ds_read_b64_tr_b16 a[232:233], v4 offset:53248
    ds_read_b64_tr_b16 a[234:235], v4 offset:55296
    buffer_load_dwordx4 v251, s[32:35], s64 offen offset:3072 lds
    s_add_u32 s58, s58, 15728640
    s_lshl_b32 s59, s43, 12
    s_add_u32 s59, s59, s58
    v_mfma_f32_32x32x16_bf16 v[176:191], a[236:239], v[108:111], v[176:191]
    ds_read_b64_tr_b16 a[236:237], v4 offset:54272
    ds_read_b64_tr_b16 a[238:239], v4 offset:56320
    s_and_b32 s49, s43, 3
    s_lshl_b32 s53, s49, 8
    v_add_u32 v0, s53, v0
    s_waitcnt lgkmcnt(15)
    v_mfma_f32_32x32x16_bf16 v[176:191], a[240:243], v[112:115], v[176:191]
    ds_read_b64_tr_b16 a[240:241], v5 offset:0
    ds_read_b64_tr_b16 a[242:243], v5 offset:2048
    s_waitcnt vmcnt(12)
    s_barrier
    s_cmp_lg_u32 s44, 0
    s_cbranch_scc1 L_sig_75
    s_lshl_b32 s51, s3, 8
    s_add_u32 s51, s51, 393216
    v_mov_b32_e64 v242, s45
    v_lshlrev_b32 v243, 2, v1
    s_mov_b32 exec_hi, 0
    buffer_store_dword v242, v243, s[4:7], s51 offen sc1
    s_mov_b32 exec_hi, -1
L_sig_75:
    v_mfma_f32_32x32x16_bf16 v[176:191], a[244:247], v[116:119], v[176:191]
    ds_read_b64_tr_b16 a[244:245], v5 offset:1024
    ds_read_b64_tr_b16 a[246:247], v5 offset:3072
    s_waitcnt lgkmcnt(12)
    s_add_u32 m0, s67, 0x00000000
    s_add_u32 s64, s50, 57344
    buffer_load_dwordx4 v248, s[32:35], s64 offen offset:0 lds
    v_mfma_f32_32x32x16_bf16 v[176:191], a[248:251], v[120:123], v[176:191]
    ds_read_b64_tr_b16 a[248:249], v5 offset:4096
    ds_read_b64_tr_b16 a[250:251], v5 offset:6144
    v_mfma_f32_32x32x16_bf16 v[176:191], a[252:255], v[124:127], v[176:191]
    ds_read_b64_tr_b16 a[252:253], v5 offset:5120
    ds_read_b64_tr_b16 a[254:255], v5 offset:7168
    buffer_load_dwordx4 v249, s[32:35], s64 offen offset:1024 lds
    s_waitcnt lgkmcnt(12)
    v_mfma_f32_32x32x16_bf16 v[176:191], a[224:227], v[128:131], v[176:191]
    ds_read_b64_tr_b16 a[224:225], v5 offset:8192
    ds_read_b64_tr_b16 a[226:227], v5 offset:10240
    s_lshl_b32 s53, s40, 1
    s_lshr_b32 s54, s44, 1
    s_add_u32 s53, s53, s54
    v_mfma_f32_32x32x16_bf16 v[176:191], a[228:231], v[132:135], v[176:191]
    ds_read_b64_tr_b16 a[228:229], v5 offset:9216
    ds_read_b64_tr_b16 a[230:231], v5 offset:11264
    s_lshl_b32 s54, s41, 12
    s_add_u32 s54, s54, s57
    s_mul_i32 s56, s53, 57344
    buffer_load_dwordx4 v250, s[32:35], s64 offen offset:2048 lds
    s_waitcnt lgkmcnt(12)
    v_mfma_f32_32x32x16_bf16 v[176:191], a[232:235], v[136:139], v[176:191]
    ds_read_b64_tr_b16 a[232:233], v5 offset:12288
    ds_read_b64_tr_b16 a[234:235], v5 offset:14336
    s_add_u32 s56, s56, s54
    s_mul_i32 s52, s40, 229376
    s_add_u32 s52, s52, s56
    v_mfma_f32_32x32x16_bf16 v[176:191], a[236:239], v[140:143], v[176:191]
    ds_read_b64_tr_b16 a[236:237], v5 offset:13312
    ds_read_b64_tr_b16 a[238:239], v5 offset:15360
    s_add_u32 s56, s52, 1163264
    s_add_u32 s52, s52, 1048576
    buffer_load_dwordx4 v251, s[32:35], s64 offen offset:3072 lds
    s_waitcnt lgkmcnt(12)
    v_mfma_f32_32x32x16_bf16 v[192:207], a[240:243], v[32:35], v[192:207]
    ds_read_b64_tr_b16 a[240:241], v5 offset:16384
    ds_read_b64_tr_b16 a[242:243], v5 offset:18432
    v_mfma_f32_32x32x16_bf16 v[192:207], a[244:247], v[36:39], v[192:207]
    s_nop 0
    ds_read_b64_tr_b16 a[244:245], v5 offset:17408
    ds_read_b64_tr_b16 a[246:247], v5 offset:19456
    s_add_u32 m0, s67, 0x00001000
    s_add_u32 s64, s50, 114688
    buffer_load_dwordx4 v248, s[32:35], s64 offen offset:0 lds
    s_waitcnt lgkmcnt(12)
    v_mfma_f32_32x32x16_bf16 v[192:207], a[248:251], v[40:43], v[192:207]
    ds_read_b64_tr_b16 a[248:249], v5 offset:20480
    ds_read_b64_tr_b16 a[250:251], v5 offset:22528
    v_fmac_f32 v176, v224, v240
    v_fmac_f32_e64 v177, v225, v240
    v_mfma_f32_32x32x16_bf16 v[192:207], a[252:255], v[44:47], v[192:207]
    ds_read_b64_tr_b16 a[252:253], v5 offset:21504
    ds_read_b64_tr_b16 a[254:255], v5 offset:23552
    buffer_load_dwordx4 v249, s[32:35], s64 offen offset:1024 lds
    v_fmac_f32 v178, v226, v240
    v_fmac_f32 v179, v227, v240
    v_fmac_f32 v180, v228, v240
    s_waitcnt lgkmcnt(12)
    v_mfma_f32_32x32x16_bf16 v[192:207], a[224:227], v[48:51], v[192:207]
    ds_read_b64_tr_b16 a[224:225], v5 offset:24576
    ds_read_b64_tr_b16 a[226:227], v5 offset:26624
    v_fmac_f32 v181, v229, v240
    v_fmac_f32 v182, v230, v240
    v_fmac_f32_e64 v183, v231, v240
    v_mfma_f32_32x32x16_bf16 v[192:207], a[228:231], v[52:55], v[192:207]
    ds_read_b64_tr_b16 a[228:229], v5 offset:25600
    ds_read_b64_tr_b16 a[230:231], v5 offset:27648
    buffer_load_dwordx4 v250, s[32:35], s64 offen offset:2048 lds
    v_fmac_f32 v184, v232, v240
    v_fmac_f32 v185, v233, v240
    v_fmac_f32 v186, v234, v240
    s_waitcnt lgkmcnt(12)
    v_mfma_f32_32x32x16_bf16 v[192:207], a[232:235], v[56:59], v[192:207]
    ds_read_b64_tr_b16 a[232:233], v5 offset:28672
    ds_read_b64_tr_b16 a[234:235], v5 offset:30720
    v_fmac_f32 v187, v235, v240
    v_fmac_f32 v188, v236, v240
    v_fmac_f32_e64 v189, v237, v240
    v_mfma_f32_32x32x16_bf16 v[192:207], a[236:239], v[60:63], v[192:207]
    ds_read_b64_tr_b16 a[236:237], v5 offset:29696
    ds_read_b64_tr_b16 a[238:239], v5 offset:31744
    buffer_load_dwordx4 v251, s[32:35], s64 offen offset:3072 lds
    v_fmac_f32 v190, v238, v240
    v_fmac_f32 v191, v239, v240
    v_mul_f32 v208, v176, v176
    s_waitcnt lgkmcnt(12)
    v_mfma_f32_32x32x16_bf16 v[192:207], a[240:243], v[64:67], v[192:207]
    ds_read_b64_tr_b16 a[240:241], v5 offset:32768
    ds_read_b64_tr_b16 a[242:243], v5 offset:34816
    v_mul_f32 v209, v177, v177
    v_mul_f32 v210, v178, v178
    v_mul_f32_e64 v211, v179, v179
    v_mfma_f32_32x32x16_bf16 v[192:207], a[244:247], v[68:71], v[192:207]
    ds_read_b64_tr_b16 a[244:245], v5 offset:33792
    ds_read_b64_tr_b16 a[246:247], v5 offset:35840
    s_add_u32 m0, s67, 0x00002000
    s_add_u32 s64, s50, 172032
    buffer_load_dwordx4 v248, s[32:35], s64 offen offset:0 lds
    v_mul_f32 v212, v180, v180
    v_mul_f32 v213, v181, v181
    v_mul_f32 v214, v182, v182
    s_waitcnt lgkmcnt(12)
    v_mfma_f32_32x32x16_bf16 v[192:207], a[248:251], v[72:75], v[192:207]
    ds_read_b64_tr_b16 a[248:249], v5 offset:36864
    ds_read_b64_tr_b16 a[250:251], v5 offset:38912
    v_mul_f32_e64 v215, v183, v183
    v_fma_f32 v208, v208, v245, v244
    v_fma_f32 v209, v209, v245, v244
    v_mfma_f32_32x32x16_bf16 v[192:207], a[252:255], v[76:79], v[192:207]
    ds_read_b64_tr_b16 a[252:253], v5 offset:37888
    ds_read_b64_tr_b16 a[254:255], v5 offset:39936
    buffer_load_dwordx4 v249, s[32:35], s64 offen offset:1024 lds
    v_fma_f32 v210, v210, v245, v244
    v_fma_f32 v211, v211, v245, v244
    v_fma_f32 v212, v212, v245, v244
    s_waitcnt lgkmcnt(12)
    v_mfma_f32_32x32x16_bf16 v[192:207], a[224:227], v[80:83], v[192:207]
    ds_read_b64_tr_b16 a[224:225], v5 offset:40960
    ds_read_b64_tr_b16 a[226:227], v5 offset:43008
    v_fma_f32 v213, v213, v245, v244
    v_fma_f32 v214, v214, v245, v244
    v_fma_f32 v215, v215, v245, v244
    v_mfma_f32_32x32x16_bf16 v[192:207], a[228:231], v[84:87], v[192:207]
    ds_read_b64_tr_b16 a[228:229], v5 offset:41984
    ds_read_b64_tr_b16 a[230:231], v5 offset:44032
    buffer_load_dwordx4 v250, s[32:35], s64 offen offset:2048 lds
    v_mul_f32 v208, v208, v176
    v_mul_f32_e64 v209, v209, v177
    v_mul_f32 v210, v210, v178
    s_waitcnt lgkmcnt(12)
    v_mfma_f32_32x32x16_bf16 v[192:207], a[232:235], v[88:91], v[192:207]
    ds_read_b64_tr_b16 a[232:233], v5 offset:45056
    ds_read_b64_tr_b16 a[234:235], v5 offset:47104
    v_mul_f32 v211, v211, v179
    v_mul_f32 v212, v212, v180
    v_mul_f32_e64 v213, v213, v181
    v_mfma_f32_32x32x16_bf16 v[192:207], a[236:239], v[92:95], v[192:207]
    ds_read_b64_tr_b16 a[236:237], v5 offset:46080
    ds_read_b64_tr_b16 a[238:239], v5 offset:48128
    buffer_load_dwordx4 v251, s[32:35], s64 offen offset:3072 lds
    v_mul_f32 v214, v214, v182
    v_mul_f32 v215, v215, v183
    v_exp_f32 v208, v208
    s_waitcnt lgkmcnt(12)
    v_mfma_f32_32x32x16_bf16 v[192:207], a[240:243], v[96:99], v[192:207]
    ds_read_b64_tr_b16 a[240:241], v5 offset:49152
    ds_read_b64_tr_b16 a[242:243], v5 offset:51200
    v_exp_f32 v209, v209
    v_exp_f32 v210, v210
    v_exp_f32_e64 v211, v211
    v_mfma_f32_32x32x16_bf16 v[192:207], a[244:247], v[100:103], v[192:207]
    ds_read_b64_tr_b16 a[244:245], v5 offset:50176
    ds_read_b64_tr_b16 a[246:247], v5 offset:52224
    v_exp_f32 v212, v212
    v_exp_f32 v213, v213
    v_exp_f32 v214, v214
    s_waitcnt lgkmcnt(12)
    v_mfma_f32_32x32x16_bf16 v[192:207], a[248:251], v[104:107], v[192:207]
    ds_read_b64_tr_b16 a[248:249], v5 offset:53248
    ds_read_b64_tr_b16 a[250:251], v5 offset:55296
    v_exp_f32_e64 v215, v215
    v_fma_f32 v208, v208, v246, v246
    v_fma_f32 v209, v209, v246, v246
    v_mfma_f32_32x32x16_bf16 v[192:207], a[252:255], v[108:111], v[192:207]
    ds_read_b64_tr_b16 a[252:253], v5 offset:54272
    ds_read_b64_tr_b16 a[254:255], v5 offset:56320
    v_fma_f32 v210, v210, v246, v246
    v_fma_f32 v211, v211, v246, v246
    v_fma_f32 v212, v212, v246, v246
    s_waitcnt lgkmcnt(12)
    v_mfma_f32_32x32x16_bf16 v[192:207], a[224:227], v[112:115], v[192:207]
    v_fma_f32 v213, v213, v246, v246
    v_fma_f32 v214, v214, v246, v246
    v_fma_f32 v215, v215, v246, v246
    v_mfma_f32_32x32x16_bf16 v[192:207], a[228:231], v[116:119], v[192:207]
    v_rcp_f32 v208, v208
    v_rcp_f32_e64 v209, v209
    v_rcp_f32 v210, v210
    s_waitcnt lgkmcnt(8)
    v_mfma_f32_32x32x16_bf16 v[192:207], a[232:235], v[120:123], v[192:207]
    v_rcp_f32 v211, v211
    v_rcp_f32 v212, v212
    v_rcp_f32_e64 v213, v213
    v_mfma_f32_32x32x16_bf16 v[192:207], a[236:239], v[124:127], v[192:207]
    v_rcp_f32 v214, v214
    v_rcp_f32 v215, v215
    v_mul_f32 v176, v176, v208
    s_waitcnt lgkmcnt(4)
    v_mfma_f32_32x32x16_bf16 v[192:207], a[240:243], v[128:131], v[192:207]
    v_mul_f32 v177, v177, v209
    v_mul_f32 v178, v178, v210
    v_mul_f32_e64 v179, v179, v211
    v_mfma_f32_32x32x16_bf16 v[192:207], a[244:247], v[132:135], v[192:207]
    v_mul_f32 v180, v180, v212
    v_mul_f32 v181, v181, v213
    v_mul_f32 v182, v182, v214
    s_waitcnt lgkmcnt(0)
    v_mfma_f32_32x32x16_bf16 v[192:207], a[248:251], v[136:139], v[192:207]
    v_mul_f32_e64 v183, v183, v215
    v_cvt_pk_bf16_f32 v8, v176, v177
    v_cvt_pk_bf16_f32 v9, v178, v179
    v_mfma_f32_32x32x16_bf16 v[192:207], a[252:255], v[140:143], v[192:207]
    v_cvt_pk_bf16_f32 v10, v180, v181
    v_cvt_pk_bf16_f32 v11, v182, v183
    s_cmp_lg_u32 s60, 0
    s_cbranch_scc0 L_fs_76
    buffer_store_dwordx4 v[8:11], v3, s[4:7], s52 offen offset:0
    s_branch L_fe_77
L_fs_76:
    s_nop 0
    buffer_store_dwordx4 v[8:11], v3, s[4:7], s52 offen offset:0 sc1
L_fe_77:
    v_pk_mul_f32 v[208:209], v[184:185], v[184:185]
    v_pk_mul_f32 v[210:211], v[186:187], v[186:187]
    v_pk_mul_f32 v[212:213], v[188:189], v[188:189]
    v_pk_mul_f32 v[214:215], v[190:191], v[190:191]
    v_pk_fma_f32 v[208:209], v[208:209], v[244:245], v[244:245] op_sel:[0,1,0] op_sel_hi:[1,1,0]
    v_pk_fma_f32 v[210:211], v[210:211], v[244:245], v[244:245] op_sel:[0,1,0] op_sel_hi:[1,1,0]
    v_pk_fma_f32 v[212:213], v[212:213], v[244:245], v[244:245] op_sel:[0,1,0] op_sel_hi:[1,1,0]
    v_pk_fma_f32 v[214:215], v[214:215], v[244:245], v[244:245] op_sel:[0,1,0] op_sel_hi:[1,1,0]
    v_pk_mul_f32 v[208:209], v[208:209], v[184:185]
    v_pk_mul_f32 v[210:211], v[210:211], v[186:187]
    v_pk_mul_f32 v[212:213], v[212:213], v[188:189]
    v_pk_mul_f32 v[214:215], v[214:215], v[190:191]
    v_exp_f32 v208, v208
    v_exp_f32 v209, v209
    v_exp_f32 v210, v210
    v_exp_f32 v211, v211
    v_exp_f32 v212, v212
    v_exp_f32 v213, v213
    v_exp_f32 v214, v214
    v_exp_f32 v215, v215
    v_pk_fma_f32 v[208:209], v[208:209], v[246:247], v[246:247] op_sel_hi:[1,0,0]
    v_pk_fma_f32 v[210:211], v[210:211], v[246:247], v[246:247] op_sel_hi:[1,0,0]
    v_pk_fma_f32 v[212:213], v[212:213], v[246:247], v[246:247] op_sel_hi:[1,0,0]
    v_pk_fma_f32 v[214:215], v[214:215], v[246:247], v[246:247] op_sel_hi:[1,0,0]
    v_rcp_f32 v208, v208
    v_rcp_f32 v209, v209
    v_rcp_f32 v210, v210
    v_rcp_f32 v211, v211
    v_rcp_f32 v212, v212
    v_rcp_f32 v213, v213
    v_rcp_f32 v214, v214
    v_rcp_f32 v215, v215
    v_pk_mul_f32 v[184:185], v[184:185], v[208:209]
    v_pk_mul_f32 v[186:187], v[186:187], v[210:211]
    v_pk_mul_f32 v[188:189], v[188:189], v[212:213]
    v_pk_mul_f32 v[190:191], v[190:191], v[214:215]
    v_cvt_pk_bf16_f32 v12, v184, v185
    v_cvt_pk_bf16_f32 v13, v186, v187
    v_cvt_pk_bf16_f32 v14, v188, v189
    v_cvt_pk_bf16_f32 v15, v190, v191
    s_cmp_lg_u32 s60, 0
    s_cbranch_scc0 L_fs_78
    buffer_store_dwordx4 v[12:15], v3, s[4:7], s52 offen offset:2048
    s_branch L_fe_79
L_fs_78:
    buffer_store_dwordx4 v[12:15], v3, s[4:7], s52 offen offset:2048 sc1
L_fe_79:
    s_mov_b32 s63, 393216
    s_mov_b64 exec, 0x3fff
    buffer_load_dword v255, v254, s[4:7], s63 offen sc1
    s_mov_b64 exec, -1
    v_pk_mul_f32 v[208:209], v[192:193], v[192:193]
    v_pk_mul_f32 v[210:211], v[194:195], v[194:195]
    v_pk_mul_f32 v[212:213], v[196:197], v[196:197]
    v_pk_mul_f32 v[214:215], v[198:199], v[198:199]
    v_pk_fma_f32 v[208:209], v[208:209], v[244:245], v[244:245] op_sel:[0,1,0] op_sel_hi:[1,1,0]
    v_pk_fma_f32 v[210:211], v[210:211], v[244:245], v[244:245] op_sel:[0,1,0] op_sel_hi:[1,1,0]
    v_pk_fma_f32 v[212:213], v[212:213], v[244:245], v[244:245] op_sel:[0,1,0] op_sel_hi:[1,1,0]
    v_pk_fma_f32 v[214:215], v[214:215], v[244:245], v[244:245] op_sel:[0,1,0] op_sel_hi:[1,1,0]
    v_pk_mul_f32 v[208:209], v[208:209], v[192:193]
    v_pk_mul_f32 v[210:211], v[210:211], v[194:195]
    v_pk_mul_f32 v[212:213], v[212:213], v[196:197]
    v_pk_mul_f32 v[214:215], v[214:215], v[198:199]
    v_exp_f32 v208, v208
    v_exp_f32 v209, v209
    v_exp_f32 v210, v210
    v_exp_f32 v211, v211
    v_exp_f32 v212, v212
    v_exp_f32 v213, v213
    v_exp_f32 v214, v214
    v_exp_f32 v215, v215
    v_pk_fma_f32 v[208:209], v[208:209], v[246:247], v[246:247] op_sel_hi:[1,0,0]
    v_pk_fma_f32 v[210:211], v[210:211], v[246:247], v[246:247] op_sel_hi:[1,0,0]
    v_pk_fma_f32 v[212:213], v[212:213], v[246:247], v[246:247] op_sel_hi:[1,0,0]
    v_pk_fma_f32 v[214:215], v[214:215], v[246:247], v[246:247] op_sel_hi:[1,0,0]
    v_rcp_f32 v208, v208
    v_rcp_f32 v209, v209
    v_rcp_f32 v210, v210
    v_rcp_f32 v211, v211
    v_rcp_f32 v212, v212
    v_rcp_f32 v213, v213
    v_rcp_f32 v214, v214
    v_rcp_f32 v215, v215
    v_pk_mul_f32 v[192:193], v[192:193], v[208:209]
    v_pk_mul_f32 v[194:195], v[194:195], v[210:211]
    v_pk_mul_f32 v[196:197], v[196:197], v[212:213]
    v_pk_mul_f32 v[198:199], v[198:199], v[214:215]
    v_cvt_pk_bf16_f32 v8, v192, v193
    v_cvt_pk_bf16_f32 v9, v194, v195
    v_cvt_pk_bf16_f32 v10, v196, v197
    v_cvt_pk_bf16_f32 v11, v198, v199
    v_pk_mul_f32 v[208:209], v[200:201], v[200:201]
    v_pk_mul_f32 v[210:211], v[202:203], v[202:203]
    v_pk_mul_f32 v[212:213], v[204:205], v[204:205]
    v_pk_mul_f32 v[214:215], v[206:207], v[206:207]
    v_pk_fma_f32 v[208:209], v[208:209], v[244:245], v[244:245] op_sel:[0,1,0] op_sel_hi:[1,1,0]
    v_pk_fma_f32 v[210:211], v[210:211], v[244:245], v[244:245] op_sel:[0,1,0] op_sel_hi:[1,1,0]
    v_pk_fma_f32 v[212:213], v[212:213], v[244:245], v[244:245] op_sel:[0,1,0] op_sel_hi:[1,1,0]
    v_pk_fma_f32 v[214:215], v[214:215], v[244:245], v[244:245] op_sel:[0,1,0] op_sel_hi:[1,1,0]
    v_pk_mul_f32 v[208:209], v[208:209], v[200:201]
    v_pk_mul_f32 v[210:211], v[210:211], v[202:203]
    v_pk_mul_f32 v[212:213], v[212:213], v[204:205]
    v_pk_mul_f32 v[214:215], v[214:215], v[206:207]
    v_exp_f32 v208, v208
    v_exp_f32 v209, v209
    v_exp_f32 v210, v210
    v_exp_f32 v211, v211
    v_exp_f32 v212, v212
    v_exp_f32 v213, v213
    v_exp_f32 v214, v214
    v_exp_f32 v215, v215
    v_pk_fma_f32 v[208:209], v[208:209], v[246:247], v[246:247] op_sel_hi:[1,0,0]
    v_pk_fma_f32 v[210:211], v[210:211], v[246:247], v[246:247] op_sel_hi:[1,0,0]
    v_pk_fma_f32 v[212:213], v[212:213], v[246:247], v[246:247] op_sel_hi:[1,0,0]
    v_pk_fma_f32 v[214:215], v[214:215], v[246:247], v[246:247] op_sel_hi:[1,0,0]
    v_rcp_f32 v208, v208
    v_rcp_f32 v209, v209
    v_rcp_f32 v210, v210
    v_rcp_f32 v211, v211
    v_rcp_f32 v212, v212
    v_rcp_f32 v213, v213
    v_rcp_f32 v214, v214
    v_rcp_f32 v215, v215
    v_pk_mul_f32 v[200:201], v[200:201], v[208:209]
    v_pk_mul_f32 v[202:203], v[202:203], v[210:211]
    v_pk_mul_f32 v[204:205], v[204:205], v[212:213]
    v_pk_mul_f32 v[206:207], v[206:207], v[214:215]
    v_cvt_pk_bf16_f32 v12, v200, v201
    v_cvt_pk_bf16_f32 v13, v202, v203
    v_cvt_pk_bf16_f32 v14, v204, v205
    v_cvt_pk_bf16_f32 v15, v206, v207
    s_mov_b32 s52, s56
    s_mov_b32 s62, 100000
    s_mov_b64 exec, 0x3fff
    s_waitcnt vmcnt(0)
L_wp_80:
    v_cmp_ne_u32 vcc, s45, v255
    s_sub_u32 s62, s62, 1
    s_cbranch_vccz L_wpok_81
    buffer_load_dword v255, v254, s[4:7], s63 offen sc1
    s_waitcnt vmcnt(0)
    s_cmp_gt_i32 s62, 0
    s_cbranch_scc1 L_wp_80
L_wpok_81:
    s_mov_b64 exec, -1
    s_cmp_lg_u32 s60, 0
    s_cbranch_scc0 L_fs_82
    buffer_store_dwordx4 v[8:11], v3, s[4:7], s52 offen offset:0
    buffer_store_dwordx4 v[12:15], v3, s[4:7], s52 offen offset:2048
    s_branch L_fe_83
L_fs_82:
    buffer_store_dwordx4 v[8:11], v3, s[4:7], s52 offen offset:0 sc1
    buffer_store_dwordx4 v[12:15], v3, s[4:7], s52 offen offset:2048 sc1
L_fe_83:
    v_xor_b32 v245, 256, v0
    v_xor_b32 v246, 512, v0
    v_xor_b32 v247, 768, v0
    s_add_u32 s55, s58, 0
    buffer_load_dwordx4 v[144:147], v0, s[4:7], s55 offen sc1
    s_xor_b32 s54, s44, s49
    v_lshrrev_b32_e64 v4, 4, v1
    v_mul_u32_u24 v4, 1040, v4
    v_and_b32_e64 v251, 15, v1
    v_lshl_add_u32 v4, v251, 4, v4
    s_mul_i32 s53, s44, 16640
    buffer_load_dwordx4 v[148:151], v245, s[4:7], s55 offen sc1
    v_add_u32 v4, s53, v4
    v_and_b32 v251, 7, v1
    v_mul_u32_u24 v5, 2080, v251
    v_lshrrev_b32_e64 v7, 3, v1
    v_lshl_add_u32 v5, v7, 4, v5
    s_lshl_b32 s53, s44, 7
    v_add_u32 v5, s53, v5
    buffer_load_dwordx4 v[152:155], v246, s[4:7], s55 offen sc1
    v_mul_u32_u24 v7, 896, v7
    v_lshl_add_u32 v7, v251, 4, v7
    s_lshl_b32 s56, s42, 3
    s_add_u32 s56, s56, s44
    s_lshl_b32 s53, s49, 1
    s_xor_b32 s56, s56, s53
    s_xor_b32 s57, s56, 4
    buffer_load_dwordx4 v[156:159], v247, s[4:7], s55 offen sc1
    s_mul_i32 s56, s56, 7168
    s_mul_i32 s57, s57, 7168
    s_lshl_b32 s53, s43, 7
    s_add_u32 s56, s56, s53
    s_add_u32 s57, s57, s53
    s_add_u32 s59, s73, 1048576
    s_add_u32 s53, s73, 1163264
    s_add_u32 s55, s58, 4096
    buffer_load_dwordx4 v[160:163], v0, s[4:7], s55 offen sc1
    s_cmp_lt_u32 s44, 2
    s_cselect_b32 s59, s59, s53
    s_and_b32 s53, s44, 1
    s_mul_i32 s53, s53, 28672
    s_add_u32 s59, s59, s53
    buffer_load_dwordx4 v[164:167], v245, s[4:7], s55 offen sc1
    ds_read_b64_tr_b16 a[128:129], v253 offset:0
    ds_read_b64_tr_b16 a[130:131], v253 offset:1024
    ds_read_b64_tr_b16 a[132:133], v253 offset:32
    ds_read_b64_tr_b16 a[134:135], v253 offset:1056
    buffer_load_dwordx4 v[168:171], v246, s[4:7], s55 offen sc1
    ds_read_b64_tr_b16 a[136:137], v252 offset:0
    ds_read_b64_tr_b16 a[138:139], v252 offset:1024
    s_branch L_skip9
.p2align 12
L_stub9:
    s_setpc_b64 s[56:57]
    s_nop 0
L_skip9:
    ds_read_b64_tr_b16 a[140:141], v252 offset:32
    ds_read_b64_tr_b16 a[142:143], v252 offset:1056
    buffer_load_dwordx4 v[172:175], v247, s[4:7], s55 offen sc1
    s_waitcnt vmcnt(8)
    s_barrier
    s_cmp_lg_u32 s44, 0
    s_cbranch_scc1 L_sig_84
    s_lshl_b32 s51, s3, 8
    s_add_u32 s51, s51, 458752
    v_mov_b32 v242, s45
    v_lshlrev_b32 v243, 2, v1
    s_mov_b32 exec_hi, 0
    s_cmp_lg_u32 s60, 0
    s_cbranch_scc0 L_fs_85
    buffer_store_dword v242, v243, s[4:7], s51 offen
    s_branch L_fe_86
L_fs_85:
    buffer_store_dword v242, v243, s[4:7], s51 offen sc1
L_fe_86:
    s_mov_b32 exec_hi, -1
L_sig_84:
    ds_read_b64_tr_b16 a[144:145], v253 offset:4096
    ds_read_b64_tr_b16 a[146:147], v253 offset:5120
    ds_read_b64_tr_b16 a[148:149], v253 offset:4128
    ds_read_b64_tr_b16 a[150:151], v253 offset:5152
    s_add_u32 s55, s58, 8192
    buffer_load_dwordx4 v[176:179], v0, s[4:7], s55 offen sc1
    ds_read_b64_tr_b16 a[152:153], v252 offset:4096
    ds_read_b64_tr_b16 a[154:155], v252 offset:5120
    ds_read_b64_tr_b16 a[156:157], v252 offset:4128
    buffer_load_dwordx4 v[180:183], v245, s[4:7], s55 offen sc1
    s_waitcnt vmcnt(9)
    s_cmp_eq_u32 s54, 0
    s_cbranch_scc1 L_rs_87
    v_mfma_f32_16x16x32_bf16 v[32:35], a[0:3], v[144:147], 0
    v_mfma_f32_16x16x32_bf16 v[36:39], a[4:7], v[144:147], 0
    v_mfma_f32_16x16x32_bf16 v[40:43], a[8:11], v[144:147], 0
    v_mfma_f32_16x16x32_bf16 v[44:47], a[12:15], v[144:147], 0
    s_branch L_re_88
L_rs_87:
    s_nop 1
    v_mfma_f32_16x16x32_bf16 v[32:35], a[0:3], v[144:147], v[16:19]
    v_mfma_f32_16x16x32_bf16 v[36:39], a[4:7], v[144:147], v[20:23]
    v_mfma_f32_16x16x32_bf16 v[40:43], a[8:11], v[144:147], v[24:27]
    v_mfma_f32_16x16x32_bf16 v[44:47], a[12:15], v[144:147], v[28:31]
L_re_88:
    buffer_load_dwordx4 v[184:187], v246, s[4:7], s55 offen sc1
    ds_read_b64_tr_b16 a[158:159], v252 offset:5152
    ds_read_b64_tr_b16 a[160:161], v253 offset:8192
    ds_read_b64_tr_b16 a[162:163], v253 offset:9216
    s_waitcnt vmcnt(9)
    s_cmp_eq_u32 s54, 1
    s_cbranch_scc1 L_rs_89
    v_mfma_f32_16x16x32_bf16 v[48:51], a[0:3], v[148:151], 0
    v_mfma_f32_16x16x32_bf16 v[52:55], a[4:7], v[148:151], 0
    v_mfma_f32_16x16x32_bf16 v[56:59], a[8:11], v[148:151], 0
    v_mfma_f32_16x16x32_bf16 v[60:63], a[12:15], v[148:151], 0
    s_branch L_re_90
L_rs_89:
    s_nop 1
    v_mfma_f32_16x16x32_bf16 v[48:51], a[0:3], v[148:151], v[16:19]
    v_mfma_f32_16x16x32_bf16 v[52:55], a[4:7], v[148:151], v[20:23]
    v_mfma_f32_16x16x32_bf16 v[56:59], a[8:11], v[148:151], v[24:27]
    v_mfma_f32_16x16x32_bf16 v[60:63], a[12:15], v[148:151], v[28:31]
L_re_90:
    buffer_load_dwordx4 v[188:191], v247, s[4:7], s55 offen sc1
    s_add_u32 s55, s58, 12288
    ds_read_b64_tr_b16 a[164:165], v253 offset:8224
    ds_read_b64_tr_b16 a[166:167], v253 offset:9248
    s_waitcnt vmcnt(9)
    s_cmp_eq_u32 s54, 2
    s_cbranch_scc1 L_rs_91
    v_mfma_f32_16x16x32_bf16 v[64:67], a[0:3], v[152:155], 0
    v_mfma_f32_16x16x32_bf16 v[68:71], a[4:7], v[152:155], 0
    v_mfma_f32_16x16x32_bf16 v[72:75], a[8:11], v[152:155], 0
    v_mfma_f32_16x16x32_bf16 v[76:79], a[12:15], v[152:155], 0
    s_branch L_re_92
L_rs_91:
    s_nop 1
    v_mfma_f32_16x16x32_bf16 v[64:67], a[0:3], v[152:155], v[16:19]
    v_mfma_f32_16x16x32_bf16 v[68:71], a[4:7], v[152:155], v[20:23]
    v_mfma_f32_16x16x32_bf16 v[72:75], a[8:11], v[152:155], v[24:27]
    v_mfma_f32_16x16x32_bf16 v[76:79], a[12:15], v[152:155], v[28:31]
L_re_92:
    buffer_load_dwordx4 v[192:195], v0, s[4:7], s55 offen sc1
    ds_read_b64_tr_b16 a[168:169], v252 offset:8192
    ds_read_b64_tr_b16 a[170:171], v252 offset:9216
    ds_read_b64_tr_b16 a[172:173], v252 offset:8224
    s_waitcnt vmcnt(9)
    s_cmp_eq_u32 s54, 3
    s_cbranch_scc1 L_rs_93
    v_mfma_f32_16x16x32_bf16 v[80:83], a[0:3], v[156:159], 0
    v_mfma_f32_16x16x32_bf16 v[84:87], a[4:7], v[156:159], 0
    v_mfma_f32_16x16x32_bf16 v[88:91], a[8:11], v[156:159], 0
    v_mfma_f32_16x16x32_bf16 v[92:95], a[12:15], v[156:159], 0
    s_branch L_re_94
L_rs_93:
    s_nop 1
    v_mfma_f32_16x16x32_bf16 v[80:83], a[0:3], v[156:159], v[16:19]
    v_mfma_f32_16x16x32_bf16 v[84:87], a[4:7], v[156:159], v[20:23]
    v_mfma_f32_16x16x32_bf16 v[88:91], a[8:11], v[156:159], v[24:27]
    v_mfma_f32_16x16x32_bf16 v[92:95], a[12:15], v[156:159], v[28:31]
L_re_94:
    buffer_load_dwordx4 v[196:199], v245, s[4:7], s55 offen sc1
    ds_read_b64_tr_b16 a[174:175], v252 offset:9248
    v_add_u32 v253, 0xffff2000, v253
    v_add_u32 v252, 0xffff2000, v252
    ds_read_b64_tr_b16 a[176:177], v253 offset:0
    s_waitcnt vmcnt(9)
    v_mfma_f32_16x16x32_bf16 v[32:35], a[16:19], v[160:163], v[32:35]
    buffer_load_dwordx4 v[200:203], v246, s[4:7], s55 offen sc1
    v_mfma_f32_16x16x32_bf16 v[36:39], a[20:23], v[160:163], v[36:39]
    ds_read_b64_tr_b16 a[178:179], v253 offset:1024
    v_mfma_f32_16x16x32_bf16 v[40:43], a[24:27], v[160:163], v[40:43]
    ds_read_b64_tr_b16 a[180:181], v253 offset:32
    v_mfma_f32_16x16x32_bf16 v[44:47], a[28:31], v[160:163], v[44:47]
    ds_read_b64_tr_b16 a[182:183], v253 offset:1056
    s_waitcnt vmcnt(9)
    v_mfma_f32_16x16x32_bf16 v[48:51], a[16:19], v[164:167], v[48:51]
    s_mov_b32 s63, 458752
    s_mov_b64 exec, 0x3fff
    buffer_load_dword v255, v254, s[4:7], s63 offen sc1
    s_mov_b64 exec, -1
    buffer_load_dwordx4 v[204:207], v247, s[4:7], s55 offen sc1
    v_mfma_f32_16x16x32_bf16 v[52:55], a[20:23], v[164:167], v[52:55]
    s_add_u32 s55, s58, 16384
    v_mfma_f32_16x16x32_bf16 v[56:59], a[24:27], v[164:167], v[56:59]
    ds_read_b64_tr_b16 a[184:185], v252 offset:0
    v_mfma_f32_16x16x32_bf16 v[60:63], a[28:31], v[164:167], v[60:63]
    ds_read_b64_tr_b16 a[186:187], v252 offset:1024
    s_waitcnt vmcnt(10)
    v_mfma_f32_16x16x32_bf16 v[64:67], a[16:19], v[168:171], v[64:67]
    buffer_load_dwordx4 v[208:211], v0, s[4:7], s55 offen sc1
    v_mfma_f32_16x16x32_bf16 v[68:71], a[20:23], v[168:171], v[68:71]
    ds_read_b64_tr_b16 a[188:189], v252 offset:32
    v_mfma_f32_16x16x32_bf16 v[72:75], a[24:27], v[168:171], v[72:75]
    ds_read_b64_tr_b16 a[190:191], v252 offset:1056
    v_mfma_f32_16x16x32_bf16 v[76:79], a[28:31], v[168:171], v[76:79]
    ds_read_b64_tr_b16 a[192:193], v253 offset:4096
    s_waitcnt vmcnt(10)
    v_mfma_f32_16x16x32_bf16 v[80:83], a[16:19], v[172:175], v[80:83]
    buffer_load_dwordx4 v[212:215], v245, s[4:7], s55 offen sc1
    v_mfma_f32_16x16x32_bf16 v[84:87], a[20:23], v[172:175], v[84:87]
    ds_read_b64_tr_b16 a[194:195], v253 offset:5120
    v_mfma_f32_16x16x32_bf16 v[88:91], a[24:27], v[172:175], v[88:91]
    ds_read_b64_tr_b16 a[196:197], v253 offset:4128
    v_mfma_f32_16x16x32_bf16 v[92:95], a[28:31], v[172:175], v[92:95]
    ds_read_b64_tr_b16 a[198:199], v253 offset:5152
    s_waitcnt vmcnt(10)
    v_mfma_f32_16x16x32_bf16 v[32:35], a[32:35], v[176:179], v[32:35]
    buffer_load_dwordx4 v[216:219], v246, s[4:7], s55 offen sc1
    v_mfma_f32_16x16x32_bf16 v[36:39], a[36:39], v[176:179], v[36:39]
    ds_read_b64_tr_b16 a[200:201], v252 offset:4096
    v_mfma_f32_16x16x32_bf16 v[40:43], a[40:43], v[176:179], v[40:43]
    ds_read_b64_tr_b16 a[202:203], v252 offset:5120
    v_mfma_f32_16x16x32_bf16 v[44:47], a[44:47], v[176:179], v[44:47]
    ds_read_b64_tr_b16 a[204:205], v252 offset:4128
    s_waitcnt vmcnt(10)
    v_mfma_f32_16x16x32_bf16 v[48:51], a[32:35], v[180:183], v[48:51]
    buffer_load_dwordx4 v[220:223], v247, s[4:7], s55 offen sc1
    v_mfma_f32_16x16x32_bf16 v[52:55], a[36:39], v[180:183], v[52:55]
    s_add_u32 s55, s58, 20480
    v_mfma_f32_16x16x32_bf16 v[56:59], a[40:43], v[180:183], v[56:59]
    ds_read_b64_tr_b16 a[206:207], v252 offset:5152
    v_mfma_f32_16x16x32_bf16 v[60:63], a[44:47], v[180:183], v[60:63]
    ds_read_b64_tr_b16 a[208:209], v253 offset:8192
    s_waitcnt vmcnt(10)
    v_mfma_f32_16x16x32_bf16 v[64:67], a[32:35], v[184:187], v[64:67]
    buffer_load_dwordx4 v[224:227], v0, s[4:7], s55 offen sc1
    v_mfma_f32_16x16x32_bf16 v[68:71], a[36:39], v[184:187], v[68:71]
    ds_read_b64_tr_b16 a[210:211], v253 offset:9216
    v_mfma_f32_16x16x32_bf16 v[72:75], a[40:43], v[184:187], v[72:75]
    ds_read_b64_tr_b16 a[212:213], v253 offset:8224
    v_mfma_f32_16x16x32_bf16 v[76:79], a[44:47], v[184:187], v[76:79]
    ds_read_b64_tr_b16 a[214:215], v253 offset:9248
    s_waitcnt vmcnt(10)
    v_mfma_f32_16x16x32_bf16 v[80:83], a[32:35], v[188:191], v[80:83]
    buffer_load_dwordx4 v[228:231], v245, s[4:7], s55 offen sc1
    v_mfma_f32_16x16x32_bf16 v[84:87], a[36:39], v[188:191], v[84:87]
    ds_read_b64_tr_b16 a[216:217], v252 offset:8192
    v_mfma_f32_16x16x32_bf16 v[88:91], a[40:43], v[188:191], v[88:91]
    ds_read_b64_tr_b16 a[218:219], v252 offset:9216
    v_mfma_f32_16x16x32_bf16 v[92:95], a[44:47], v[188:191], v[92:95]
    ds_read_b64_tr_b16 a[220:221], v252 offset:8224
    s_waitcnt vmcnt(10)
    v_mfma_f32_16x16x32_bf16 v[32:35], a[48:51], v[192:195], v[32:35]
    buffer_load_dwordx4 v[232:235], v246, s[4:7], s55 offen sc1
    v_mfma_f32_16x16x32_bf16 v[36:39], a[52:55], v[192:195], v[36:39]
    ds_read_b64_tr_b16 a[222:223], v252 offset:9248
    v_mfma_f32_16x16x32_bf16 v[40:43], a[56:59], v[192:195], v[40:43]
    v_mfma_f32_16x16x32_bf16 v[44:47], a[60:63], v[192:195], v[44:47]
    s_waitcnt vmcnt(10)
    v_mfma_f32_16x16x32_bf16 v[48:51], a[48:51], v[196:199], v[48:51]
    buffer_load_dwordx4 v[236:239], v247, s[4:7], s55 offen sc1
    v_mfma_f32_16x16x32_bf16 v[52:55], a[52:55], v[196:199], v[52:55]
    s_add_u32 s55, s58, 24576
    v_mfma_f32_16x16x32_bf16 v[56:59], a[56:59], v[196:199], v[56:59]
    v_mfma_f32_16x16x32_bf16 v[60:63], a[60:63], v[196:199], v[60:63]
    s_waitcnt vmcnt(10)
    v_mfma_f32_16x16x32_bf16 v[64:67], a[48:51], v[200:203], v[64:67]
    buffer_load_dwordx4 v[144:147], v0, s[4:7], s55 offen sc1
    v_mfma_f32_16x16x32_bf16 v[68:71], a[52:55], v[200:203], v[68:71]
    v_mfma_f32_16x16x32_bf16 v[72:75], a[56:59], v[200:203], v[72:75]
    v_mfma_f32_16x16x32_bf16 v[76:79], a[60:63], v[200:203], v[76:79]
    s_waitcnt vmcnt(9)
    v_mfma_f32_16x16x32_bf16 v[80:83], a[48:51], v[204:207], v[80:83]
    buffer_load_dwordx4 v[148:151], v245, s[4:7], s55 offen sc1
    v_mfma_f32_16x16x32_bf16 v[84:87], a[52:55], v[204:207], v[84:87]
    v_mfma_f32_16x16x32_bf16 v[88:91], a[56:59], v[204:207], v[88:91]
    v_mfma_f32_16x16x32_bf16 v[92:95], a[60:63], v[204:207], v[92:95]
    s_waitcnt vmcnt(9)
    v_mfma_f32_16x16x32_bf16 v[32:35], a[64:67], v[208:211], v[32:35]
    s_mov_b32 s62, 100000
    s_mov_b64 exec, 0x3fff
L_wp_95:
    v_cmp_ne_u32 vcc, s45, v255
    s_sub_u32 s62, s62, 1
    s_cbranch_vccz L_wpok_96
    buffer_load_dword v255, v254, s[4:7], s63 offen sc1
    s_waitcnt vmcnt(0)
    s_cmp_gt_i32 s62, 0
    s_cbranch_scc1 L_wp_95
L_wpok_96:
    s_mov_b64 exec, -1
    buffer_load_dwordx4 v[152:155], v246, s[4:7], s55 offen sc1
    v_mfma_f32_16x16x32_bf16 v[36:39], a[68:71], v[208:211], v[36:39]
    v_mfma_f32_16x16x32_bf16 v[40:43], a[72:75], v[208:211], v[40:43]
    v_mfma_f32_16x16x32_bf16 v[44:47], a[76:79], v[208:211], v[44:47]
    s_waitcnt vmcnt(9)
    v_mfma_f32_16x16x32_bf16 v[48:51], a[64:67], v[212:215], v[48:51]
    buffer_load_dwordx4 v[156:159], v247, s[4:7], s55 offen sc1
    v_mfma_f32_16x16x32_bf16 v[52:55], a[68:71], v[212:215], v[52:55]
    s_add_u32 s55, s59, 0
    v_mfma_f32_16x16x32_bf16 v[56:59], a[72:75], v[212:215], v[56:59]
    v_mfma_f32_16x16x32_bf16 v[60:63], a[76:79], v[212:215], v[60:63]
    s_waitcnt vmcnt(9)
    v_mfma_f32_16x16x32_bf16 v[64:67], a[64:67], v[216:219], v[64:67]
    buffer_load_dwordx4 v[160:163], v0, s[4:7], s55 offen sc1
    v_mfma_f32_16x16x32_bf16 v[68:71], a[68:71], v[216:219], v[68:71]
    s_add_u32 s55, s59, 4096
    v_mfma_f32_16x16x32_bf16 v[72:75], a[72:75], v[216:219], v[72:75]
    v_mfma_f32_16x16x32_bf16 v[76:79], a[76:79], v[216:219], v[76:79]
    s_waitcnt vmcnt(9)
    v_mfma_f32_16x16x32_bf16 v[80:83], a[64:67], v[220:223], v[80:83]
    buffer_load_dwordx4 v[164:167], v0, s[4:7], s55 offen sc1
    v_mfma_f32_16x16x32_bf16 v[84:87], a[68:71], v[220:223], v[84:87]
    s_add_u32 s55, s59, 8192
    v_mfma_f32_16x16x32_bf16 v[88:91], a[72:75], v[220:223], v[88:91]
    v_mfma_f32_16x16x32_bf16 v[92:95], a[76:79], v[220:223], v[92:95]
    s_waitcnt vmcnt(9)
    v_mfma_f32_16x16x32_bf16 v[32:35], a[80:83], v[224:227], v[32:35]
    buffer_load_dwordx4 v[168:171], v0, s[4:7], s55 offen sc1
    v_mfma_f32_16x16x32_bf16 v[36:39], a[84:87], v[224:227], v[36:39]
    s_add_u32 s55, s59, 12288
    v_mfma_f32_16x16x32_bf16 v[40:43], a[88:91], v[224:227], v[40:43]
    v_mfma_f32_16x16x32_bf16 v[44:47], a[92:95], v[224:227], v[44:47]
    s_waitcnt vmcnt(9)
    v_mfma_f32_16x16x32_bf16 v[48:51], a[80:83], v[228:231], v[48:51]
    buffer_load_dwordx4 v[172:175], v0, s[4:7], s55 offen sc1
    v_mfma_f32_16x16x32_bf16 v[52:55], a[84:87], v[228:231], v[52:55]
    s_add_u32 s55, s59, 16384
    v_mfma_f32_16x16x32_bf16 v[56:59], a[88:91], v[228:231], v[56:59]
    v_mfma_f32_16x16x32_bf16 v[60:63], a[92:95], v[228:231], v[60:63]
    s_waitcnt vmcnt(9)
    v_mfma_f32_16x16x32_bf16 v[64:67], a[80:83], v[232:235], v[64:67]
    buffer_load_dwordx4 v[176:179], v0, s[4:7], s55 offen sc1
    v_mfma_f32_16x16x32_bf16 v[68:71], a[84:87], v[232:235], v[68:71]
    s_add_u32 s55, s59, 20480
    v_mfma_f32_16x16x32_bf16 v[72:75], a[88:91], v[232:235], v[72:75]
    v_mfma_f32_16x16x32_bf16 v[76:79], a[92:95], v[232:235], v[76:79]
    s_waitcnt vmcnt(9)
    v_mfma_f32_16x16x32_bf16 v[80:83], a[80:83], v[236:239], v[80:83]
    buffer_load_dwordx4 v[180:183], v0, s[4:7], s55 offen sc1
    v_mfma_f32_16x16x32_bf16 v[84:87], a[84:87], v[236:239], v[84:87]
    s_add_u32 s55, s59, 24576
    v_mfma_f32_16x16x32_bf16 v[88:91], a[88:91], v[236:239], v[88:91]
    v_mfma_f32_16x16x32_bf16 v[92:95], a[92:95], v[236:239], v[92:95]
    s_waitcnt vmcnt(9)
    v_mfma_f32_16x16x32_bf16 v[32:35], a[96:99], v[144:147], v[32:35]
    buffer_load_dwordx4 v[184:187], v0, s[4:7], s55 offen sc1
    v_mfma_f32_16x16x32_bf16 v[36:39], a[100:103], v[144:147], v[36:39]
    s_add_u32 s55, s59, 0
    v_mfma_f32_16x16x32_bf16 v[40:43], a[104:107], v[144:147], v[40:43]
    v_mfma_f32_16x16x32_bf16 v[44:47], a[108:111], v[144:147], v[44:47]
    s_waitcnt vmcnt(9)
    v_mfma_f32_16x16x32_bf16 v[48:51], a[96:99], v[148:151], v[48:51]
    buffer_load_dwordx4 v[188:191], v245, s[4:7], s55 offen sc1
    v_mfma_f32_16x16x32_bf16 v[52:55], a[100:103], v[148:151], v[52:55]
    s_add_u32 s55, s59, 4096
    v_mfma_f32_16x16x32_bf16 v[56:59], a[104:107], v[148:151], v[56:59]
    v_mfma_f32_16x16x32_bf16 v[60:63], a[108:111], v[148:151], v[60:63]
    s_waitcnt vmcnt(9)
    v_mfma_f32_16x16x32_bf16 v[64:67], a[96:99], v[152:155], v[64:67]
    buffer_load_dwordx4 v[192:195], v245, s[4:7], s55 offen sc1
    v_mfma_f32_16x16x32_bf16 v[68:71], a[100:103], v[152:155], v[68:71]
    s_add_u32 s55, s59, 8192
    v_mfma_f32_16x16x32_bf16 v[72:75], a[104:107], v[152:155], v[72:75]
    v_mfma_f32_16x16x32_bf16 v[76:79], a[108:111], v[152:155], v[76:79]
    s_waitcnt vmcnt(9)
    v_mfma_f32_16x16x32_bf16 v[80:83], a[96:99], v[156:159], v[80:83]
    buffer_load_dwordx4 v[196:199], v245, s[4:7], s55 offen sc1
    v_mfma_f32_16x16x32_bf16 v[84:87], a[100:103], v[156:159], v[84:87]
    s_add_u32 s55, s59, 12288
    v_mfma_f32_16x16x32_bf16 v[88:91], a[104:107], v[156:159], v[88:91]
    v_mfma_f32_16x16x32_bf16 v[92:95], a[108:111], v[156:159], v[92:95]
    s_waitcnt vmcnt(9)
    s_waitcnt lgkmcnt(0)
    s_barrier
    v_mfma_f32_16x16x32_bf16 v[32:35], a[112:115], v[160:163], v[32:35]
    buffer_load_dwordx4 v[200:203], v245, s[4:7], s55 offen sc1
    v_mfma_f32_16x16x32_bf16 v[36:39], a[116:119], v[160:163], v[36:39]
    s_add_u32 s55, s59, 16384
    v_mfma_f32_16x16x32_bf16 v[40:43], a[120:123], v[160:163], v[40:43]
    v_mfma_f32_16x16x32_bf16 v[44:47], a[124:127], v[160:163], v[44:47]
    s_waitcnt vmcnt(9)
    v_mfma_f32_16x16x32_bf16 v[32:35], a[128:131], v[164:167], v[32:35]
    buffer_load_dwordx4 v[204:207], v245, s[4:7], s55 offen sc1
    v_mfma_f32_16x16x32_bf16 v[36:39], a[132:135], v[164:167], v[36:39]
    s_add_u32 s55, s59, 20480
    v_mfma_f32_16x16x32_bf16 v[40:43], a[136:139], v[164:167], v[40:43]
    v_mfma_f32_16x16x32_bf16 v[44:47], a[140:143], v[164:167], v[44:47]
    s_waitcnt vmcnt(9)
    v_mfma_f32_16x16x32_bf16 v[32:35], a[144:147], v[168:171], v[32:35]
    buffer_load_dwordx4 v[208:211], v245, s[4:7], s55 offen sc1
    v_mfma_f32_16x16x32_bf16 v[36:39], a[148:151], v[168:171], v[36:39]
    s_add_u32 s55, s59, 24576
    v_mfma_f32_16x16x32_bf16 v[40:43], a[152:155], v[168:171], v[40:43]
    v_mfma_f32_16x16x32_bf16 v[44:47], a[156:159], v[168:171], v[44:47]
    s_waitcnt vmcnt(9)
    v_mfma_f32_16x16x32_bf16 v[32:35], a[160:163], v[172:175], v[32:35]
    buffer_load_dwordx4 v[212:215], v245, s[4:7], s55 offen sc1
    v_mfma_f32_16x16x32_bf16 v[36:39], a[164:167], v[172:175], v[36:39]
    s_add_u32 s55, s59, 0
    v_mfma_f32_16x16x32_bf16 v[40:43], a[168:171], v[172:175], v[40:43]
    v_mfma_f32_16x16x32_bf16 v[44:47], a[172:175], v[172:175], v[44:47]
    s_waitcnt vmcnt(9)
    v_mfma_f32_16x16x32_bf16 v[32:35], a[176:179], v[176:179], v[32:35]
    buffer_load_dwordx4 v[216:219], v246, s[4:7], s55 offen sc1
    v_mfma_f32_16x16x32_bf16 v[36:39], a[180:183], v[176:179], v[36:39]
    s_add_u32 s55, s59, 4096
    v_mfma_f32_16x16x32_bf16 v[40:43], a[184:187], v[176:179], v[40:43]
    v_mfma_f32_16x16x32_bf16 v[44:47], a[188:191], v[176:179], v[44:47]
    s_waitcnt vmcnt(9)
    v_mfma_f32_16x16x32_bf16 v[32:35], a[192:195], v[180:183], v[32:35]
    buffer_load_dwordx4 v[220:223], v246, s[4:7], s55 offen sc1
    v_mfma_f32_16x16x32_bf16 v[36:39], a[196:199], v[180:183], v[36:39]
    s_add_u32 s55, s59, 8192
    v_mfma_f32_16x16x32_bf16 v[40:43], a[200:203], v[180:183], v[40:43]
    v_mfma_f32_16x16x32_bf16 v[44:47], a[204:207], v[180:183], v[44:47]
    s_waitcnt vmcnt(9)
    v_mfma_f32_16x16x32_bf16 v[32:35], a[208:211], v[184:187], v[32:35]
    buffer_load_dwordx4 v[224:227], v246, s[4:7], s55 offen sc1
    v_mfma_f32_16x16x32_bf16 v[36:39], a[212:215], v[184:187], v[36:39]
    s_add_u32 s55, s59, 12288
    v_mfma_f32_16x16x32_bf16 v[40:43], a[216:219], v[184:187], v[40:43]
    v_mfma_f32_16x16x32_bf16 v[44:47], a[220:223], v[184:187], v[44:47]
    s_waitcnt vmcnt(9)
    v_mfma_f32_16x16x32_bf16 v[48:51], a[112:115], v[188:191], v[48:51]
    buffer_load_dwordx4 v[228:231], v246, s[4:7], s55 offen sc1
    v_mfma_f32_16x16x32_bf16 v[52:55], a[116:119], v[188:191], v[52:55]
    s_add_u32 s55, s59, 16384
    v_mfma_f32_16x16x32_bf16 v[56:59], a[120:123], v[188:191], v[56:59]
    v_mfma_f32_16x16x32_bf16 v[60:63], a[124:127], v[188:191], v[60:63]
    s_waitcnt vmcnt(9)
    v_mfma_f32_16x16x32_bf16 v[48:51], a[128:131], v[192:195], v[48:51]
    buffer_load_dwordx4 v[232:235], v246, s[4:7], s55 offen sc1
    v_mfma_f32_16x16x32_bf16 v[52:55], a[132:135], v[192:195], v[52:55]
    s_add_u32 s55, s59, 20480
    v_mfma_f32_16x16x32_bf16 v[56:59], a[136:139], v[192:195], v[56:59]
    ds_write_b128 v4, v[32:35] offset:0
    v_mfma_f32_16x16x32_bf16 v[60:63], a[140:143], v[192:195], v[60:63]
    ds_write_b128 v4, v[36:39] offset:4160
    s_waitcnt vmcnt(9)
    v_mfma_f32_16x16x32_bf16 v[48:51], a[144:147], v[196:199], v[48:51]
    buffer_load_dwordx4 v[236:239], v246, s[4:7], s55 offen sc1
    v_mfma_f32_16x16x32_bf16 v[52:55], a[148:151], v[196:199], v[52:55]
    s_add_u32 s55, s59, 24576
    v_mfma_f32_16x16x32_bf16 v[56:59], a[152:155], v[196:199], v[56:59]
    ds_write_b128 v4, v[40:43] offset:8320
    v_mfma_f32_16x16x32_bf16 v[60:63], a[156:159], v[196:199], v[60:63]
    ds_write_b128 v4, v[44:47] offset:12480
    s_waitcnt vmcnt(9)
    v_mfma_f32_16x16x32_bf16 v[48:51], a[160:163], v[200:203], v[48:51]
    buffer_load_dwordx4 v[144:147], v246, s[4:7], s55 offen sc1
    v_mfma_f32_16x16x32_bf16 v[52:55], a[164:167], v[200:203], v[52:55]
    s_add_u32 s55, s59, 0
    v_mfma_f32_16x16x32_bf16 v[56:59], a[168:171], v[200:203], v[56:59]
    v_mfma_f32_16x16x32_bf16 v[60:63], a[172:175], v[200:203], v[60:63]
    s_waitcnt vmcnt(9)
    v_mfma_f32_16x16x32_bf16 v[48:51], a[176:179], v[204:207], v[48:51]
    buffer_load_dwordx4 v[148:151], v247, s[4:7], s55 offen sc1
    v_mfma_f32_16x16x32_bf16 v[52:55], a[180:183], v[204:207], v[52:55]
    s_add_u32 s55, s59, 4096
    v_mfma_f32_16x16x32_bf16 v[56:59], a[184:187], v[204:207], v[56:59]
    v_mfma_f32_16x16x32_bf16 v[60:63], a[188:191], v[204:207], v[60:63]
    s_waitcnt vmcnt(9)
    v_mfma_f32_16x16x32_bf16 v[48:51], a[192:195], v[208:211], v[48:51]
    buffer_load_dwordx4 v[152:155], v247, s[4:7], s55 offen sc1
    v_mfma_f32_16x16x32_bf16 v[52:55], a[196:199], v[208:211], v[52:55]
    s_add_u32 s55, s59, 8192
    v_mfma_f32_16x16x32_bf16 v[56:59], a[200:203], v[208:211], v[56:59]
    v_mfma_f32_16x16x32_bf16 v[60:63], a[204:207], v[208:211], v[60:63]
    s_waitcnt vmcnt(9)
    v_mfma_f32_16x16x32_bf16 v[48:51], a[208:211], v[212:215], v[48:51]
    buffer_load_dwordx4 v[156:159], v247, s[4:7], s55 offen sc1
    v_mfma_f32_16x16x32_bf16 v[52:55], a[212:215], v[212:215], v[52:55]
    s_add_u32 s55, s59, 12288
    v_mfma_f32_16x16x32_bf16 v[56:59], a[216:219], v[212:215], v[56:59]
    v_mfma_f32_16x16x32_bf16 v[60:63], a[220:223], v[212:215], v[60:63]
    s_waitcnt vmcnt(9)
    v_mfma_f32_16x16x32_bf16 v[64:67], a[112:115], v[216:219], v[64:67]
    buffer_load_dwordx4 v[160:163], v247, s[4:7], s55 offen sc1
    v_mfma_f32_16x16x32_bf16 v[68:71], a[116:119], v[216:219], v[68:71]
    s_add_u32 s55, s59, 16384
    v_mfma_f32_16x16x32_bf16 v[72:75], a[120:123], v[216:219], v[72:75]
    v_mfma_f32_16x16x32_bf16 v[76:79], a[124:127], v[216:219], v[76:79]
    s_waitcnt vmcnt(9)
    v_mfma_f32_16x16x32_bf16 v[64:67], a[128:131], v[220:223], v[64:67]
    buffer_load_dwordx4 v[164:167], v247, s[4:7], s55 offen sc1
    v_mfma_f32_16x16x32_bf16 v[68:71], a[132:135], v[220:223], v[68:71]
    s_add_u32 s55, s59, 20480
    v_mfma_f32_16x16x32_bf16 v[72:75], a[136:139], v[220:223], v[72:75]
    ds_write_b128 v4, v[48:51] offset:256
    v_mfma_f32_16x16x32_bf16 v[76:79], a[140:143], v[220:223], v[76:79]
    ds_write_b128 v4, v[52:55] offset:4416
    s_waitcnt vmcnt(9)
    v_mfma_f32_16x16x32_bf16 v[64:67], a[144:147], v[224:227], v[64:67]
    buffer_load_dwordx4 v[168:171], v247, s[4:7], s55 offen sc1
    v_mfma_f32_16x16x32_bf16 v[68:71], a[148:151], v[224:227], v[68:71]
    s_add_u32 s55, s59, 24576
    v_mfma_f32_16x16x32_bf16 v[72:75], a[152:155], v[224:227], v[72:75]
    ds_write_b128 v4, v[56:59] offset:8576
    v_mfma_f32_16x16x32_bf16 v[76:79], a[156:159], v[224:227], v[76:79]
    ds_write_b128 v4, v[60:63] offset:12736
    s_waitcnt vmcnt(9)
    v_mfma_f32_16x16x32_bf16 v[64:67], a[160:163], v[228:231], v[64:67]
    buffer_load_dwordx4 v[172:175], v247, s[4:7], s55 offen sc1
    v_mfma_f32_16x16x32_bf16 v[68:71], a[164:167], v[228:231], v[68:71]
    v_mfma_f32_16x16x32_bf16 v[72:75], a[168:171], v[228:231], v[72:75]
    v_mfma_f32_16x16x32_bf16 v[76:79], a[172:175], v[228:231], v[76:79]
    s_waitcnt vmcnt(9)
    v_mfma_f32_16x16x32_bf16 v[64:67], a[176:179], v[232:235], v[64:67]
    s_waitcnt lgkmcnt(0)
    s_barrier
    v_mfma_f32_16x16x32_bf16 v[68:71], a[180:183], v[232:235], v[68:71]
    ds_read_b128 v[96:99], v5 offset:0
    v_mfma_f32_16x16x32_bf16 v[72:75], a[184:187], v[232:235], v[72:75]
    ds_read_b128 v[100:103], v5 offset:16640
    v_mfma_f32_16x16x32_bf16 v[76:79], a[188:191], v[232:235], v[76:79]
    ds_read_b128 v[104:107], v5 offset:33280
    s_waitcnt vmcnt(8)
    v_mfma_f32_16x16x32_bf16 v[64:67], a[192:195], v[236:239], v[64:67]
    ds_read_b128 v[108:111], v5 offset:49920
    v_mfma_f32_16x16x32_bf16 v[68:71], a[196:199], v[236:239], v[68:71]
    ds_read_b128 v[112:115], v5 offset:1040
    v_mfma_f32_16x16x32_bf16 v[72:75], a[200:203], v[236:239], v[72:75]
    ds_read_b128 v[116:119], v5 offset:17680
    v_mfma_f32_16x16x32_bf16 v[76:79], a[204:207], v[236:239], v[76:79]
    ds_read_b128 v[120:123], v5 offset:34320
    s_waitcnt vmcnt(7)
    v_mfma_f32_16x16x32_bf16 v[64:67], a[208:211], v[144:147], v[64:67]
    ds_read_b128 v[124:127], v5 offset:50960
    v_mfma_f32_16x16x32_bf16 v[68:71], a[212:215], v[144:147], v[68:71]
    v_mfma_f32_16x16x32_bf16 v[72:75], a[216:219], v[144:147], v[72:75]
    v_mfma_f32_16x16x32_bf16 v[76:79], a[220:223], v[144:147], v[76:79]
    s_waitcnt vmcnt(6)
    v_mfma_f32_16x16x32_bf16 v[80:83], a[112:115], v[148:151], v[80:83]
    v_mfma_f32_16x16x32_bf16 v[84:87], a[116:119], v[148:151], v[84:87]
    v_mfma_f32_16x16x32_bf16 v[88:91], a[120:123], v[148:151], v[88:91]
    v_mfma_f32_16x16x32_bf16 v[92:95], a[124:127], v[148:151], v[92:95]
    s_waitcnt vmcnt(5)
    v_mfma_f32_16x16x32_bf16 v[80:83], a[128:131], v[152:155], v[80:83]
    ds_write_b128 v4, v[64:67] offset:512
    v_mfma_f32_16x16x32_bf16 v[84:87], a[132:135], v[152:155], v[84:87]
    ds_write_b128 v4, v[68:71] offset:4672
    v_mfma_f32_16x16x32_bf16 v[88:91], a[136:139], v[152:155], v[88:91]
    ds_write_b128 v4, v[72:75] offset:8832
    v_mfma_f32_16x16x32_bf16 v[92:95], a[140:143], v[152:155], v[92:95]
    ds_write_b128 v4, v[76:79] offset:12992
    s_waitcnt vmcnt(4)
    v_mfma_f32_16x16x32_bf16 v[80:83], a[144:147], v[156:159], v[80:83]
    s_waitcnt lgkmcnt(4)
    v_add_f32 v96, v96, v100
    v_mfma_f32_16x16x32_bf16 v[84:87], a[148:151], v[156:159], v[84:87]
    v_add_f32 v97, v97, v101
    v_add_f32 v98, v98, v102
    v_mfma_f32_16x16x32_bf16 v[88:91], a[152:155], v[156:159], v[88:91]
    v_add_f32 v99, v99, v103
    v_add_f32 v104, v104, v108
    v_mfma_f32_16x16x32_bf16 v[92:95], a[156:159], v[156:159], v[92:95]
    v_add_f32_e64 v105, v105, v109
    v_add_f32 v106, v106, v110
    s_waitcnt vmcnt(3)
    v_mfma_f32_16x16x32_bf16 v[80:83], a[160:163], v[160:163], v[80:83]
    v_add_f32 v107, v107, v111
    v_add_f32 v96, v96, v104
    v_mfma_f32_16x16x32_bf16 v[84:87], a[164:167], v[160:163], v[84:87]
    v_add_f32 v97, v97, v105
    v_add_f32 v98, v98, v106
    v_mfma_f32_16x16x32_bf16 v[88:91], a[168:171], v[160:163], v[88:91]
    v_add_f32_e64 v99, v99, v107
    v_cvt_pk_bf16_f32 v8, v96, v97
    v_mfma_f32_16x16x32_bf16 v[92:95], a[172:175], v[160:163], v[92:95]
    v_cvt_pk_bf16_f32 v9, v98, v99
    v_add_f32 v112, v112, v116
    s_waitcnt vmcnt(2)
    v_mfma_f32_16x16x32_bf16 v[80:83], a[176:179], v[164:167], v[80:83]
    v_add_f32 v113, v113, v117
    v_add_f32 v114, v114, v118
    v_mfma_f32_16x16x32_bf16 v[84:87], a[180:183], v[164:167], v[84:87]
    v_add_f32 v115, v115, v119
    v_add_f32 v120, v120, v124
    v_mfma_f32_16x16x32_bf16 v[88:91], a[184:187], v[164:167], v[88:91]
    v_add_f32 v121, v121, v125
    v_add_f32 v122, v122, v126
    v_mfma_f32_16x16x32_bf16 v[92:95], a[188:191], v[164:167], v[92:95]
    v_add_f32_e64 v123, v123, v127
    v_add_f32 v112, v112, v120
    s_waitcnt vmcnt(1)
    v_mfma_f32_16x16x32_bf16 v[80:83], a[192:195], v[168:171], v[80:83]
    v_add_f32 v113, v113, v121
    v_add_f32 v114, v114, v122
    v_mfma_f32_16x16x32_bf16 v[84:87], a[196:199], v[168:171], v[84:87]
    v_add_f32_e64 v115, v115, v123
    v_cvt_pk_bf16_f32 v10, v112, v113
    v_mfma_f32_16x16x32_bf16 v[88:91], a[200:203], v[168:171], v[88:91]
    v_cvt_pk_bf16_f32 v11, v114, v115
    buffer_store_dwordx4 v[8:11], v7, s[36:39], s56 offen sc1
    v_mfma_f32_16x16x32_bf16 v[92:95], a[204:207], v[168:171], v[92:95]
    s_waitcnt vmcnt(1)
    v_mfma_f32_16x16x32_bf16 v[80:83], a[208:211], v[172:175], v[80:83]
    v_mfma_f32_16x16x32_bf16 v[84:87], a[212:215], v[172:175], v[84:87]
    v_mfma_f32_16x16x32_bf16 v[88:91], a[216:219], v[172:175], v[88:91]
    v_mfma_f32_16x16x32_bf16 v[92:95], a[220:223], v[172:175], v[92:95]
    s_nop 4
    ds_write_b128 v4, v[80:83] offset:768
    ds_write_b128 v4, v[84:87] offset:4928
    ds_write_b128 v4, v[88:91] offset:9088
    ds_write_b128 v4, v[92:95] offset:13248
    s_waitcnt lgkmcnt(0)
    s_barrier
    ds_read_b128 v[96:99], v5 offset:512
    ds_read_b128 v[100:103], v5 offset:17152
    ds_read_b128 v[104:107], v5 offset:33792
    ds_read_b128 v[108:111], v5 offset:50432
    ds_read_b128 v[112:115], v5 offset:1552
    ds_read_b128 v[116:119], v5 offset:18192
    ds_read_b128 v[120:123], v5 offset:34832
    ds_read_b128 v[124:127], v5 offset:51472
    s_waitcnt lgkmcnt(0)
    s_nop 0
    v_pk_add_f32 v[96:97], v[96:97], v[100:101]
    v_pk_add_f32 v[98:99], v[98:99], v[102:103]
    v_pk_add_f32 v[104:105], v[104:105], v[108:109]
    v_pk_add_f32 v[106:107], v[106:107], v[110:111]
    v_pk_add_f32 v[96:97], v[96:97], v[104:105]
    v_pk_add_f32 v[98:99], v[98:99], v[106:107]
    v_cvt_pk_bf16_f32 v12, v96, v97
    v_cvt_pk_bf16_f32 v13, v98, v99
    v_pk_add_f32 v[112:113], v[112:113], v[116:117]
    v_pk_add_f32 v[114:115], v[114:115], v[118:119]
    v_pk_add_f32 v[120:121], v[120:121], v[124:125]
    v_pk_add_f32 v[122:123], v[122:123], v[126:127]
    v_pk_add_f32 v[112:113], v[112:113], v[120:121]
    v_pk_add_f32 v[114:115], v[114:115], v[122:123]
    v_cvt_pk_bf16_f32 v14, v112, v113
    v_cvt_pk_bf16_f32 v15, v114, v115
    buffer_store_dwordx4 v[12:15], v7, s[36:39], s57 offen
    s_endpgm
L_hh:
    s_nop 0
    s_load_dwordx2 s[16:17], s[0:1], 16
    s_load_dwordx2 s[20:21], s[0:1], 32
    s_load_dwordx2 s[24:25], s[0:1], 40
    s_load_dwordx2 s[28:29], s[0:1], 48
    s_load_dwordx2 s[32:33], s[0:1], 56
    s_load_dwordx2 s[36:37], s[0:1], 64
    s_mov_b32 s6, 0x10000000
    s_mov_b32 s7, 0x20000
    v_mov_b32_e64 v255, 0
    buffer_load_dword v4, v255, s[4:7], 0 offen sc1
    s_waitcnt lgkmcnt(0)
    s_nop 0
    s_mov_b32 s18, 401408
    s_mov_b32 s19, 0x20000
    s_mov_b32 s22, 401408
    s_mov_b32 s23, 0x20000
    s_mov_b32 s26, 401408
    s_mov_b32 s27, 0x20000
    s_mov_b32 s30, 1605632
    s_mov_b32 s31, 0x20000
    s_mov_b32 s34, 1605632
    s_mov_b32 s35, 0x20000
    s_mov_b32 s38, 1835008
    s_mov_b32 s39, 0x20000
    s_lshl_b32 s3, s40, 4
    s_add_u32 s3, s3, s41
    s_mul_i32 s66, s44, 14336
    s_lshl_b32 s52, s43, 7
    s_cmp_ge_u32 s41, 14
    s_cselect_b32 s52, 1073741824, s52
    s_mul_i32 s68, s44, 100352
    s_add_u32 s68, s68, s52
    s_mul_i32 s69, s44, 200704
    s_add_u32 s69, s69, s52
    v_lshrrev_b32 v252, 3, v1
    v_mul_u32_u24 v251, 896, v252
    v_lshrrev_b32 v252, 4, v1
    v_lshlrev_b32 v252, 1, v252
    v_and_b32 v253, 7, v1
    v_xor_b32 v252, v252, v253
    v_lshl_add_u32 v251, v252, 4, v251
    v_accvgpr_write_b32 a250, v251
    v_lshrrev_b32_e64 v252, 3, v1
    v_mul_u32_u24 v251, 896, v252
    v_bfe_u32 v252, v1, 4, 1
    v_lshlrev_b32 v252, 2, v252
    v_and_b32 v253, 7, v1
    v_xor_b32_e64 v252, v252, v253
    v_lshl_add_u32 v251, v252, 4, v251
    v_accvgpr_write_b32 a251, v251
    s_lshl_b32 s52, s40, 4
    v_lshrrev_b32 v252, 5, v1
    v_and_b32_e64 v253, 15, v1
    v_add_lshl_u32 v254, v253, s52, 8
    v_lshl_add_u32 v254, v252, 19, v254
    s_min_u32 s52, s44, 2
    s_sub_u32 s52, 2, s52
    s_min_u32 s52, s52, s40
    s_lshl_b32 s52, s52, 12
    s_mov_b64 exec, 0xffff
    v_subrev_u32_e64 v254, s52, v254
    s_mov_b64 exec, -1
    s_mul_i32 s0, s41, 28
    s_add_u32 s1, s0, 27
    s_lshr_b32 s0, s0, 6
    s_lshr_b32 s1, s1, 6
    s_lshl_b32 s0, 1, s0
    s_bitset1_b32 s0, s1
    s_lshr_b32 s52, s44, 1
    s_lshl_b32 s52, s52, 3
    s_lshl_b32 s1, s0, s52
    s_mul_i32 s0, s0, 0x101
    v_lshl_add_u32 v40, s44, 6, v1
    v_lshlrev_b32 v40, 7, v40
    v_mov_b32 v42, 1073741824
    s_lshl_b32 s57, s40, 1
    s_add_u32 s57, s57, s41
    s_sub_u32 s57, s57, 14
    s_and_b32 s56, s57, 3
    s_mul_i32 s52, s57, 12544
    s_add_u32 s52, s52, 0
    s_mov_b32 s53, 0
    s_mov_b32 s55, 1
L_pf_97:
    s_lshl_b32 s54, s53, 15
    v_lshl_add_u32 v41, v40, 0, s54
    v_cmp_gt_u32 vcc, 12544, v41
    s_add_u32 s53, s53, 1
    s_cmp_ge_u32 s53, 1
    s_cselect_b32 s53, 0, s53
    v_cndmask_b32 v41, v42, v41, vcc
    buffer_load_dword v43, v41, s[16:19], s52 offen
    s_sub_u32 s55, s55, 1
    s_cmp_lg_u32 s55, 0
    s_cbranch_scc1 L_pf_97
    s_mul_i32 s52, s57, 22528
    s_add_u32 s52, s52, 65536
    s_mov_b32 s53, 0
    s_mov_b32 s55, 1
L_pf_98:
    s_lshl_b32 s54, s53, 16
    v_lshl_add_u32 v41, v40, 1, s54
    v_cmp_gt_u32 vcc, 22528, v41
    s_add_u32 s53, s53, 1
    s_cmp_ge_u32 s53, 1
    s_cselect_b32 s53, 0, s53
    v_cndmask_b32 v41, v42, v41, vcc
    buffer_load_dword v43, v41, s[4:7], s52 offen sc1
    s_sub_u32 s55, s55, 1
    s_cmp_lg_u32 s55, 0
    s_cbranch_scc1 L_pf_98
    s_mul_i32 s52, s57, 4096
    s_add_u32 s52, s52, 786432
    s_mov_b32 s53, 0
    s_mov_b32 s55, 1
L_pf_99:
    s_lshl_b32 s54, s53, 15
    v_lshl_add_u32 v41, v40, 0, s54
    v_cmp_gt_u32 vcc, 4096, v41
    s_add_u32 s53, s53, 1
    s_cmp_ge_u32 s53, 1
    s_cselect_b32 s53, 0, s53
    v_cndmask_b32 v41, v42, v41, vcc
    buffer_load_dword v43, v41, s[4:7], s52 offen sc1
    s_sub_u32 s55, s55, 1
    s_cmp_lg_u32 s55, 0
    s_cbranch_scc1 L_pf_99
    s_mul_i32 s58, s56, 200704
    s_lshr_b32 s59, s40, 1
    s_mul_i32 s52, s59, 25088
    s_add_u32 s52, s52, s58
    s_mov_b32 s53, 0
    s_mov_b32 s55, 1
L_pf_100:
    s_lshl_b32 s54, s53, 15
    v_lshl_add_u32 v41, v40, 0, s54
    v_cmp_gt_u32 vcc, 25088, v41
    s_add_u32 s53, s53, 1
    s_cmp_ge_u32 s53, 1
    s_cselect_b32 s53, 0, s53
    v_cndmask_b32 v41, v42, v41, vcc
    buffer_load_dword v43, v41, s[32:35], s52 offen
    s_sub_u32 s55, s55, 1
    s_cmp_lg_u32 s55, 0
    s_cbranch_scc1 L_pf_100
    s_mul_i32 s52, s57, 12544
    s_add_u32 s52, s52, 0
    s_mov_b32 s53, 0
    s_mov_b32 s55, 1
L_pf_101:
    s_lshl_b32 s54, s53, 15
    v_lshl_add_u32 v41, v40, 0, s54
    v_cmp_gt_u32 vcc, 12544, v41
    s_add_u32 s53, s53, 1
    s_cmp_ge_u32 s53, 1
    s_cselect_b32 s53, 0, s53
    v_cndmask_b32 v41, v42, v41, vcc
    buffer_load_dword v43, v41, s[20:23], s52 offen
    s_sub_u32 s55, s55, 1
    s_cmp_lg_u32 s55, 0
    s_cbranch_scc1 L_pf_101
    s_mul_i32 s52, s57, 12544
    s_add_u32 s52, s52, 0
    s_mov_b32 s53, 0
    s_mov_b32 s55, 1
L_pf_102:
    s_lshl_b32 s54, s53, 15
    v_lshl_add_u32 v41, v40, 0, s54
    v_cmp_gt_u32 vcc, 12544, v41
    s_add_u32 s53, s53, 1
    s_cmp_ge_u32 s53, 1
    s_cselect_b32 s53, 0, s53
    v_cndmask_b32 v41, v42, v41, vcc
    buffer_load_dword v43, v41, s[24:27], s52 offen
    s_sub_u32 s55, s55, 1
    s_cmp_lg_u32 s55, 0
    s_cbranch_scc1 L_pf_102
    s_mul_i32 s52, s56, 100352
    s_add_u32 s52, s52, 0
    s_lshr_b32 s53, s40, 1
    s_mul_i32 s53, s53, 4
    s_lshr_b32 s53, s53, 3
    s_mov_b32 s55, 4
L_pf_103:
    s_lshl_b32 s54, s53, 15
    v_lshl_add_u32 v41, v40, 0, s54
    v_cmp_gt_u32 vcc, 100352, v41
    s_add_u32 s53, s53, 1
    s_cmp_ge_u32 s53, 4
    s_cselect_b32 s53, 0, s53
    v_cndmask_b32 v41, v42, v41, vcc
    buffer_load_dword v43, v41, s[16:19], s52 offen
    s_sub_u32 s55, s55, 1
    s_cmp_lg_u32 s55, 0
    s_cbranch_scc1 L_pf_103
    v_lshrrev_b32_e64 v252, 5, v1
    v_mul_u32_u24 v111, 512, v252
    v_bfe_u32 v252, v1, 2, 2
    v_lshl_add_u32 v111, v252, 7, v111
    v_bfe_u32 v252, v1, 4, 1
    v_lshl_add_u32 v111, v252, 5, v111
    v_and_b32_e64 v252, 3, v1
    v_lshl_add_u32 v111, v252, 3, v111
    v_bfe_u32 v252, v1, 3, 1
    v_lshl_add_u32 v111, v252, 6, v111
    v_accvgpr_write_b32 a249, v111
    s_lshl_b32 s47, s42, 3
    s_add_u32 s47, s47, s43
    s_mul_i32 s67, s44, 12288
    s_add_u32 s67, s67, 114688
    s_mul_i32 s70, s44, 401408
    s_lshl_b32 s52, s41, 7
    s_add_u32 s70, s70, s52
    s_mul_i32 s73, s46, 57344
    s_mul_i32 s52, s40, 344064
    s_add_u32 s73, s73, s52
    s_lshl_b32 s71, s43, 13
    s_add_u32 s71, s71, s73
    s_lshl_b32 s72, s47, 9
    s_lshl_b32 s52, s44, 7
    s_add_u32 s72, s72, s52
    s_mov_b32 s48, 0x3f803f80
    s_and_b32 s52, s44, 1
    s_mul_i32 s50, s52, 401408
    s_lshr_b32 s52, s44, 1
    s_mul_i32 s52, s52, 28672
    s_add_u32 s50, s50, s52
    s_lshl_b32 s52, s43, 7
    s_add_u32 s50, s50, s52
    s_add_u32 s50, s50, 802816
    v_lshrrev_b32 v110, 4, v1
    v_and_b32 v111, 15, v1
    v_lshlrev_b32 v111, 4, v111
    v_lshl_add_u32 v2, v110, 10, v111
    v_lshl_add_u32 v2, v0, 8, v2
    v_lshrrev_b32 v110, 5, v1
    v_and_b32 v111, 31, v1
    v_lshlrev_b32_e64 v111, 4, v111
    v_lshl_add_u32 v3, v110, 10, v111
    v_lshrrev_b32 v110, 2, v1
    v_lshlrev_b32 v111, 7, v110
    v_and_b32_e64 v110, 6, v110
    v_lshl_add_u32 v111, v110, 4, v111
    v_and_b32_e64 v110, 3, v1
    v_lshl_add_u32 v111, v110, 3, v111
    v_accvgpr_write_b32 a248, v111
    v_lshrrev_b32_e64 v252, 3, v1
    v_mul_u32_u24 v111, 3584, v252
    v_bfe_u32 v252, v1, 4, 1
    v_lshlrev_b32 v252, 2, v252
    v_and_b32 v253, 7, v1
    v_xor_b32_e64 v252, v252, v253
    v_lshl_add_u32 v111, v252, 4, v111
    v_accvgpr_write_b32 a252, v111
    s_add_u32 s52, s72, 786432
    v_mov_b32 v104, s52
    s_cmp_eq_u32 s44, 0
    s_cselect_b32 s53, s3, s47
    s_lshl_b32 s53, s53, 8
    s_lshl_b32 s52, s44, 16
    s_add_u32 s53, s53, s52
    s_add_u32 s53, s53, 131072
    v_writelane_b32 v104, s53, 1
    s_lshl_b32 s53, s3, 8
    s_add_u32 s53, s53, 458752
    v_writelane_b32 v104, s53, 2
    v_accvgpr_write_b32 a253, v104
    v_lshrrev_b32 v104, 2, v1
    v_and_b32 v105, 3, v1
    v_lshlrev_b32 v105, 2, v105
    v_lshl_add_u32 v104, v104, 8, v105
    v_accvgpr_write_b32 a254, v104
    v_bfe_u32 v104, v1, 2, 3
    v_lshlrev_b32_e64 v104, 7, v104
    v_lshl_add_u32 v104, v105, 1, v104
    v_lshrrev_b32_e64 v105, 5, v1
    v_lshl_add_u32 v104, v105, 11, v104
    v_bfe_u32 v105, v1, 3, 1
    v_lshl_add_u32 v104, v105, 6, v104
    v_accvgpr_write_b32 a255, v104
    s_sub_u32 s57, 2, s40
    s_max_i32 s57, s57, 0
    v_lshrrev_b32 v125, 5, v1
    v_and_b32 v124, 31, v1
    v_lshlrev_b32_e64 v124, 3, v124
    v_lshl_add_u32 v234, v125, 10, v124
    v_lshlrev_b32_e64 v235, 4, v1
    s_mul_i32 s55, s40, 344064
    s_mul_i32 s54, s41, 7168
    s_add_u32 s55, s55, s54
    s_add_u32 s55, s55, 1048576
    s_sub_u32 s58, 2, s44
    s_mul_i32 s58, s58, 344064
    s_sub_u32 s58, s55, s58
    s_cmp_lt_u32 s44, s57
    s_cselect_b32 s58, 1073741824, s58
    s_lshl_b32 s53, s44, 8
    s_add_u32 s55, s55, s53
    s_lshl_b32 s59, s44, 10
    s_cmp_eq_u32 s44, 3
    s_cselect_b32 s59, 110592, s59
    s_cselect_b32 s58, 1073741824, s58
    v_and_b32 v112, 31, v1
    v_lshrrev_b32 v113, 5, v1
    v_lshlrev_b32 v114, 2, v113
    v_sub_u32 v112, v112, v114
    v_mov_b32 v114, 0xf149f2ca
    v_subrev_u32 v115, 0, v112
    v_ashrrev_i32 v115, 31, v115
    v_and_b32 v176, v114, v115
    v_xor_b32 v192, v114, v176
    v_subrev_u32 v115, 1, v112
    v_ashrrev_i32 v115, 31, v115
    v_and_b32 v177, v114, v115
    v_xor_b32 v193, v114, v177
    v_subrev_u32 v115, 2, v112
    v_ashrrev_i32 v115, 31, v115
    v_and_b32 v178, v114, v115
    v_xor_b32 v194, v114, v178
    v_subrev_u32 v115, 3, v112
    v_ashrrev_i32 v115, 31, v115
    v_and_b32 v179, v114, v115
    v_xor_b32 v195, v114, v179
    v_subrev_u32 v115, 8, v112
    v_ashrrev_i32 v115, 31, v115
    v_and_b32 v180, v114, v115
    v_xor_b32 v196, v114, v180
    v_subrev_u32 v115, 9, v112
    v_ashrrev_i32 v115, 31, v115
    v_and_b32 v181, v114, v115
    v_xor_b32 v197, v114, v181
    v_subrev_u32 v115, 10, v112
    v_ashrrev_i32 v115, 31, v115
    v_and_b32 v182, v114, v115
    v_xor_b32 v198, v114, v182
    v_subrev_u32 v115, 11, v112
    v_ashrrev_i32 v115, 31, v115
    v_and_b32 v183, v114, v115
    v_xor_b32 v199, v114, v183
    v_subrev_u32 v115, 16, v112
    v_ashrrev_i32 v115, 31, v115
    v_and_b32 v184, v114, v115
    v_xor_b32 v200, v114, v184
    v_subrev_u32 v115, 17, v112
    v_ashrrev_i32 v115, 31, v115
    v_and_b32 v185, v114, v115
    v_xor_b32 v201, v114, v185
    v_subrev_u32 v115, 18, v112
    v_ashrrev_i32 v115, 31, v115
    v_and_b32 v186, v114, v115
    v_xor_b32 v202, v114, v186
    v_subrev_u32 v115, 19, v112
    v_ashrrev_i32 v115, 31, v115
    v_and_b32 v187, v114, v115
    v_xor_b32 v203, v114, v187
    v_subrev_u32 v115, 24, v112
    v_ashrrev_i32 v115, 31, v115
    v_and_b32 v188, v114, v115
    v_xor_b32 v204, v114, v188
    v_subrev_u32 v115, 25, v112
    v_ashrrev_i32 v115, 31, v115
    v_and_b32 v189, v114, v115
    v_xor_b32 v205, v114, v189
    v_subrev_u32 v115, 26, v112
    v_ashrrev_i32 v115, 31, v115
    v_and_b32 v190, v114, v115
    v_xor_b32 v206, v114, v190
    v_subrev_u32 v115, 27, v112
    v_ashrrev_i32 v115, 31, v115
    v_and_b32_e64 v191, v114, v115
    v_xor_b32 v207, v114, v191
    s_cmp_lt_u32 s44, s57
    s_cselect_b32 s53, 0x0000f149, 0
    v_mov_b32 v116, s53
    v_mov_b32 v117, 0
    v_mov_b32 v118, s53
    v_mov_b32 v119, 0
    v_mov_b32 v120, 0x3f80
    v_mov_b32_e64 v121, 0
    v_mov_b32 v122, 0x3f80
    v_mov_b32_e64 v123, 0
    s_add_u32 s53, s59, 79072
    v_add_u32_e64 v112, s53, v235
    ds_write_b128 v112, v[116:119]
    ds_write_b128 v112, v[120:123] offset:24832
    v_and_b32 v112, 0xff, v234
    v_mul_u32_u24 v232, 3104, v113
    s_lshl_b32 s53, s44, 8
    s_add_u32 s52, s53, 57344
    v_add3_u32 v232, v232, v112, s52
    v_bfe_u32 v112, v1, 4, 1
    v_and_b32 v114, 3, v1
    v_lshl_add_u32 v112, v112, 2, v114
    v_mul_u32_u24 v233, 3104, v112
    v_lshl_add_u32 v233, v113, 5, v233
    v_bfe_u32 v112, v1, 2, 2
    v_lshl_add_u32 v233, v112, 3, v233
    s_add_u32 s52, s53, 82176
    v_add_u32 v233, s52, v233
    s_waitcnt vmcnt(0)
    s_waitcnt vmcnt(0)
    v_readfirstlane_b32 s45, v4
    s_getreg_b32 s61, hwreg(HW_REG_XCC_ID, 0, 4)
    s_lshr_b32 s45, s45, 4
    s_mul_i32 s45, s45, 0x9E3779B1
    s_add_u32 s45, s45, 0x7F4A7C15
    s_lshl_b32 s45, s45, 4
    s_lshl_b32 s52, s40, 1
    s_add_u32 s52, s52, s41
    s_sub_u32 s52, s52, 14
    s_lshl_b32 s52, s52, 3
    s_add_u32 s52, s52, 7
    s_cmp_lg_u32 s44, 0
    s_cbranch_scc1 L_sig_104
    s_lshl_b32 s51, s52, 8
    s_add_u32 s51, s51, 65536
    v_mov_b32 v242, s45
    v_lshlrev_b32 v243, 2, v1
    s_mov_b32 exec_hi, 0
    buffer_store_dword v242, v243, s[4:7], s51 offen sc1
    s_mov_b32 exec_hi, -1
L_sig_104:
    s_cmp_lg_u32 s44, 0
    s_cbranch_scc1 L_hw_105
    s_mov_b32 s62, 100000
    s_mov_b32 s63, 65536
    s_mov_b32 exec_lo, 0x7f7f0000
    s_mov_b32 exec_hi, 0
    s_branch L_spr_108
L_sp_106:
    v_xor_b32 v239, s45, v255
    v_cmp_lt_u32 vcc, 15, v239
    s_sub_u32 s62, s62, 1
    s_cbranch_vccz L_spok_107
L_spr_108:
    buffer_load_dword v255, v254, s[4:7], s63 offen sc1
    s_waitcnt vmcnt(0)
    s_cmp_gt_i32 s62, 0
    s_cbranch_scc1 L_sp_106
L_spok_107:
    s_mov_b64 exec, -1
L_hw_105:
    s_barrier
    s_mov_b32 s63, 65536
    s_mov_b32 exec_lo, s0
    s_mov_b32 exec_hi, 0
    buffer_load_dword v255, v254, s[4:7], s63 offen sc1
    s_mov_b64 exec, -1
    s_waitcnt vmcnt(0)
    s_branch L_att
L_ht:
    s_waitcnt vmcnt(3)
    s_lshl_b32 s51, s3, 8
    s_add_u32 s51, s51, 131072
    v_mov_b32 v254, s45
    v_lshlrev_b32 v255, 2, s44
    s_mov_b64 exec, 1
    s_waitcnt vmcnt(0)
    s_cmp_lg_u32 s60, 0
    s_cbranch_scc0 L_fs_109
    buffer_store_dword v254, v255, s[4:7], s51 offen
    s_branch L_fe_110
L_fs_109:
    buffer_store_dword v254, v255, s[4:7], s51 offen sc1
L_fe_110:
    s_mov_b64 exec, -1
    s_waitcnt lgkmcnt(0)
    s_barrier
    v_lshl_add_u32 v40, s44, 6, v1
    v_lshlrev_b32 v40, 7, v40
    v_mov_b32 v42, 1073741824
    s_lshl_b32 s57, s40, 1
    s_add_u32 s57, s57, s41
    s_sub_u32 s57, s57, 14
    s_and_b32 s56, s57, 3
    s_cmp_ge_u32 s57, 28
    s_cbranch_scc1 L_noc3_111
    s_mul_i32 s58, s44, 401408
    s_lshl_b32 s59, s57, 7
    s_add_u32 s58, s58, s59
    s_cmp_ge_u32 s57, 28
    s_cselect_b32 s58, 1073741824, s58
    v_accvgpr_read_b32 v248, a252
    v_add_u32 v249, 27648, v248
    v_add_u32 v250, 55296, v248
    v_add_u32 v251, 82944, v248
    s_add_u32 m0, s66, 0x00000000
    s_add_u32 s64, s58, 0
    buffer_load_dwordx4 v248, s[28:31], s64 offen offset:0 lds
    buffer_load_dwordx4 v249, s[28:31], s64 offen offset:1024 lds
    buffer_load_dwordx4 v250, s[28:31], s64 offen offset:2048 lds
    buffer_load_dwordx4 v251, s[28:31], s64 offen offset:3072 lds
    s_add_u32 m0, s66, 0x00001000
    s_add_u32 s64, s58, 114688
    buffer_load_dwordx4 v248, s[28:31], s64 offen offset:0 lds
    buffer_load_dwordx4 v249, s[28:31], s64 offen offset:1024 lds
    buffer_load_dwordx4 v250, s[28:31], s64 offen offset:2048 lds
    buffer_load_dwordx4 v251, s[28:31], s64 offen offset:3072 lds
    s_add_u32 m0, s66, 0x00002000
    s_add_u32 s64, s58, 229376
    buffer_load_dwordx4 v248, s[28:31], s64 offen offset:0 lds
    buffer_load_dwordx4 v249, s[28:31], s64 offen offset:1024 lds
    buffer_load_dwordx4 v250, s[28:31], s64 offen offset:2048 lds
    buffer_load_dwordx4 v251, s[28:31], s64 offen offset:3072 lds
    s_add_u32 m0, s66, 0x00003000
    s_add_u32 s64, s58, 344064
    buffer_load_dwordx4 v248, s[28:31], s64 offen offset:0 lds
    buffer_load_dwordx4 v249, s[28:31], s64 offen offset:1024 lds
    s_and_b32 s52, s44, 1
    s_lshl_b32 s53, s52, 6
    v_accvgpr_read_b32 v8, a249
    v_xor_b32 v8, s53, v8
    v_mov_b32 v12, s48
    v_mov_b32 v13, s48
    v_mov_b32 v14, s48
    v_mov_b32 v15, s48
    s_lshl_b32 s58, s57, 8
    s_lshl_b32 s52, s52, 7
    s_add_u32 s58, s58, s52
    s_add_u32 s58, s58, 917504
    v_lshlrev_b32 v9, 1, v1
    s_mov_b32 s65, s58
    v_lshrrev_b32_e64 v41, 11, v40
    v_mul_u32_u24 v41, 3584, v41
    v_and_b32 v44, 0x780, v40
    v_add_u32_e64 v41, v41, v44
    v_cmp_gt_u32 vcc, 0x700, v44
    s_mul_i32 s52, s56, 401408
    s_add_u32 s52, s52, 0
    v_cndmask_b32 v41, v42, v41, vcc
    buffer_load_dword v43, v41, s[28:31], s52 offen
    s_add_u32 s52, s52, 57344
    buffer_load_dword v43, v41, s[28:31], s52 offen
    s_add_u32 s52, s52, 57344
    buffer_load_dword v43, v41, s[28:31], s52 offen
    s_add_u32 s52, s52, 57344
    s_mov_b32 s58, s65
    s_waitcnt vmcnt(3)
    s_barrier
    s_nop 0
    ds_read_b64_tr_b16 v[176:177], v8 offset:0
    ds_read_b64_tr_b16 v[178:179], v8 offset:2048
    ds_read_b64_tr_b16 v[180:181], v8 offset:1024
    ds_read_b64_tr_b16 v[182:183], v8 offset:3072
    ds_read_b64_tr_b16 v[184:185], v8 offset:4096
    ds_read_b64_tr_b16 v[186:187], v8 offset:6144
    ds_read_b64_tr_b16 v[188:189], v8 offset:5120
    ds_read_b64_tr_b16 v[190:191], v8 offset:7168
    ds_read_b64_tr_b16 v[192:193], v8 offset:8192
    ds_read_b64_tr_b16 v[194:195], v8 offset:10240
    s_waitcnt lgkmcnt(8)
    v_mfma_f32_32x32x16_bf16 v[208:223], v[176:179], v[12:15], 0
    ds_read_b64_tr_b16 v[196:197], v8 offset:9216
    ds_read_b64_tr_b16 v[198:199], v8 offset:11264
    s_waitcnt lgkmcnt(8)
    v_mfma_f32_32x32x16_bf16 v[208:223], v[180:183], v[12:15], v[208:223]
    ds_read_b64_tr_b16 v[200:201], v8 offset:12288
    ds_read_b64_tr_b16 v[202:203], v8 offset:14336
    s_waitcnt lgkmcnt(8)
    v_mfma_f32_32x32x16_bf16 v[208:223], v[184:187], v[12:15], v[208:223]
    ds_read_b64_tr_b16 v[204:205], v8 offset:13312
    ds_read_b64_tr_b16 v[206:207], v8 offset:15360
    s_waitcnt lgkmcnt(8)
    v_mfma_f32_32x32x16_bf16 v[208:223], v[188:191], v[12:15], v[208:223]
    ds_read_b64_tr_b16 v[176:177], v8 offset:16384
    ds_read_b64_tr_b16 v[178:179], v8 offset:18432
    s_waitcnt lgkmcnt(8)
    v_mfma_f32_32x32x16_bf16 v[208:223], v[192:195], v[12:15], v[208:223]
    ds_read_b64_tr_b16 v[180:181], v8 offset:17408
    ds_read_b64_tr_b16 v[182:183], v8 offset:19456
    s_waitcnt lgkmcnt(8)
    v_mfma_f32_32x32x16_bf16 v[208:223], v[196:199], v[12:15], v[208:223]
    ds_read_b64_tr_b16 v[184:185], v8 offset:20480
    ds_read_b64_tr_b16 v[186:187], v8 offset:22528
    s_waitcnt lgkmcnt(8)
    v_mfma_f32_32x32x16_bf16 v[208:223], v[200:203], v[12:15], v[208:223]
    ds_read_b64_tr_b16 v[188:189], v8 offset:21504
    ds_read_b64_tr_b16 v[190:191], v8 offset:23552
    s_waitcnt lgkmcnt(8)
    v_mfma_f32_32x32x16_bf16 v[208:223], v[204:207], v[12:15], v[208:223]
    ds_read_b64_tr_b16 v[192:193], v8 offset:24576
    ds_read_b64_tr_b16 v[194:195], v8 offset:26624
    s_waitcnt lgkmcnt(8)
    v_mfma_f32_32x32x16_bf16 v[208:223], v[176:179], v[12:15], v[208:223]
    ds_read_b64_tr_b16 v[196:197], v8 offset:25600
    ds_read_b64_tr_b16 v[198:199], v8 offset:27648
    s_waitcnt lgkmcnt(8)
    v_mfma_f32_32x32x16_bf16 v[208:223], v[180:183], v[12:15], v[208:223]
    ds_read_b64_tr_b16 v[200:201], v8 offset:28672
    ds_read_b64_tr_b16 v[202:203], v8 offset:30720
    s_waitcnt lgkmcnt(8)
    v_mfma_f32_32x32x16_bf16 v[208:223], v[184:187], v[12:15], v[208:223]
    ds_read_b64_tr_b16 v[204:205], v8 offset:29696
    ds_read_b64_tr_b16 v[206:207], v8 offset:31744
    s_waitcnt lgkmcnt(8)
    v_mfma_f32_32x32x16_bf16 v[208:223], v[188:191], v[12:15], v[208:223]
    ds_read_b64_tr_b16 v[176:177], v8 offset:32768
    ds_read_b64_tr_b16 v[178:179], v8 offset:34816
    s_waitcnt lgkmcnt(8)
    v_mfma_f32_32x32x16_bf16 v[208:223], v[192:195], v[12:15], v[208:223]
    ds_read_b64_tr_b16 v[180:181], v8 offset:33792
    ds_read_b64_tr_b16 v[182:183], v8 offset:35840
    s_waitcnt lgkmcnt(8)
    v_mfma_f32_32x32x16_bf16 v[208:223], v[196:199], v[12:15], v[208:223]
    ds_read_b64_tr_b16 v[184:185], v8 offset:36864
    ds_read_b64_tr_b16 v[186:187], v8 offset:38912
    s_waitcnt lgkmcnt(8)
    v_mfma_f32_32x32x16_bf16 v[208:223], v[200:203], v[12:15], v[208:223]
    ds_read_b64_tr_b16 v[188:189], v8 offset:37888
    ds_read_b64_tr_b16 v[190:191], v8 offset:39936
    s_waitcnt lgkmcnt(8)
    v_mfma_f32_32x32x16_bf16 v[208:223], v[204:207], v[12:15], v[208:223]
    ds_read_b64_tr_b16 v[192:193], v8 offset:40960
    ds_read_b64_tr_b16 v[194:195], v8 offset:43008
    s_waitcnt lgkmcnt(8)
    v_mfma_f32_32x32x16_bf16 v[208:223], v[176:179], v[12:15], v[208:223]
    ds_read_b64_tr_b16 v[196:197], v8 offset:41984
    ds_read_b64_tr_b16 v[198:199], v8 offset:44032
    s_waitcnt lgkmcnt(8)
    v_mfma_f32_32x32x16_bf16 v[208:223], v[180:183], v[12:15], v[208:223]
    ds_read_b64_tr_b16 v[200:201], v8 offset:45056
    ds_read_b64_tr_b16 v[202:203], v8 offset:47104
    s_waitcnt lgkmcnt(8)
    v_mfma_f32_32x32x16_bf16 v[208:223], v[184:187], v[12:15], v[208:223]
    ds_read_b64_tr_b16 v[204:205], v8 offset:46080
    ds_read_b64_tr_b16 v[206:207], v8 offset:48128
    s_waitcnt lgkmcnt(8)
    v_mfma_f32_32x32x16_bf16 v[208:223], v[188:191], v[12:15], v[208:223]
    ds_read_b64_tr_b16 v[176:177], v8 offset:49152
    ds_read_b64_tr_b16 v[178:179], v8 offset:51200
    s_waitcnt lgkmcnt(8)
    v_mfma_f32_32x32x16_bf16 v[208:223], v[192:195], v[12:15], v[208:223]
    ds_read_b64_tr_b16 v[180:181], v8 offset:50176
    ds_read_b64_tr_b16 v[182:183], v8 offset:52224
    s_waitcnt lgkmcnt(8)
    v_mfma_f32_32x32x16_bf16 v[208:223], v[196:199], v[12:15], v[208:223]
    ds_read_b64_tr_b16 v[184:185], v8 offset:53248
    ds_read_b64_tr_b16 v[186:187], v8 offset:55296
    s_waitcnt lgkmcnt(8)
    v_mfma_f32_32x32x16_bf16 v[208:223], v[200:203], v[12:15], v[208:223]
    ds_read_b64_tr_b16 v[188:189], v8 offset:54272
    ds_read_b64_tr_b16 v[190:191], v8 offset:56320
    s_waitcnt lgkmcnt(8)
    v_mfma_f32_32x32x16_bf16 v[208:223], v[204:207], v[12:15], v[208:223]
    s_waitcnt lgkmcnt(6)
    v_mfma_f32_32x32x16_bf16 v[208:223], v[176:179], v[12:15], v[208:223]
    s_waitcnt lgkmcnt(4)
    v_mfma_f32_32x32x16_bf16 v[208:223], v[180:183], v[12:15], v[208:223]
    s_waitcnt lgkmcnt(2)
    v_mfma_f32_32x32x16_bf16 v[208:223], v[184:187], v[12:15], v[208:223]
    s_waitcnt lgkmcnt(0)
    v_mfma_f32_32x32x16_bf16 v[208:223], v[188:191], v[12:15], v[208:223]
    s_mov_b32 exec_lo, 1
    s_mov_b32 exec_hi, 1
    s_nop 9
    buffer_store_dwordx4 v[208:211], v9, s[4:7], s58 offen offset:0 sc1
    buffer_store_dwordx4 v[212:215], v9, s[4:7], s58 offen offset:16 sc1
    buffer_store_dwordx4 v[216:219], v9, s[4:7], s58 offen offset:32 sc1
    buffer_store_dwordx4 v[220:223], v9, s[4:7], s58 offen offset:48 sc1
    s_mov_b64 exec, -1
    s_lshl_b32 s52, s57, 3
    s_add_u32 s52, s52, 7
    s_mov_b32 s65, s52
    v_lshrrev_b32 v41, 11, v40
    v_mul_u32_u24 v41, 3584, v41
    v_and_b32 v44, 0x780, v40
    v_add_u32_e64 v41, v41, v44
    v_cmp_gt_u32 vcc, 0x700, v44
    s_mul_i32 s52, s56, 401408
    s_add_u32 s52, s52, 172032
    v_cndmask_b32 v41, v42, v41, vcc
    s_nop 0
    buffer_load_dword v43, v41, s[28:31], s52 offen
    s_add_u32 s52, s52, 57344
    buffer_load_dword v43, v41, s[28:31], s52 offen
    s_add_u32 s52, s52, 57344
    buffer_load_dword v43, v41, s[28:31], s52 offen
    s_add_u32 s52, s52, 57344
    buffer_load_dword v43, v41, s[28:31], s52 offen
    s_add_u32 s52, s52, 57344
    s_waitcnt vmcnt(4)
    s_barrier
    s_cmp_lg_u32 s44, 0
    s_cbranch_scc1 L_sig_112
    s_lshl_b32 s51, s65, 8
    s_add_u32 s51, s51, 524288
    v_mov_b32 v242, s45
    v_lshlrev_b32 v243, 2, v1
    s_mov_b32 exec_hi, 0
    buffer_store_dword v242, v243, s[4:7], s51 offen sc1
    s_mov_b32 exec_hi, -1
L_sig_112:
    s_branch L_c3d_113
L_noc3_111:
    v_lshrrev_b32_e64 v41, 11, v40
    v_mul_u32_u24 v41, 3584, v41
    v_and_b32 v44, 0x780, v40
    v_add_u32_e64 v41, v41, v44
    v_cmp_gt_u32 vcc, 0x700, v44
    s_mul_i32 s52, s56, 401408
    s_add_u32 s52, s52, 0
    v_cndmask_b32 v41, v42, v41, vcc
    buffer_load_dword v43, v41, s[28:31], s52 offen
    s_add_u32 s52, s52, 57344
    buffer_load_dword v43, v41, s[28:31], s52 offen
    s_add_u32 s52, s52, 57344
    buffer_load_dword v43, v41, s[28:31], s52 offen
    s_add_u32 s52, s52, 57344
    buffer_load_dword v43, v41, s[28:31], s52 offen
    s_add_u32 s52, s52, 57344
    buffer_load_dword v43, v41, s[28:31], s52 offen
    s_add_u32 s52, s52, 57344
    buffer_load_dword v43, v41, s[28:31], s52 offen
    s_add_u32 s52, s52, 57344
    buffer_load_dword v43, v41, s[28:31], s52 offen
    s_add_u32 s52, s52, 57344
L_c3d_113:
    v_lshrrev_b32_e64 v41, 11, v40
    v_mul_u32_u24 v41, 3584, v41
    v_and_b32 v44, 0x780, v40
    v_add_u32_e64 v41, v41, v44
    v_cmp_gt_u32 vcc, 0x700, v44
    s_mul_i32 s52, s56, 401408
    s_add_u32 s52, s52, 1792
    v_cndmask_b32 v41, v42, v41, vcc
    s_nop 0
    buffer_load_dword v43, v41, s[28:31], s52 offen
    s_add_u32 s52, s52, 57344
    buffer_load_dword v43, v41, s[28:31], s52 offen
    s_add_u32 s52, s52, 57344
    buffer_load_dword v43, v41, s[28:31], s52 offen
    s_add_u32 s52, s52, 57344
    buffer_load_dword v43, v41, s[28:31], s52 offen
    s_add_u32 s52, s52, 57344
    buffer_load_dword v43, v41, s[28:31], s52 offen
    s_add_u32 s52, s52, 57344
    buffer_load_dword v43, v41, s[28:31], s52 offen
    s_add_u32 s52, s52, 57344
    buffer_load_dword v43, v41, s[28:31], s52 offen
    s_add_u32 s52, s52, 57344
    s_mul_i32 s52, s57, 25088
    s_add_u32 s52, s52, 802816
    s_mov_b32 s53, 0
    s_mov_b32 s55, 1
L_pf_114:
    s_lshl_b32 s54, s53, 15
    v_lshl_add_u32 v41, v40, 0, s54
    v_cmp_gt_u32 vcc, 25088, v41
    s_add_u32 s53, s53, 1
    s_cmp_ge_u32 s53, 1
    s_cselect_b32 s53, 0, s53
    v_cndmask_b32 v41, v42, v41, vcc
    buffer_load_dword v43, v41, s[32:35], s52 offen
    s_sub_u32 s55, s55, 1
    s_cmp_lg_u32 s55, 0
    s_cbranch_scc1 L_pf_114
    s_getpc_b64 s[8:9]
L_pc_115:
    s_sub_u32 s8, s8, L_pc_115-L_p3
    s_subb_u32 s9, s9, 0
    s_mov_b32 s10, L_hh-L_p3
    s_mov_b32 s11, 0x20000
    s_mul_i32 s52, s56, 8192
    s_add_u32 s52, s52, 0
    s_mov_b32 s53, 0
    s_mov_b32 s55, 1
L_pf_116:
    s_lshl_b32 s54, s53, 15
    v_lshl_add_u32 v41, v40, 0, s54
    v_cmp_gt_u32 vcc, 8192, v41
    s_add_u32 s53, s53, 1
    s_cmp_ge_u32 s53, 1
    s_cselect_b32 s53, 0, s53
    v_cndmask_b32 v41, v42, v41, vcc
    buffer_load_dword v43, v41, s[8:11], s52 offen
    s_sub_u32 s55, s55, 1
    s_cmp_lg_u32 s55, 0
    s_cbranch_scc1 L_pf_116
    s_mul_i32 s58, s56, 200704
    s_add_u32 s58, s58, 172032
    s_mul_i32 s52, 0, 28672
    s_add_u32 s52, s52, s58
    s_mov_b32 s53, 0
    s_mov_b32 s55, 1
L_pf_117:
    s_lshl_b32 s54, s53, 15
    v_lshl_add_u32 v41, v40, 0, s54
    v_cmp_gt_u32 vcc, 28672, v41
    s_add_u32 s53, s53, 1
    s_cmp_ge_u32 s53, 1
    s_cselect_b32 s53, 0, s53
    v_cndmask_b32 v41, v42, v41, vcc
    buffer_load_dword v43, v41, s[32:35], s52 offen
    s_sub_u32 s55, s55, 1
    s_cmp_lg_u32 s55, 0
    s_cbranch_scc1 L_pf_117
    s_mul_i32 s58, s56, 200704
    s_add_u32 s58, s58, 802816
    s_mul_i32 s52, 0, 200704
    s_add_u32 s52, s52, s58
    s_lshr_b32 s53, s40, 1
    s_mul_i32 s53, s53, 7
    s_lshr_b32 s53, s53, 3
    s_mov_b32 s55, 7
L_pf_118:
    s_lshl_b32 s54, s53, 15
    v_lshl_add_u32 v41, v40, 0, s54
    v_cmp_gt_u32 vcc, 200704, v41
    s_add_u32 s53, s53, 1
    s_cmp_ge_u32 s53, 7
    s_cselect_b32 s53, 0, s53
    v_cndmask_b32 v41, v42, v41, vcc
    buffer_load_dword v43, v41, s[32:35], s52 offen
    s_sub_u32 s55, s55, 1
    s_cmp_lg_u32 s55, 0
    s_cbranch_scc1 L_pf_118
    s_waitcnt vmcnt(0)
    s_cmp_lg_u32 s3, 15
    s_cbranch_scc1 L_fin
    s_mov_b32 s54, 0
    s_cmp_lg_u32 s44, 0
    s_cbranch_scc1 L_pskip_119
    v_add_u32 v254, s54, v1
    v_and_b32 v254, 255, v254
    v_lshlrev_b32_e64 v254, 8, v254
    s_mov_b32 s52, 65536
    s_mov_b32 s53, 100000
    s_mov_b64 exec, -1
L_poll_122:
    buffer_load_dword v255, v254, s[4:7], s52 offen sc1
    s_waitcnt vmcnt(0)
    v_xor_b32 v255, s45, v255
    v_cmp_lt_u32 vcc, 15, v255
    s_sub_u32 s53, s53, 1
    s_cbranch_vccz L_pok_123
    s_cmp_gt_i32 s53, 0
    s_cbranch_scc1 L_poll_122
L_pok_123:
    s_mov_b64 exec, -1
L_pskip_119:
    s_barrier
    s_mov_b32 s54, 64
    s_cmp_lg_u32 s44, 0
    s_cbranch_scc1 L_pskip_124
    v_add_u32 v254, s54, v1
    v_and_b32 v254, 255, v254
    v_lshlrev_b32_e64 v254, 8, v254
    s_mov_b32 s52, 65536
    s_mov_b32 s53, 100000
    s_mov_b64 exec, -1
L_poll_127:
    buffer_load_dword v255, v254, s[4:7], s52 offen sc1
    s_waitcnt vmcnt(0)
    v_xor_b32 v255, s45, v255
    v_cmp_lt_u32 vcc, 15, v255
    s_sub_u32 s53, s53, 1
    s_cbranch_vccz L_pok_128
    s_cmp_gt_i32 s53, 0
    s_cbranch_scc1 L_poll_127
L_pok_128:
    s_mov_b64 exec, -1
L_pskip_124:
    s_barrier
    s_mov_b32 s54, 128
    s_cmp_lg_u32 s44, 0
    s_cbranch_scc1 L_pskip_129
    v_add_u32_e64 v254, s54, v1
    v_and_b32 v254, 255, v254
    v_lshlrev_b32_e64 v254, 8, v254
    s_mov_b32 s52, 65536
    s_mov_b32 s53, 100000
    s_mov_b64 exec, -1
L_poll_132:
    buffer_load_dword v255, v254, s[4:7], s52 offen sc1
    s_waitcnt vmcnt(0)
    v_xor_b32 v255, s45, v255
    v_cmp_lt_u32 vcc, 15, v255
    s_sub_u32 s53, s53, 1
    s_cbranch_vccz L_pok_133
    s_cmp_gt_i32 s53, 0
    s_cbranch_scc1 L_poll_132
L_pok_133:
    s_mov_b64 exec, -1
L_pskip_129:
    s_barrier
    s_mov_b32 s54, 192
    s_cmp_lg_u32 s44, 0
    s_cbranch_scc1 L_pskip_134
    v_add_u32_e64 v254, s54, v1
    v_and_b32 v254, 255, v254
    v_lshlrev_b32_e64 v254, 8, v254
    s_mov_b32 s52, 65536
    s_mov_b32 s53, 100000
    s_mov_b64 exec, -1
L_poll_137:
    buffer_load_dword v255, v254, s[4:7], s52 offen sc1
    s_waitcnt vmcnt(0)
    v_xor_b32 v255, s45, v255
    v_cmp_lt_u32 vcc, 15, v255
    s_sub_u32 s53, s53, 1
    s_cbranch_vccz L_pok_138
    s_cmp_gt_i32 s53, 0
    s_cbranch_scc1 L_poll_137
L_pok_138:
    s_mov_b64 exec, -1
L_pskip_134:
    s_barrier
    s_cmp_lg_u32 s44, 0
    s_cbranch_scc1 L_fin
    v_mov_b32_e64 v254, s45
    v_mov_b32 v255, 0
    s_mov_b64 exec, 1
    buffer_store_dword v254, v255, s[4:7], 0 offen sc1
    s_mov_b64 exec, -1
    s_branch L_fin
L_fin:
L_end:
    s_endpgm
.section .rodata,"a"
.p2align 6
.amdhsa_kernel sequential_preLN__sliding_block__mixer_s_mlp__prompt_kernel
  .amdhsa_next_free_vgpr 512
  .amdhsa_next_free_sgpr 102
  .amdhsa_accum_offset 256
  .amdhsa_group_segment_fixed_size 0
  .amdhsa_kernarg_size 88
  .amdhsa_user_sgpr_count 2
  .amdhsa_user_sgpr_kernarg_segment_ptr 1
  .amdhsa_system_sgpr_workgroup_id_x 1
.end_amdhsa_kernel
```
